```python
import torch

def _softmax(x, axis=-1):
    return torch.softmax(x, dim=axis)
def _gelu(x):
    return torch.nn.functional.gelu(x, approximate="tanh")
def _silu(x):
    return torch.nn.functional.silu(x)
def _sigmoid(x):
    return torch.sigmoid(x)
def _layernorm(x, axis=-1, eps=1e-5):
    m = x.mean(dim=axis, keepdim=True)
    v = x.var(dim=axis, keepdim=True, unbiased=False)
    return (x - m) / torch.sqrt(v + eps)
def _scatter_add(tgt, idx, src, axis=0):
    return tgt.clone().index_add_(axis, idx, src)
def _segment_sum(src, seg, n):
    out = torch.zeros((n,) + src.shape[1:], dtype=src.dtype)
    return out.index_add_(0, seg, src)
def _pad(x, pw):
    flat = tuple(v for pair in reversed(pw) for v in pair)
    return torch.nn.functional.pad(x, flat)

kernel_name = 'standalone__qk_norm__prompt'

def setup_inputs():

    _w = (lambda a: (lambda t: t.to(torch.bfloat16) if t.is_floating_point() else t)(torch.as_tensor(a)))
    B, H, S, D = 2, 32, 2048, 1024
    Dh = D // H
    return {
        "q": _w((lambda *s: torch.randn(*s, dtype=torch.bfloat16) * 0.05)(B, H, S, Dh)),
        "k": _w((lambda *s: torch.randn(*s, dtype=torch.bfloat16) * 0.05)(B, H, S, Dh)),
        "v": _w((lambda *s: torch.randn(*s, dtype=torch.bfloat16) * 0.8)(B, H, S, Dh)),
        "t": _w(torch.abs((lambda *s: torch.randn(*s, dtype=torch.bfloat16) * 0.8)(H)) + 1.0),
    }

def reference(q, k, v, t):
    eps = 1e-6
    qn = q / (torch.sqrt((q * q).sum(axis=-1, keepdims=True)) + eps)
    kn = k / (torch.sqrt((k * k).sum(axis=-1, keepdims=True)) + eps)
    logits = torch.einsum('bhqd,bhkd->bhqk', qn, kn) * t[None, :, None, None]
    attn = _softmax(logits, axis=-1)
    return torch.einsum('bhqk,bhkd->bhqd', attn, v)
```

```asm
; @launch grid=(256,1,1) block=(320,1,1) lds=65536
.amdgcn_target "amdgcn-amd-amdhsa--gfx950"
.text
.globl standalone__qk_norm__prompt_kernel
.p2align 8
.type standalone__qk_norm__prompt_kernel,@function
standalone__qk_norm__prompt_kernel:
    s_load_dwordx8 s[36:43], s[0:1], 0
    s_load_dwordx4 s[44:47], s[0:1], 32
    s_load_dwordx2 s[48:49], s[0:1], 48
    s_cmp_ge_u32 s2, 256
    s_cbranch_scc1 L_end
    s_getpc_b64 s[50:51]
    v_sub_u32 v14, 319, v0
    v_min_u32 v14, 96, v14
    v_lshlrev_b32 v14, 7, v14
    v_mov_b32 v15, s51
    v_add_co_u32 v14, vcc, s50, v14
    v_lshrrev_b32 v12, 6, v0
    v_and_b32 v0, 63, v0
    v_addc_co_u32 v15, vcc, 0, v15, vcc
    global_load_dword v11, v[14:15], off
    v_readfirstlane_b32 s28, v12
    s_and_b32 s50, s2, 7
    s_lshr_b32 s51, s2, 5
    s_lshl3_add_u32 s30, s50, s51
    s_bfe_u32 s29, s2, 0x20003
    s_lshl_b32 s52, s30, 17
    s_lshl_b32 s57, s29, 15
    s_and_b32 s58, s30, 15
    s_lshl_b32 s58, s58, 13
    v_bfe_u32 v14, v0, 4, 1
    v_xor_b32 v14, v14, v0
    v_lshlrev_b32 v6, 5, v14
    s_mov_b32 s10, 0x20000
    s_mov_b32 s11, 0x20000
    s_mov_b64 s[6:7], s[10:11]
    s_cmp_ge_u32 s28, 4
    s_cbranch_scc1 L_loader
    s_lshl_b32 s55, s28, 11
    s_add_u32 s56, s55, s57
    s_and_b32 s33, s58, 0x7fff
    s_add_u32 s33, s33, s56
    s_add_u32 s32, s58, s55
    v_and_b32 v12, 31, v0
    v_lshrrev_b32 v13, 5, v0
    v_lshlrev_b32 v1, 6, v12
    v_lshl_add_u32 v1, v13, 4, v1
    s_and_b32 s53, s30, 30
    s_lshl_b32 s53, s53, 1
    s_add_u32 s3, s58, 8192
    s_and_b32 s3, s3, 0x1ffff
    s_add_u32 s34, s58, s57
    s_and_b32 s51, s30, 1
    s_lshl_b32 s51, s51, 4
    v_lshlrev_b32 v2, 4, v0
    s_mov_b64 s[14:15], s[10:11]
    s_mov_b64 s[18:19], s[10:11]
    s_mov_b64 s[22:23], s[10:11]
    s_mov_b64 s[26:27], s[10:11]
    s_movk_i32 s26, 256
    s_mov_b32 s61, 0x358637bd
    s_mov_b64 vcc, 0
    s_add_u32 s35, s58, 8192
    s_and_b32 s35, s35, 0x7fff
    s_add_u32 s35, s35, s56
    s_add_u32 s54, s58, 16384
    s_and_b32 s54, s54, 0x7fff
    s_add_u32 s54, s54, s56
    s_add_u32 s59, s58, 24576
    s_and_b32 s59, s59, 0x7fff
    s_add_u32 s59, s59, s56
    s_waitcnt lgkmcnt(0)
    s_add_u32 s8, s38, s52
    s_addc_u32 s9, s39, 0
    buffer_load_dwordx4 v[24:27], v6, s[8:11], s32 offen
    buffer_load_dwordx4 v[28:31], v6, s[8:11], s32 offen offset:16
    s_add_u32 s4, s36, s52
    s_addc_u32 s5, s37, 0
    buffer_load_dwordx4 v[32:35], v1, s[4:7], s33 offen
    buffer_load_dwordx4 v[36:39], v1, s[4:7], s33 offen offset:32
    s_load_dword s31, s[42:43], s53
    s_add_u32 s12, s40, s52
    s_addc_u32 s13, s41, 0
    s_add_u32 s16, s44, s52
    s_addc_u32 s17, s45, 0
    s_add_u32 s20, s48, s52
    s_addc_u32 s21, s49, 0
    s_mov_b32 s24, s46
    s_mov_b32 s25, s47
    s_branch L_main
L_loader:
    s_setprio 3
    s_and_b32 s53, s30, 30
    s_lshl_b32 s53, s53, 1
    s_add_u32 s3, s58, 8192
    s_and_b32 s3, s3, 0x1ffff
    s_add_u32 s34, s58, s57
    s_and_b32 s51, s30, 1
    s_lshl_b32 s51, s51, 4
    v_lshlrev_b32 v2, 4, v0
    s_mov_b64 s[14:15], s[10:11]
    s_mov_b64 s[18:19], s[10:11]
    s_mov_b64 s[22:23], s[10:11]
    s_mov_b64 s[26:27], s[10:11]
    s_movk_i32 s26, 256
    s_mov_b32 s61, 0x358637bd
    s_mov_b64 vcc, -1
    s_mov_b32 s33, s34
    s_lshl_b32 s50, s30, 8
    v_mov_b32 v7, s50
    s_add_u32 s50, s50, s29
    v_lshl_add_u32 v1, v0, 14, s50
    s_lshl_b32 s50, s2, 14
    v_lshl_add_u32 v3, v0, 8, s50
    v_mov_b32 v5, 1
    v_mov_b32 v4, 3
    v_mov_b32 v10, 7
    v_mov_b32 v20, 0
    v_and_b32 v22, 48, v0
    v_xor_b32 v22, v22, v2
    s_mov_b32 s18, 16384
    v_lshlrev_b32 v16, 7, v0
    v_mov_b32 v9, -1
    s_waitcnt lgkmcnt(0)
    s_load_dword s31, s[42:43], s53
    s_add_u32 s12, s40, s52
    s_addc_u32 s13, s41, 0
    s_add_u32 s4, s36, s52
    s_addc_u32 s5, s37, 0
    s_add_u32 s8, s38, s52
    s_addc_u32 s9, s39, 0
    s_add_u32 s20, s48, s52
    s_addc_u32 s21, s49, 0
    s_mov_b32 s24, s46
    s_mov_b32 s25, s47
    s_add_u32 s16, s48, 0x800000
    s_addc_u32 s17, s49, 0
    s_getpc_b64 s[90:91]
L_pc1:
    s_add_u32 s90, s90, L_main-L_pc1+8192
    s_addc_u32 s91, s91, 0
    v_mov_b32 v33, s91
    v_add_co_u32 v32, s[92:93], s90, v16
    s_add_u32 s90, s90, 8192
    s_addc_u32 s91, s91, 0
    v_addc_co_u32 v33, s[92:93], 0, v33, s[92:93]
    v_mov_b32 v35, s91
    v_add_co_u32 v34, s[92:93], s90, v16
    s_add_u32 s90, s90, 8192
    s_addc_u32 s91, s91, 0
    v_addc_co_u32 v35, s[92:93], 0, v35, s[92:93]
    v_mov_b32 v37, s91
    v_add_co_u32 v36, s[92:93], s90, v16
    s_add_u32 s90, s90, 6144
    s_addc_u32 s91, s91, 0
    v_addc_co_u32 v37, s[92:93], 0, v37, s[92:93]
    v_mov_b32 v39, s91
    v_add_co_u32 v38, s[92:93], s90, v16
    s_add_u32 s90, s90, 6144
    s_addc_u32 s91, s91, 0
    v_addc_co_u32 v39, s[92:93], 0, v39, s[92:93]
    s_waitcnt lgkmcnt(0)
    s_mov_b32 m0, 32768
    s_nop 0
    buffer_load_dwordx4 v2, s[12:15], s58 offen offset:0  lds
    buffer_load_dwordx4 v2, s[12:15], s58 offen offset:1024  lds
    buffer_load_dwordx4 v2, s[12:15], s58 offen offset:2048  lds
    buffer_load_dwordx4 v2, s[12:15], s58 offen offset:3072  lds
    s_mov_b32 m0, 36864
    s_add_u32 s50, s58, 4096
    buffer_load_dwordx4 v2, s[12:15], s50 offen offset:0  lds
    buffer_load_dwordx4 v2, s[12:15], s50 offen offset:1024  lds
    buffer_load_dwordx4 v2, s[12:15], s50 offen offset:2048  lds
    buffer_load_dwordx4 v2, s[12:15], s50 offen offset:3072  lds
    s_add_u32 s35, s58, 8192
    s_and_b32 s35, s35, 0x7fff
    s_add_u32 s35, s35, s57
    s_mov_b32 m0, 16384
    s_nop 0
    buffer_load_dwordx4 v22, s[4:7], s35 offen offset:0 lds
    buffer_load_dwordx4 v22, s[4:7], s35 offen offset:1024 lds
    buffer_load_dwordx4 v22, s[4:7], s35 offen offset:2048 lds
    buffer_load_dwordx4 v22, s[4:7], s35 offen offset:3072 lds
    s_mov_b32 m0, 20480
    s_add_u32 s50, s35, 4096
    buffer_load_dwordx4 v22, s[4:7], s50 offen offset:0 lds
    buffer_load_dwordx4 v22, s[4:7], s50 offen offset:1024 lds
    buffer_load_dwordx4 v22, s[4:7], s50 offen offset:2048 lds
    buffer_load_dwordx4 v22, s[4:7], s50 offen offset:3072 lds
    s_waitcnt lgkmcnt(0)
    s_lshr_b32 s31, s31, s51
    s_lshl_b32 s31, s31, 16
    s_and_b32 s50, s31, 0x7fffffff
    s_cmp_gt_u32 s50, 0x41800000
    s_cbranch_scc1 L_loader_slow
    s_barrier
    s_add_u32 s35, s58, 16384
    s_and_b32 s35, s35, 0x7fff
    s_add_u32 s35, s35, s57
    s_mov_b32 m0, 24576
    s_nop 0
    buffer_load_dwordx4 v22, s[4:7], s35 offen offset:0 lds
    buffer_load_dwordx4 v22, s[4:7], s35 offen offset:1024 lds
    buffer_load_dwordx4 v22, s[4:7], s35 offen offset:2048 lds
    buffer_load_dwordx4 v22, s[4:7], s35 offen offset:3072 lds
    s_mov_b32 m0, 28672
    s_add_u32 s50, s35, 4096
    buffer_load_dwordx4 v22, s[4:7], s50 offen offset:0 lds
    buffer_load_dwordx4 v22, s[4:7], s50 offen offset:1024 lds
    buffer_load_dwordx4 v22, s[4:7], s50 offen offset:2048 lds
    buffer_load_dwordx4 v22, s[4:7], s50 offen offset:3072 lds
    s_waitcnt vmcnt(16)
    s_barrier
    s_waitcnt vmcnt(8)
    s_barrier
    s_add_u32 s35, s58, 24576
    s_and_b32 s35, s35, 0x7fff
    s_add_u32 s35, s35, s57
    s_mov_b32 m0, 49152
    s_nop 0
    buffer_load_dwordx4 v22, s[4:7], s35 offen offset:0 lds
    buffer_load_dwordx4 v22, s[4:7], s35 offen offset:1024 lds
    buffer_load_dwordx4 v22, s[4:7], s35 offen offset:2048 lds
    buffer_load_dwordx4 v22, s[4:7], s35 offen offset:3072 lds
    s_mov_b32 m0, 53248
    s_add_u32 s50, s35, 4096
    buffer_load_dwordx4 v22, s[4:7], s50 offen offset:0 lds
    buffer_load_dwordx4 v22, s[4:7], s50 offen offset:1024 lds
    buffer_load_dwordx4 v22, s[4:7], s50 offen offset:2048 lds
    buffer_load_dwordx4 v22, s[4:7], s50 offen offset:3072 lds
    s_add_u32 s34, s34, 8192
    s_and_b32 s34, s34, 0x1ffff
    s_cmp_eq_u32 s34, s58
    s_cselect_b32 s34, s3, s34
    s_add_u32 s50, s34, 4096
    s_mov_b32 m0, 8192
    s_nop 0
    buffer_load_dwordx4 v6, s[8:11], s34 offen offset:0  lds
    buffer_load_dwordx4 v6, s[8:11], s34 offen offset:2048  lds
    s_mov_b32 m0, 9200
    s_nop 0
    buffer_load_dwordx4 v6, s[8:11], s34 offen offset:16  lds
    buffer_load_dwordx4 v6, s[8:11], s34 offen offset:2064  lds
    s_mov_b32 m0, 12288
    s_nop 0
    buffer_load_dwordx4 v6, s[8:11], s50 offen offset:0  lds
    buffer_load_dwordx4 v6, s[8:11], s50 offen offset:2048  lds
    s_mov_b32 m0, 13296
    s_nop 0
    buffer_load_dwordx4 v6, s[8:11], s50 offen offset:16  lds
    buffer_load_dwordx4 v6, s[8:11], s50 offen offset:2064  lds
    buffer_store_dword v20, v3, s[16:19], 0 offen sc1
    s_branch L_pad1
L_hop1:
    s_waitcnt vmcnt(17)
    s_barrier
    s_add_u32 s33, s33, 8192
    s_and_b32 s33, s33, 0x1ffff
    s_cmp_eq_u32 s33, s58
    s_cselect_b32 s33, s3, s33
    s_mov_b32 m0, 40960
    s_nop 0
    buffer_load_dwordx4 v2, s[12:15], s33 offen offset:0  lds
    buffer_load_dwordx4 v2, s[12:15], s33 offen offset:1024  lds
    buffer_load_dwordx4 v2, s[12:15], s33 offen offset:2048  lds
    buffer_load_dwordx4 v2, s[12:15], s33 offen offset:3072  lds
    s_mov_b32 m0, 45056
    s_add_u32 s50, s33, 4096
    buffer_load_dwordx4 v2, s[12:15], s50 offen offset:0  lds
    buffer_load_dwordx4 v2, s[12:15], s50 offen offset:1024  lds
    buffer_load_dwordx4 v2, s[12:15], s50 offen offset:2048  lds
    buffer_load_dwordx4 v2, s[12:15], s50 offen offset:3072  lds
    global_load_dword v21, v[32:33], off
    global_load_dword v21, v[34:35], off
    global_load_dword v21, v[36:37], off
    global_load_dword v21, v[38:39], off
    s_waitcnt vmcnt(21)
    s_barrier
    s_waitcnt vmcnt(13)
    s_barrier
    s_waitcnt vmcnt(0)
    buffer_store_dword v5, v3, s[24:27], 0 offen sc1
    s_add_u32 s34, s34, 8192
    s_and_b32 s34, s34, 0x1ffff
    s_cmp_eq_u32 s34, s58
    s_cselect_b32 s34, s3, s34
    s_add_u32 s50, s34, 4096
    s_mov_b32 m0, 16384
    s_nop 0
    buffer_load_dwordx4 v6, s[8:11], s34 offen offset:0  lds
    buffer_load_dwordx4 v6, s[8:11], s34 offen offset:2048  lds
    s_mov_b32 m0, 17392
    s_nop 0
    buffer_load_dwordx4 v6, s[8:11], s34 offen offset:16  lds
    buffer_load_dwordx4 v6, s[8:11], s34 offen offset:2064  lds
    s_mov_b32 m0, 20480
    s_nop 0
    buffer_load_dwordx4 v6, s[8:11], s50 offen offset:0  lds
    buffer_load_dwordx4 v6, s[8:11], s50 offen offset:2048  lds
    s_mov_b32 m0, 21488
    s_nop 0
    buffer_load_dwordx4 v6, s[8:11], s50 offen offset:16  lds
    buffer_load_dwordx4 v6, s[8:11], s50 offen offset:2064  lds
    s_barrier
    s_add_u32 s33, s33, 8192
    s_and_b32 s33, s33, 0x1ffff
    s_cmp_eq_u32 s33, s58
    s_cselect_b32 s33, s3, s33
    s_mov_b32 m0, 49152
    s_nop 0
    buffer_load_dwordx4 v2, s[12:15], s33 offen offset:0  lds
    buffer_load_dwordx4 v2, s[12:15], s33 offen offset:1024  lds
    buffer_load_dwordx4 v2, s[12:15], s33 offen offset:2048  lds
    buffer_load_dwordx4 v2, s[12:15], s33 offen offset:3072  lds
    s_mov_b32 m0, 53248
    s_add_u32 s50, s33, 4096
    buffer_load_dwordx4 v2, s[12:15], s50 offen offset:0  lds
    buffer_load_dwordx4 v2, s[12:15], s50 offen offset:1024  lds
    buffer_load_dwordx4 v2, s[12:15], s50 offen offset:2048  lds
    buffer_load_dwordx4 v2, s[12:15], s50 offen offset:3072  lds
    s_branch L_pad2
L_hop2:
    s_waitcnt vmcnt(8)
    s_barrier
    s_add_u32 s34, s34, 8192
    s_and_b32 s34, s34, 0x1ffff
    s_cmp_eq_u32 s34, s58
    s_cselect_b32 s34, s3, s34
    s_add_u32 s50, s34, 4096
    s_mov_b32 m0, 24576
    s_nop 0
    buffer_load_dwordx4 v6, s[8:11], s34 offen offset:0  lds
    buffer_load_dwordx4 v6, s[8:11], s34 offen offset:2048  lds
    s_mov_b32 m0, 25584
    s_nop 0
    buffer_load_dwordx4 v6, s[8:11], s34 offen offset:16  lds
    buffer_load_dwordx4 v6, s[8:11], s34 offen offset:2064  lds
    s_mov_b32 m0, 28672
    s_nop 0
    buffer_load_dwordx4 v6, s[8:11], s50 offen offset:0  lds
    buffer_load_dwordx4 v6, s[8:11], s50 offen offset:2048  lds
    s_mov_b32 m0, 29680
    s_nop 0
    buffer_load_dwordx4 v6, s[8:11], s50 offen offset:16  lds
    buffer_load_dwordx4 v6, s[8:11], s50 offen offset:2064  lds
    s_waitcnt vmcnt(8)
    s_barrier
    s_add_u32 s33, s33, 8192
    s_and_b32 s33, s33, 0x1ffff
    s_cmp_eq_u32 s33, s58
    s_cselect_b32 s33, s3, s33
    s_mov_b32 m0, 57344
    s_nop 0
    buffer_load_dwordx4 v2, s[12:15], s33 offen offset:0  lds
    buffer_load_dwordx4 v2, s[12:15], s33 offen offset:1024  lds
    buffer_load_dwordx4 v2, s[12:15], s33 offen offset:2048  lds
    buffer_load_dwordx4 v2, s[12:15], s33 offen offset:3072  lds
    s_mov_b32 m0, 61440
    s_add_u32 s50, s33, 4096
    buffer_load_dwordx4 v2, s[12:15], s50 offen offset:0  lds
    buffer_load_dwordx4 v2, s[12:15], s50 offen offset:1024  lds
    buffer_load_dwordx4 v2, s[12:15], s50 offen offset:2048  lds
    buffer_load_dwordx4 v2, s[12:15], s50 offen offset:3072  lds
    s_waitcnt vmcnt(8)
    s_barrier
    buffer_load_dword v8, v20, s[24:27], 0 offen sc1
    s_add_u32 s34, s34, 8192
    s_and_b32 s34, s34, 0x1ffff
    s_cmp_eq_u32 s34, s58
    s_cselect_b32 s34, s3, s34
    s_add_u32 s50, s34, 4096
    s_mov_b32 m0, 0
    s_nop 0
    buffer_load_dwordx4 v6, s[8:11], s34 offen offset:0  lds
    buffer_load_dwordx4 v6, s[8:11], s34 offen offset:2048  lds
    s_mov_b32 m0, 1008
    s_nop 0
    buffer_load_dwordx4 v6, s[8:11], s34 offen offset:16  lds
    buffer_load_dwordx4 v6, s[8:11], s34 offen offset:2064  lds
    s_mov_b32 m0, 4096
    s_nop 0
    buffer_load_dwordx4 v6, s[8:11], s50 offen offset:0  lds
    buffer_load_dwordx4 v6, s[8:11], s50 offen offset:2048  lds
    s_mov_b32 m0, 5104
    s_nop 0
    buffer_load_dwordx4 v6, s[8:11], s50 offen offset:16  lds
    buffer_load_dwordx4 v6, s[8:11], s50 offen offset:2064  lds
    s_waitcnt vmcnt(9)
    s_barrier
    s_mov_b32 s32, 1
    s_mov_b32 s60, 256
L_spin1:
    s_waitcnt vmcnt(0)
    v_readfirstlane_b32 s54, v8
    s_sub_u32 s60, s60, 1
    s_nop 2
    s_and_b32 s54, s54, 0x1
    s_cmp_eq_u32 s54, 0x1
    s_cbranch_scc1 L_ready1
    buffer_load_dword v8, v20, s[24:27], 0 offen sc1
    s_cmp_lg_u32 s60, 0
    s_cbranch_scc1 L_spin1
    s_branch L_help
L_ready1:
    buffer_store_byte v5, v1, s[16:19], 0 offen sc1
    s_add_u32 s33, s33, 8192
    s_and_b32 s33, s33, 0x1ffff
    s_cmp_eq_u32 s33, s58
    s_cselect_b32 s33, s3, s33
    s_mov_b32 m0, 32768
    s_nop 0
    buffer_load_dwordx4 v2, s[12:15], s33 offen offset:0  lds
    buffer_load_dwordx4 v2, s[12:15], s33 offen offset:1024  lds
    buffer_load_dwordx4 v2, s[12:15], s33 offen offset:2048  lds
    buffer_load_dwordx4 v2, s[12:15], s33 offen offset:3072  lds
    s_mov_b32 m0, 36864
    s_add_u32 s50, s33, 4096
    buffer_load_dwordx4 v2, s[12:15], s50 offen offset:0  lds
    buffer_load_dwordx4 v2, s[12:15], s50 offen offset:1024  lds
    buffer_load_dwordx4 v2, s[12:15], s50 offen offset:2048  lds
    buffer_load_dwordx4 v2, s[12:15], s50 offen offset:3072  lds
    s_branch L_pad3
L_hop3:
    s_waitcnt vmcnt(10)
    s_barrier
    s_add_u32 s33, s33, 8192
    s_and_b32 s33, s33, 0x1ffff
    s_cmp_eq_u32 s33, s58
    s_cselect_b32 s33, s3, s33
    s_mov_b32 m0, 40960
    s_nop 0
    buffer_load_dwordx4 v2, s[12:15], s33 offen offset:0  lds
    buffer_load_dwordx4 v2, s[12:15], s33 offen offset:1024  lds
    buffer_load_dwordx4 v2, s[12:15], s33 offen offset:2048  lds
    buffer_load_dwordx4 v2, s[12:15], s33 offen offset:3072  lds
    s_mov_b32 m0, 45056
    s_add_u32 s50, s33, 4096
    buffer_load_dwordx4 v2, s[12:15], s50 offen offset:0  lds
    buffer_load_dwordx4 v2, s[12:15], s50 offen offset:1024  lds
    buffer_load_dwordx4 v2, s[12:15], s50 offen offset:2048  lds
    buffer_load_dwordx4 v2, s[12:15], s50 offen offset:3072  lds
    buffer_load_dword v8, v7, s[16:19], 0 offen sc1
    s_waitcnt vmcnt(9)
    s_barrier
    s_cmp_eq_u32 s32, 9
    s_cbranch_scc1 L_ready2
    s_mov_b32 s32, 2
    s_mov_b32 s60, 256
L_spin2:
    s_waitcnt vmcnt(0)
    v_readfirstlane_b32 s54, v8
    s_sub_u32 s60, s60, 1
    s_nop 2
    s_and_b32 s54, s54, 0x1010101
    s_cmp_eq_u32 s54, 0x1010101
    s_cbranch_scc1 L_ready2
    buffer_load_dword v8, v7, s[16:19], 0 offen sc1
    s_cmp_lg_u32 s60, 0
    s_cbranch_scc1 L_spin2
    s_branch L_help
L_ready2:
    buffer_store_byte v4, v1, s[16:19], 0 offen sc1
    s_add_u32 s34, s34, 8192
    s_and_b32 s34, s34, 0x1ffff
    s_cmp_eq_u32 s34, s58
    s_cselect_b32 s34, s3, s34
    s_mov_b32 m0, 8192
    s_nop 0
    buffer_load_dwordx4 v2, s[20:23], s34 offen offset:0 sc1 lds
    buffer_load_dwordx4 v2, s[20:23], s34 offen offset:1024 sc1 lds
    buffer_load_dwordx4 v2, s[20:23], s34 offen offset:2048 sc1 lds
    buffer_load_dwordx4 v2, s[20:23], s34 offen offset:3072 sc1 lds
    s_mov_b32 m0, 12288
    s_add_u32 s50, s34, 4096
    buffer_load_dwordx4 v2, s[20:23], s50 offen offset:0 sc1 lds
    buffer_load_dwordx4 v2, s[20:23], s50 offen offset:1024 sc1 lds
    buffer_load_dwordx4 v2, s[20:23], s50 offen offset:2048 sc1 lds
    buffer_load_dwordx4 v2, s[20:23], s50 offen offset:3072 sc1 lds
    s_add_u32 s33, s33, 8192
    s_and_b32 s33, s33, 0x1ffff
    s_cmp_eq_u32 s33, s58
    s_cselect_b32 s33, s3, s33
    s_mov_b32 m0, 49152
    s_nop 0
    buffer_load_dwordx4 v2, s[12:15], s33 offen offset:0  lds
    buffer_load_dwordx4 v2, s[12:15], s33 offen offset:1024  lds
    buffer_load_dwordx4 v2, s[12:15], s33 offen offset:2048  lds
    buffer_load_dwordx4 v2, s[12:15], s33 offen offset:3072  lds
    s_mov_b32 m0, 53248
    s_add_u32 s50, s33, 4096
    buffer_load_dwordx4 v2, s[12:15], s50 offen offset:0  lds
    buffer_load_dwordx4 v2, s[12:15], s50 offen offset:1024  lds
    buffer_load_dwordx4 v2, s[12:15], s50 offen offset:2048  lds
    buffer_load_dwordx4 v2, s[12:15], s50 offen offset:3072  lds
    s_branch L_loader2
.p2align 12
L_main:
    v_mov_b32 v5, 0xdddddddd
    v_add_u32 v4, s55, v2
    v_bfe_u32 v14, v0, 3, 1
    v_lshl_add_u32 v14, v12, 1, v14
    v_lshlrev_b32 v14, 4, v14
    v_lshl_add_u32 v7, v13, 10, v14
    v_xor_b32 v8, 16, v7
    v_bfe_u32 v14, v0, 2, 2
    v_lshl_add_u32 v14, v13, 3, v14
    v_lshlrev_b32 v3, 6, v14
    v_and_b32 v14, 1, v0
    v_lshl_add_u32 v3, v14, 5, v3
    v_bfe_u32 v14, v0, 4, 1
    v_lshl_add_u32 v3, v14, 4, v3
    v_bfe_u32 v14, v0, 1, 1
    v_lshl_add_u32 v3, v14, 3, v3
    v_and_b32 v14, 15, v0
    v_and_b32 v15, 48, v0
    v_lshl_add_u32 v9, v14, 6, v15
    v_and_b32 v14, 7, v0
    v_lshlrev_b32_e64 v14, v14, 1
    v_bfe_i32 v15, v14, 0, 1
    v_and_b32 v20, 0x3f803f80, v15
    v_and_b32 v21, 0x3f803f80, v15
    v_bfe_i32 v15, v14, 4, 1
    v_and_b32 v22, 0x3f803f80, v15
    v_and_b32 v23, 0x3f803f80, v15
    v_mov_b32 v10, 0x3fb8aa3b
    v_mov_b64 v[64:65], 0
    v_mov_b64 v[66:67], 0
    v_mov_b64 v[68:69], 0
    v_mov_b64 v[70:71], 0
    v_mov_b64 v[72:73], 0
    v_mov_b64 v[74:75], 0
    v_mov_b64 v[76:77], 0
    v_mov_b64 v[78:79], 0
    v_mov_b64 v[80:81], 0
    v_mov_b64 v[82:83], 0
    v_mov_b64 v[84:85], 0
    v_mov_b64 v[86:87], 0
    v_mov_b64 v[88:89], 0
    v_mov_b64 v[90:91], 0
    v_mov_b64 v[92:93], 0
    v_mov_b64 v[94:95], 0
    v_mov_b64 v[96:97], 0
    v_mov_b64 v[98:99], 0
    v_mov_b64 v[100:101], 0
    v_mov_b64 v[102:103], 0
    v_mov_b64 v[104:105], 0
    v_mov_b64 v[106:107], 0
    v_mov_b64 v[108:109], 0
    v_mov_b64 v[110:111], 0
    v_mov_b64 v[112:113], 0
    v_mov_b64 v[114:115], 0
    v_mov_b64 v[116:117], 0
    v_mov_b64 v[118:119], 0
    v_mov_b64 v[120:121], 0
    v_mov_b64 v[122:123], 0
    v_mov_b64 v[124:125], 0
    v_mov_b64 v[126:127], 0
    v_mov_b64 v[128:129], 0
    v_mov_b64 v[130:131], 0
    v_mov_b64 v[132:133], 0
    v_mov_b64 v[134:135], 0
    v_mov_b64 v[136:137], 0
    v_mov_b64 v[138:139], 0
    v_mov_b64 v[140:141], 0
    v_mov_b64 v[142:143], 0
    s_waitcnt lgkmcnt(0)
    s_lshr_b32 s31, s31, s51
    s_lshl_b32 s31, s31, 16
    s_and_b32 s50, s31, 0x7fffffff
    v_mul_f32 v10, s31, v10
    s_cmp_gt_u32 s50, 0x41800000
    s_cbranch_scc1 L_slow
    v_bfe_u32 v14, v0, 2, 2
    v_lshlrev_b32 v14, 4, v14
    v_xor_b32 v1, v1, v14
    v_add_u32 v1, s55, v1
    v_xor_b32 v6, 32, v1
    s_waitcnt vmcnt(2)
    v_dot2_f32_bf16 v12, v24, v24, 0
    v_dot2_f32_bf16 v12, v25, v25, v12
    v_dot2_f32_bf16 v12, v26, v26, v12
    v_dot2_f32_bf16 v12, v27, v27, v12
    v_dot2_f32_bf16 v12, v28, v28, v12
    v_dot2_f32_bf16 v12, v29, v29, v12
    v_dot2_f32_bf16 v12, v30, v30, v12
    v_dot2_f32_bf16 v12, v31, v31, v12
    v_lshlrev_b32 v14, 16, v24
    v_and_b32 v15, 0xffff0000, v24
    v_lshlrev_b32 v16, 16, v25
    v_add_f32_dpp v12, v12, v12 quad_perm:[1,0,3,2] row_mask:0xf bank_mask:0xf
    v_sqrt_f32 v12, v12
    v_and_b32 v17, 0xffff0000, v25
    v_add_f32 v12, s61, v12
    v_rcp_f32 v12, v12
    v_lshlrev_b32 v18, 16, v26
    v_pk_mul_f32 v[14:15], v[14:15], v[12:13] op_sel_hi:[1,0]
    v_cvt_pk_bf16_f32 v24, v14, v15
    v_pk_mul_f32 v[16:17], v[16:17], v[12:13] op_sel_hi:[1,0]
    v_cvt_pk_bf16_f32 v25, v16, v17
    v_and_b32 v19, 0xffff0000, v26
    v_pk_mul_f32 v[18:19], v[18:19], v[12:13] op_sel_hi:[1,0]
    v_cvt_pk_bf16_f32 v26, v18, v19
    v_lshlrev_b32 v14, 16, v27
    v_and_b32 v15, 0xffff0000, v27
    v_pk_mul_f32 v[14:15], v[14:15], v[12:13] op_sel_hi:[1,0]
    v_cvt_pk_bf16_f32 v27, v14, v15
    v_lshlrev_b32 v16, 16, v28
    v_and_b32 v17, 0xffff0000, v28
    v_pk_mul_f32 v[16:17], v[16:17], v[12:13] op_sel_hi:[1,0]
    v_cvt_pk_bf16_f32 v28, v16, v17
    v_lshlrev_b32 v18, 16, v29
    v_and_b32 v19, 0xffff0000, v29
    v_pk_mul_f32 v[18:19], v[18:19], v[12:13] op_sel_hi:[1,0]
    v_cvt_pk_bf16_f32 v29, v18, v19
    v_lshlrev_b32 v14, 16, v30
    v_and_b32 v15, 0xffff0000, v30
    v_pk_mul_f32 v[14:15], v[14:15], v[12:13] op_sel_hi:[1,0]
    v_cvt_pk_bf16_f32 v30, v14, v15
    v_lshlrev_b32 v16, 16, v31
    v_and_b32 v17, 0xffff0000, v31
    v_pk_mul_f32 v[16:17], v[16:17], v[12:13] op_sel_hi:[1,0]
    v_cvt_pk_bf16_f32 v31, v16, v17
    ds_write_b128 v4, v[24:27] offset:0
    ds_write_b128 v4, v[28:31] offset:1024
    s_waitcnt vmcnt(0)
    v_dot2_f32_bf16 v12, v32, v32, 0
    v_dot2_f32_bf16 v12, v33, v33, v12
    v_dot2_f32_bf16 v12, v34, v34, v12
    v_dot2_f32_bf16 v12, v35, v35, v12
    v_dot2_f32_bf16 v12, v36, v36, v12
    v_dot2_f32_bf16 v12, v37, v37, v12
    v_dot2_f32_bf16 v12, v38, v38, v12
    v_dot2_f32_bf16 v12, v39, v39, v12
    v_lshlrev_b32 v176, 16, v32
    v_and_b32 v177, 0xffff0000, v32
    v_lshlrev_b32 v178, 16, v33
    v_mov_b32 v13, v12
    v_and_b32 v179, 0xffff0000, v33
    v_lshlrev_b32 v180, 16, v34
    v_permlane32_swap_b32 v12, v13
    v_and_b32 v181, 0xffff0000, v34
    v_add_f32 v12, v12, v13
    v_sqrt_f32 v12, v12
    v_lshlrev_b32 v182, 16, v35
    v_add_f32 v12, s61, v12
    v_rcp_f32 v12, v12
    v_and_b32 v183, 0xffff0000, v35
    s_waitcnt lgkmcnt(0)
    s_barrier
    ds_read_b128 a[0:3], v7 offset:0
    ds_read_b128 a[4:7], v8 offset:0
    ds_read_b128 a[8:11], v7 offset:2048
    v_mul_f32 v12, v10, v12
    v_pk_mul_f32 v[176:177], v[176:177], v[12:13] op_sel_hi:[1,0]
    v_cvt_pk_bf16_f32 v32, v176, v177
    v_pk_mul_f32 v[178:179], v[178:179], v[12:13] op_sel_hi:[1,0]
    v_cvt_pk_bf16_f32 v33, v178, v179
    v_pk_mul_f32 v[180:181], v[180:181], v[12:13] op_sel_hi:[1,0]
    v_cvt_pk_bf16_f32 v34, v180, v181
    v_pk_mul_f32 v[182:183], v[182:183], v[12:13] op_sel_hi:[1,0]
    v_cvt_pk_bf16_f32 v35, v182, v183
    v_lshlrev_b32 v176, 16, v36
    v_and_b32 v177, 0xffff0000, v36
    v_pk_mul_f32 v[176:177], v[176:177], v[12:13] op_sel_hi:[1,0]
    v_cvt_pk_bf16_f32 v36, v176, v177
    v_lshlrev_b32 v178, 16, v37
    v_and_b32 v179, 0xffff0000, v37
    v_pk_mul_f32 v[178:179], v[178:179], v[12:13] op_sel_hi:[1,0]
    v_cvt_pk_bf16_f32 v37, v178, v179
    v_lshlrev_b32 v180, 16, v38
    v_and_b32 v181, 0xffff0000, v38
    v_pk_mul_f32 v[180:181], v[180:181], v[12:13] op_sel_hi:[1,0]
    v_cvt_pk_bf16_f32 v38, v180, v181
    v_lshlrev_b32 v182, 16, v39
    v_and_b32 v183, 0xffff0000, v39
    v_pk_mul_f32 v[182:183], v[182:183], v[12:13] op_sel_hi:[1,0]
    v_cvt_pk_bf16_f32 v39, v182, v183
    s_waitcnt lgkmcnt(0)
    s_nop 0
    v_mfma_f32_32x32x16_bf16 v[144:159], a[0:3], v[32:35], 4.0
    ds_read_b128 a[12:15], v8 offset:2048
    ds_read_b128 a[16:19], v7 offset:4096
    ds_read_b128 a[20:23], v8 offset:4096
    v_mfma_f32_32x32x16_bf16 v[144:159], a[4:7], v[36:39], v[144:159]
    ds_read_b128 a[24:27], v7 offset:6144
    ds_read_b128 a[28:31], v8 offset:6144
    s_nop 7
    v_mfma_f32_32x32x16_bf16 v[160:175], a[8:11], v[32:35], 4.0
    s_waitcnt lgkmcnt(4)
    v_exp_f32 v144, v144
    v_exp_f32 v145, v145
    v_exp_f32 v146, v146
    v_mfma_f32_32x32x16_bf16 v[160:175], a[12:15], v[36:39], v[160:175]
    s_waitcnt lgkmcnt(0)
    v_exp_f32 v147, v147
    v_exp_f32 v148, v148
    v_exp_f32 v149, v149
    v_exp_f32 v150, v150
    v_exp_f32 v151, v151
    v_exp_f32 v152, v152
    v_exp_f32 v153, v153
    v_exp_f32 v154, v154
    s_barrier
    ds_read_b64_tr_b16 a[32:33], v3 offset:32768
    ds_read_b64_tr_b16 a[34:35], v3 offset:33024
    ds_read_b64_tr_b16 a[36:37], v3 offset:33792
    ds_read_b64_tr_b16 a[38:39], v3 offset:34048
    ds_read_b64_tr_b16 a[40:41], v3 offset:34816
    ds_read_b64_tr_b16 a[42:43], v3 offset:35072
    v_exp_f32 v155, v155
    v_exp_f32 v156, v156
    v_exp_f32 v157, v157
    v_exp_f32 v158, v158
    v_exp_f32 v159, v159
    v_mfma_f32_32x32x16_bf16 v[176:191], a[16:19], v[32:35], 4.0
    ds_read_b64_tr_b16 a[44:45], v3 offset:35840
    v_exp_f32 v160, v160
    v_exp_f32 v161, v161
    v_exp_f32 v162, v162
    v_mfma_f32_32x32x16_bf16 v[176:191], a[20:23], v[36:39], v[176:191]
    s_waitcnt lgkmcnt(3)
    ds_read_b64_tr_b16 a[46:47], v3 offset:36096
    v_exp_f32 v163, v163
    v_exp_f32 v164, v164
    v_exp_f32 v165, v165
    v_exp_f32 v166, v166
    v_smfmac_f32_32x32x32_bf16 v[64:79], a[32:35], v[144:151], v5
    s_barrier
    v_exp_f32 v167, v167
    v_exp_f32 v168, v168
    v_exp_f32 v169, v169
    v_smfmac_f32_16x16x64_bf16 v[128:131], v[20:23], v[144:151], v5
    ds_read_b128 v[40:43], v1 offset:16384
    v_exp_f32 v170, v170
    v_smfmac_f32_32x32x32_bf16 v[64:79], a[36:39], v[152:159], v5
    ds_read_b64_tr_b16 a[48:49], v3 offset:36864
    v_exp_f32 v171, v171
    v_exp_f32 v172, v172
    v_exp_f32 v173, v173
    v_smfmac_f32_16x16x64_bf16 v[128:131], v[20:23], v[152:159], v5
    ds_read_b128 v[44:47], v6 offset:16384
    v_exp_f32 v174, v174
    v_exp_f32 v175, v175
    v_mfma_f32_32x32x16_bf16 v[144:159], a[24:27], v[32:35], 4.0
    ds_read_b64_tr_b16 a[50:51], v3 offset:37120
    v_exp_f32 v176, v176
    v_exp_f32 v177, v177
    v_exp_f32 v178, v178
    v_mfma_f32_32x32x16_bf16 v[144:159], a[28:31], v[36:39], v[144:159]
    v_exp_f32 v179, v179
    v_exp_f32 v180, v180
    v_exp_f32 v181, v181
    v_exp_f32 v182, v182
    s_waitcnt lgkmcnt(1)
    v_dot2_f32_bf16 v12, v40, v40, 0
    v_dot2_f32_bf16 v12, v41, v41, v12
    v_dot2_f32_bf16 v12, v42, v42, v12
    v_dot2_f32_bf16 v12, v43, v43, v12
    v_dot2_f32_bf16 v12, v44, v44, v12
    v_dot2_f32_bf16 v12, v45, v45, v12
    v_dot2_f32_bf16 v12, v46, v46, v12
    v_dot2_f32_bf16 v12, v47, v47, v12
    v_lshlrev_b32 v24, 16, v40
    v_and_b32 v25, 0xffff0000, v40
    v_lshlrev_b32 v26, 16, v41
    v_mov_b32 v13, v12
    v_and_b32 v27, 0xffff0000, v41
    v_lshlrev_b32 v28, 16, v42
    v_permlane32_swap_b32 v12, v13
    v_and_b32 v29, 0xffff0000, v42
    v_add_f32 v12, v12, v13
    v_sqrt_f32 v12, v12
    v_lshlrev_b32 v30, 16, v43
    v_add_f32 v12, s61, v12
    v_rcp_f32 v12, v12
    v_and_b32 v31, 0xffff0000, v43
    v_mul_f32 v12, v10, v12
    v_pk_mul_f32 v[24:25], v[24:25], v[12:13] op_sel_hi:[1,0]
    v_cvt_pk_bf16_f32 v40, v24, v25
    v_pk_mul_f32 v[26:27], v[26:27], v[12:13] op_sel_hi:[1,0]
    v_cvt_pk_bf16_f32 v41, v26, v27
    v_pk_mul_f32 v[28:29], v[28:29], v[12:13] op_sel_hi:[1,0]
    v_cvt_pk_bf16_f32 v42, v28, v29
    v_pk_mul_f32 v[30:31], v[30:31], v[12:13] op_sel_hi:[1,0]
    v_cvt_pk_bf16_f32 v43, v30, v31
    v_lshlrev_b32 v24, 16, v44
    v_and_b32 v25, 0xffff0000, v44
    v_pk_mul_f32 v[24:25], v[24:25], v[12:13] op_sel_hi:[1,0]
    v_cvt_pk_bf16_f32 v44, v24, v25
    v_lshlrev_b32 v26, 16, v45
    v_and_b32 v27, 0xffff0000, v45
    v_pk_mul_f32 v[26:27], v[26:27], v[12:13] op_sel_hi:[1,0]
    v_cvt_pk_bf16_f32 v45, v26, v27
    v_lshlrev_b32 v28, 16, v46
    v_and_b32 v29, 0xffff0000, v46
    v_pk_mul_f32 v[28:29], v[28:29], v[12:13] op_sel_hi:[1,0]
    v_cvt_pk_bf16_f32 v46, v28, v29
    v_lshlrev_b32 v30, 16, v47
    v_and_b32 v31, 0xffff0000, v47
    v_pk_mul_f32 v[30:31], v[30:31], v[12:13] op_sel_hi:[1,0]
    v_cvt_pk_bf16_f32 v47, v30, v31
    v_smfmac_f32_32x32x32_bf16 v[64:79], a[40:43], v[160:167], v5
    ds_read_b64_tr_b16 a[52:53], v3 offset:37888
    v_exp_f32 v183, v183
    v_exp_f32 v184, v184
    v_exp_f32 v185, v185
    v_smfmac_f32_16x16x64_bf16 v[128:131], v[20:23], v[160:167], v5
    ds_read_b64_tr_b16 a[54:55], v3 offset:38144
    v_exp_f32 v186, v186
    v_smfmac_f32_32x32x32_bf16 v[64:79], a[44:47], v[168:175], v5
    ds_read_b64_tr_b16 a[56:57], v3 offset:38912
    v_exp_f32 v187, v187
    v_exp_f32 v188, v188
    v_exp_f32 v189, v189
    v_smfmac_f32_16x16x64_bf16 v[128:131], v[20:23], v[168:175], v5
    ds_read_b64_tr_b16 a[58:59], v3 offset:39168
    v_exp_f32 v190, v190
    v_exp_f32 v191, v191
    v_mfma_f32_32x32x16_bf16 v[160:175], a[0:3], v[40:43], 4.0
    v_exp_f32 v144, v144
    v_exp_f32 v145, v145
    v_exp_f32 v146, v146
    v_mfma_f32_32x32x16_bf16 v[160:175], a[4:7], v[44:47], v[160:175]
    s_waitcnt lgkmcnt(2)
    v_exp_f32 v147, v147
    v_exp_f32 v148, v148
    v_exp_f32 v149, v149
    v_exp_f32 v150, v150
    v_smfmac_f32_32x32x32_bf16 v[64:79], a[48:51], v[176:183], v5
    v_exp_f32 v151, v151
    v_exp_f32 v152, v152
    v_exp_f32 v153, v153
    v_smfmac_f32_16x16x64_bf16 v[128:131], v[20:23], v[176:183], v5
    ds_read_b64_tr_b16 a[60:61], v3 offset:39936
    v_exp_f32 v154, v154
    v_smfmac_f32_32x32x32_bf16 v[64:79], a[52:55], v[184:191], v5
    v_exp_f32 v155, v155
    v_exp_f32 v156, v156
    v_exp_f32 v157, v157
    v_smfmac_f32_16x16x64_bf16 v[128:131], v[20:23], v[184:191], v5
    ds_read_b64_tr_b16 a[62:63], v3 offset:40192
    v_exp_f32 v158, v158
    v_exp_f32 v159, v159
    v_mfma_f32_32x32x16_bf16 v[176:191], a[8:11], v[40:43], 4.0
    v_exp_f32 v160, v160
    v_exp_f32 v161, v161
    v_exp_f32 v162, v162
    v_mfma_f32_32x32x16_bf16 v[176:191], a[12:15], v[44:47], v[176:191]
    s_waitcnt lgkmcnt(2)
    v_exp_f32 v163, v163
    v_exp_f32 v164, v164
    v_exp_f32 v165, v165
    v_exp_f32 v166, v166
    v_smfmac_f32_32x32x32_bf16 v[64:79], a[56:59], v[144:151], v5
    s_waitcnt lgkmcnt(0)
    v_exp_f32 v167, v167
    v_exp_f32 v168, v168
    v_exp_f32 v169, v169
    v_smfmac_f32_16x16x64_bf16 v[128:131], v[20:23], v[144:151], v5
    v_exp_f32 v170, v170
    v_smfmac_f32_32x32x32_bf16 v[64:79], a[60:63], v[152:159], v5
    v_exp_f32 v171, v171
    v_exp_f32 v172, v172
    v_exp_f32 v173, v173
    v_smfmac_f32_16x16x64_bf16 v[128:131], v[20:23], v[152:159], v5
    v_exp_f32 v174, v174
    v_exp_f32 v175, v175
    v_mfma_f32_32x32x16_bf16 v[144:159], a[16:19], v[40:43], 4.0
    v_exp_f32 v176, v176
    v_exp_f32 v177, v177
    v_exp_f32 v178, v178
    v_mfma_f32_32x32x16_bf16 v[144:159], a[20:23], v[44:47], v[144:159]
    v_exp_f32 v179, v179
    v_exp_f32 v180, v180
    v_exp_f32 v181, v181
    v_exp_f32 v182, v182
    v_smfmac_f32_32x32x32_bf16 v[80:95], a[32:35], v[160:167], v5
    s_barrier
    v_exp_f32 v183, v183
    v_exp_f32 v184, v184
    v_exp_f32 v185, v185
    v_smfmac_f32_16x16x64_bf16 v[132:135], v[20:23], v[160:167], v5
    ds_read_b128 v[48:51], v1 offset:24576
    v_exp_f32 v186, v186
    v_smfmac_f32_32x32x32_bf16 v[80:95], a[36:39], v[168:175], v5
    v_exp_f32 v187, v187
    v_exp_f32 v188, v188
    v_exp_f32 v189, v189
    v_smfmac_f32_16x16x64_bf16 v[132:135], v[20:23], v[168:175], v5
    ds_read_b128 v[52:55], v6 offset:24576
    v_exp_f32 v190, v190
    v_exp_f32 v191, v191
    v_mfma_f32_32x32x16_bf16 v[160:175], a[24:27], v[40:43], 4.0
    v_exp_f32 v144, v144
    v_exp_f32 v145, v145
    v_exp_f32 v146, v146
    v_mfma_f32_32x32x16_bf16 v[160:175], a[28:31], v[44:47], v[160:175]
    v_exp_f32 v147, v147
    v_exp_f32 v148, v148
    v_exp_f32 v149, v149
    v_exp_f32 v150, v150
    s_waitcnt lgkmcnt(0)
    v_dot2_f32_bf16 v12, v48, v48, 0
    v_dot2_f32_bf16 v12, v49, v49, v12
    v_dot2_f32_bf16 v12, v50, v50, v12
    v_dot2_f32_bf16 v12, v51, v51, v12
    v_dot2_f32_bf16 v12, v52, v52, v12
    v_dot2_f32_bf16 v12, v53, v53, v12
    v_dot2_f32_bf16 v12, v54, v54, v12
    v_dot2_f32_bf16 v12, v55, v55, v12
    v_lshlrev_b32 v24, 16, v48
    v_and_b32 v25, 0xffff0000, v48
    v_lshlrev_b32 v26, 16, v49
    v_mov_b32 v13, v12
    v_and_b32 v27, 0xffff0000, v49
    v_lshlrev_b32 v28, 16, v50
    v_permlane32_swap_b32 v12, v13
    v_and_b32 v29, 0xffff0000, v50
    v_add_f32 v12, v12, v13
    v_sqrt_f32 v12, v12
    v_lshlrev_b32 v30, 16, v51
    v_add_f32 v12, s61, v12
    v_rcp_f32 v12, v12
    v_and_b32 v31, 0xffff0000, v51
    v_mul_f32 v12, v10, v12
    v_pk_mul_f32 v[24:25], v[24:25], v[12:13] op_sel_hi:[1,0]
    v_cvt_pk_bf16_f32 v48, v24, v25
    v_pk_mul_f32 v[26:27], v[26:27], v[12:13] op_sel_hi:[1,0]
    v_cvt_pk_bf16_f32 v49, v26, v27
    v_pk_mul_f32 v[28:29], v[28:29], v[12:13] op_sel_hi:[1,0]
    v_cvt_pk_bf16_f32 v50, v28, v29
    v_pk_mul_f32 v[30:31], v[30:31], v[12:13] op_sel_hi:[1,0]
    v_cvt_pk_bf16_f32 v51, v30, v31
    v_lshlrev_b32 v24, 16, v52
    v_and_b32 v25, 0xffff0000, v52
    v_pk_mul_f32 v[24:25], v[24:25], v[12:13] op_sel_hi:[1,0]
    v_cvt_pk_bf16_f32 v52, v24, v25
    v_lshlrev_b32 v26, 16, v53
    v_and_b32 v27, 0xffff0000, v53
    v_pk_mul_f32 v[26:27], v[26:27], v[12:13] op_sel_hi:[1,0]
    v_cvt_pk_bf16_f32 v53, v26, v27
    v_lshlrev_b32 v28, 16, v54
    v_and_b32 v29, 0xffff0000, v54
    v_pk_mul_f32 v[28:29], v[28:29], v[12:13] op_sel_hi:[1,0]
    v_cvt_pk_bf16_f32 v54, v28, v29
    v_lshlrev_b32 v30, 16, v55
    v_and_b32 v31, 0xffff0000, v55
    v_pk_mul_f32 v[30:31], v[30:31], v[12:13] op_sel_hi:[1,0]
    v_cvt_pk_bf16_f32 v55, v30, v31
    v_smfmac_f32_32x32x32_bf16 v[80:95], a[40:43], v[176:183], v5
    v_exp_f32 v151, v151
    v_exp_f32 v152, v152
    v_exp_f32 v153, v153
    v_smfmac_f32_16x16x64_bf16 v[132:135], v[20:23], v[176:183], v5
    v_exp_f32 v154, v154
    v_smfmac_f32_32x32x32_bf16 v[80:95], a[44:47], v[184:191], v5
    v_exp_f32 v155, v155
    v_exp_f32 v156, v156
    v_exp_f32 v157, v157
    v_smfmac_f32_16x16x64_bf16 v[132:135], v[20:23], v[184:191], v5
    v_exp_f32 v158, v158
    v_exp_f32 v159, v159
    v_mfma_f32_32x32x16_bf16 v[176:191], a[0:3], v[48:51], 4.0
    v_exp_f32 v160, v160
    v_exp_f32 v161, v161
    v_exp_f32 v162, v162
    v_mfma_f32_32x32x16_bf16 v[176:191], a[4:7], v[52:55], v[176:191]
    v_exp_f32 v163, v163
    v_exp_f32 v164, v164
    v_exp_f32 v165, v165
    v_exp_f32 v166, v166
    v_smfmac_f32_32x32x32_bf16 v[80:95], a[48:51], v[144:151], v5
    v_exp_f32 v167, v167
    v_exp_f32 v168, v168
    v_exp_f32 v169, v169
    v_smfmac_f32_16x16x64_bf16 v[132:135], v[20:23], v[144:151], v5
    v_exp_f32 v170, v170
    v_smfmac_f32_32x32x32_bf16 v[80:95], a[52:55], v[152:159], v5
    v_exp_f32 v171, v171
    v_exp_f32 v172, v172
    v_exp_f32 v173, v173
    v_smfmac_f32_16x16x64_bf16 v[132:135], v[20:23], v[152:159], v5
    v_exp_f32 v174, v174
    v_exp_f32 v175, v175
    v_mfma_f32_32x32x16_bf16 v[144:159], a[8:11], v[48:51], 4.0
    v_exp_f32 v176, v176
    v_exp_f32 v177, v177
    v_exp_f32 v178, v178
    v_mfma_f32_32x32x16_bf16 v[144:159], a[12:15], v[52:55], v[144:159]
    v_exp_f32 v179, v179
    v_exp_f32 v180, v180
    v_exp_f32 v181, v181
    v_exp_f32 v182, v182
    v_smfmac_f32_32x32x32_bf16 v[80:95], a[56:59], v[160:167], v5
    v_exp_f32 v183, v183
    v_exp_f32 v184, v184
    v_exp_f32 v185, v185
    v_smfmac_f32_16x16x64_bf16 v[132:135], v[20:23], v[160:167], v5
    v_exp_f32 v186, v186
    v_smfmac_f32_32x32x32_bf16 v[80:95], a[60:63], v[168:175], v5
    v_exp_f32 v187, v187
    v_exp_f32 v188, v188
    v_exp_f32 v189, v189
    v_smfmac_f32_16x16x64_bf16 v[132:135], v[20:23], v[168:175], v5
    v_exp_f32 v190, v190
    v_exp_f32 v191, v191
    v_mfma_f32_32x32x16_bf16 v[160:175], a[16:19], v[48:51], 4.0
    v_exp_f32 v144, v144
    v_exp_f32 v145, v145
    v_exp_f32 v146, v146
    v_mfma_f32_32x32x16_bf16 v[160:175], a[20:23], v[52:55], v[160:175]
    v_exp_f32 v147, v147
    v_exp_f32 v148, v148
    v_exp_f32 v149, v149
    v_exp_f32 v150, v150
    v_smfmac_f32_32x32x32_bf16 v[96:111], a[32:35], v[176:183], v5
    s_barrier
    v_exp_f32 v151, v151
    v_exp_f32 v152, v152
    v_exp_f32 v153, v153
    v_smfmac_f32_16x16x64_bf16 v[136:139], v[20:23], v[176:183], v5
    ds_read_b128 v[56:59], v1 offset:49152
    v_exp_f32 v154, v154
    v_smfmac_f32_32x32x32_bf16 v[96:111], a[36:39], v[184:191], v5
    v_exp_f32 v155, v155
    v_exp_f32 v156, v156
    v_exp_f32 v157, v157
    v_smfmac_f32_16x16x64_bf16 v[136:139], v[20:23], v[184:191], v5
    ds_read_b128 v[60:63], v6 offset:49152
    v_exp_f32 v158, v158
    v_exp_f32 v159, v159
    v_mfma_f32_32x32x16_bf16 v[176:191], a[24:27], v[48:51], 4.0
    v_exp_f32 v160, v160
    v_exp_f32 v161, v161
    v_exp_f32 v162, v162
    v_mfma_f32_32x32x16_bf16 v[176:191], a[28:31], v[52:55], v[176:191]
    v_exp_f32 v163, v163
    v_exp_f32 v164, v164
    v_exp_f32 v165, v165
    v_exp_f32 v166, v166
    s_waitcnt lgkmcnt(0)
    v_dot2_f32_bf16 v12, v56, v56, 0
    v_dot2_f32_bf16 v12, v57, v57, v12
    v_dot2_f32_bf16 v12, v58, v58, v12
    v_dot2_f32_bf16 v12, v59, v59, v12
    v_dot2_f32_bf16 v12, v60, v60, v12
    v_dot2_f32_bf16 v12, v61, v61, v12
    v_dot2_f32_bf16 v12, v62, v62, v12
    v_dot2_f32_bf16 v12, v63, v63, v12
    v_lshlrev_b32 v24, 16, v56
    v_and_b32 v25, 0xffff0000, v56
    v_lshlrev_b32 v26, 16, v57
    v_mov_b32 v13, v12
    v_and_b32 v27, 0xffff0000, v57
    v_lshlrev_b32 v28, 16, v58
    v_permlane32_swap_b32 v12, v13
    v_and_b32 v29, 0xffff0000, v58
    v_add_f32 v12, v12, v13
    v_sqrt_f32 v12, v12
    v_lshlrev_b32 v30, 16, v59
    v_add_f32 v12, s61, v12
    v_rcp_f32 v12, v12
    v_and_b32 v31, 0xffff0000, v59
    v_mul_f32 v12, v10, v12
    v_pk_mul_f32 v[24:25], v[24:25], v[12:13] op_sel_hi:[1,0]
    v_cvt_pk_bf16_f32 v56, v24, v25
    v_pk_mul_f32 v[26:27], v[26:27], v[12:13] op_sel_hi:[1,0]
    v_cvt_pk_bf16_f32 v57, v26, v27
    v_pk_mul_f32 v[28:29], v[28:29], v[12:13] op_sel_hi:[1,0]
    v_cvt_pk_bf16_f32 v58, v28, v29
    v_pk_mul_f32 v[30:31], v[30:31], v[12:13] op_sel_hi:[1,0]
    v_cvt_pk_bf16_f32 v59, v30, v31
    v_lshlrev_b32 v24, 16, v60
    v_and_b32 v25, 0xffff0000, v60
    v_pk_mul_f32 v[24:25], v[24:25], v[12:13] op_sel_hi:[1,0]
    v_cvt_pk_bf16_f32 v60, v24, v25
    v_lshlrev_b32 v26, 16, v61
    v_and_b32 v27, 0xffff0000, v61
    v_pk_mul_f32 v[26:27], v[26:27], v[12:13] op_sel_hi:[1,0]
    v_cvt_pk_bf16_f32 v61, v26, v27
    v_lshlrev_b32 v28, 16, v62
    v_and_b32 v29, 0xffff0000, v62
    v_pk_mul_f32 v[28:29], v[28:29], v[12:13] op_sel_hi:[1,0]
    v_cvt_pk_bf16_f32 v62, v28, v29
    v_lshlrev_b32 v30, 16, v63
    v_and_b32 v31, 0xffff0000, v63
    v_pk_mul_f32 v[30:31], v[30:31], v[12:13] op_sel_hi:[1,0]
    v_cvt_pk_bf16_f32 v63, v30, v31
    v_smfmac_f32_32x32x32_bf16 v[96:111], a[40:43], v[144:151], v5
    v_exp_f32 v167, v167
    v_exp_f32 v168, v168
    v_exp_f32 v169, v169
    v_smfmac_f32_16x16x64_bf16 v[136:139], v[20:23], v[144:151], v5
    v_exp_f32 v170, v170
    v_smfmac_f32_32x32x32_bf16 v[96:111], a[44:47], v[152:159], v5
    v_exp_f32 v171, v171
    v_exp_f32 v172, v172
    v_exp_f32 v173, v173
    v_smfmac_f32_16x16x64_bf16 v[136:139], v[20:23], v[152:159], v5
    v_exp_f32 v174, v174
    v_exp_f32 v175, v175
    v_mfma_f32_32x32x16_bf16 v[144:159], a[0:3], v[56:59], 4.0
    v_exp_f32 v176, v176
    v_exp_f32 v177, v177
    v_exp_f32 v178, v178
    v_mfma_f32_32x32x16_bf16 v[144:159], a[4:7], v[60:63], v[144:159]
    v_exp_f32 v179, v179
    v_exp_f32 v180, v180
    v_exp_f32 v181, v181
    v_exp_f32 v182, v182
    v_smfmac_f32_32x32x32_bf16 v[96:111], a[48:51], v[160:167], v5
    s_barrier
    v_exp_f32 v183, v183
    v_exp_f32 v184, v184
    v_exp_f32 v185, v185
    v_smfmac_f32_16x16x64_bf16 v[136:139], v[20:23], v[160:167], v5
    ds_read_b128 v[24:27], v4 offset:8192
    v_exp_f32 v186, v186
    v_smfmac_f32_32x32x32_bf16 v[96:111], a[52:55], v[168:175], v5
    v_exp_f32 v187, v187
    v_exp_f32 v188, v188
    v_exp_f32 v189, v189
    v_smfmac_f32_16x16x64_bf16 v[136:139], v[20:23], v[168:175], v5
    ds_read_b128 v[28:31], v4 offset:9216
    v_exp_f32 v190, v190
    v_exp_f32 v191, v191
    v_mfma_f32_32x32x16_bf16 v[160:175], a[8:11], v[56:59], 4.0
    v_exp_f32 v144, v144
    v_exp_f32 v145, v145
    v_exp_f32 v146, v146
    v_mfma_f32_32x32x16_bf16 v[160:175], a[12:15], v[60:63], v[160:175]
    v_exp_f32 v147, v147
    v_exp_f32 v148, v148
    v_exp_f32 v149, v149
    v_exp_f32 v150, v150
    s_waitcnt lgkmcnt(0)
    v_dot2_f32_bf16 v12, v24, v24, 0
    v_dot2_f32_bf16 v12, v25, v25, v12
    v_dot2_f32_bf16 v12, v26, v26, v12
    v_dot2_f32_bf16 v12, v27, v27, v12
    v_dot2_f32_bf16 v12, v28, v28, v12
    v_dot2_f32_bf16 v12, v29, v29, v12
    v_dot2_f32_bf16 v12, v30, v30, v12
    v_dot2_f32_bf16 v12, v31, v31, v12
    v_lshlrev_b32 v14, 16, v24
    v_and_b32 v15, 0xffff0000, v24
    v_lshlrev_b32 v16, 16, v25
    v_add_f32_dpp v12, v12, v12 quad_perm:[1,0,3,2] row_mask:0xf bank_mask:0xf
    v_sqrt_f32 v12, v12
    v_and_b32 v17, 0xffff0000, v25
    v_add_f32 v12, s61, v12
    v_rcp_f32 v12, v12
    v_lshlrev_b32 v18, 16, v26
    v_pk_mul_f32 v[14:15], v[14:15], v[12:13] op_sel_hi:[1,0]
    v_cvt_pk_bf16_f32 v24, v14, v15
    v_pk_mul_f32 v[16:17], v[16:17], v[12:13] op_sel_hi:[1,0]
    v_cvt_pk_bf16_f32 v25, v16, v17
    v_and_b32 v19, 0xffff0000, v26
    v_pk_mul_f32 v[18:19], v[18:19], v[12:13] op_sel_hi:[1,0]
    v_cvt_pk_bf16_f32 v26, v18, v19
    v_lshlrev_b32 v14, 16, v27
    v_and_b32 v15, 0xffff0000, v27
    v_pk_mul_f32 v[14:15], v[14:15], v[12:13] op_sel_hi:[1,0]
    v_cvt_pk_bf16_f32 v27, v14, v15
    v_lshlrev_b32 v16, 16, v28
    v_and_b32 v17, 0xffff0000, v28
    v_pk_mul_f32 v[16:17], v[16:17], v[12:13] op_sel_hi:[1,0]
    v_cvt_pk_bf16_f32 v28, v16, v17
    v_lshlrev_b32 v18, 16, v29
    v_and_b32 v19, 0xffff0000, v29
    v_pk_mul_f32 v[18:19], v[18:19], v[12:13] op_sel_hi:[1,0]
    v_cvt_pk_bf16_f32 v29, v18, v19
    v_lshlrev_b32 v14, 16, v30
    v_and_b32 v15, 0xffff0000, v30
    v_pk_mul_f32 v[14:15], v[14:15], v[12:13] op_sel_hi:[1,0]
    v_cvt_pk_bf16_f32 v30, v14, v15
    v_lshlrev_b32 v16, 16, v31
    v_and_b32 v17, 0xffff0000, v31
    v_pk_mul_f32 v[16:17], v[16:17], v[12:13] op_sel_hi:[1,0]
    v_cvt_pk_bf16_f32 v31, v16, v17
    v_smfmac_f32_32x32x32_bf16 v[96:111], a[56:59], v[176:183], v5
    v_exp_f32 v151, v151
    v_exp_f32 v152, v152
    v_exp_f32 v153, v153
    v_smfmac_f32_16x16x64_bf16 v[136:139], v[20:23], v[176:183], v5
    ds_write_b128 v4, v[24:27] offset:8192
    v_exp_f32 v154, v154
    v_smfmac_f32_32x32x32_bf16 v[96:111], a[60:63], v[184:191], v5
    v_exp_f32 v155, v155
    v_exp_f32 v156, v156
    v_exp_f32 v157, v157
    v_smfmac_f32_16x16x64_bf16 v[136:139], v[20:23], v[184:191], v5
    ds_write_b128 v4, v[28:31] offset:9216
    v_exp_f32 v158, v158
    v_exp_f32 v159, v159
    v_mfma_f32_32x32x16_bf16 v[176:191], a[16:19], v[56:59], 4.0
L_pad1:
    s_cbranch_vccnz L_hop1
    v_exp_f32 v160, v160
    v_exp_f32 v161, v161
    v_exp_f32 v162, v162
    v_mfma_f32_32x32x16_bf16 v[176:191], a[20:23], v[60:63], v[176:191]
    s_waitcnt lgkmcnt(2)
    v_exp_f32 v163, v163
    v_exp_f32 v164, v164
    v_exp_f32 v165, v165
    v_exp_f32 v166, v166
    v_smfmac_f32_32x32x32_bf16 v[112:127], a[32:35], v[144:151], v5
    s_waitcnt lgkmcnt(0)
    s_barrier
    v_exp_f32 v167, v167
    v_exp_f32 v168, v168
    v_exp_f32 v169, v169
    v_smfmac_f32_16x16x64_bf16 v[140:143], v[20:23], v[144:151], v5
    ds_read_b128 a[0:3], v7 offset:8192
    v_exp_f32 v170, v170
    v_smfmac_f32_32x32x32_bf16 v[112:127], a[36:39], v[152:159], v5
    v_exp_f32 v171, v171
    v_exp_f32 v172, v172
    v_exp_f32 v173, v173
    v_smfmac_f32_16x16x64_bf16 v[140:143], v[20:23], v[152:159], v5
    ds_read_b128 a[4:7], v8 offset:8192
    v_exp_f32 v174, v174
    v_exp_f32 v175, v175
    v_mfma_f32_32x32x16_bf16 v[144:159], a[24:27], v[56:59], 4.0
    v_exp_f32 v176, v176
    v_exp_f32 v177, v177
    v_exp_f32 v178, v178
    v_mfma_f32_32x32x16_bf16 v[144:159], a[28:31], v[60:63], v[144:159]
    v_exp_f32 v179, v179
    v_exp_f32 v180, v180
    v_exp_f32 v181, v181
    v_exp_f32 v182, v182
    v_smfmac_f32_32x32x32_bf16 v[112:127], a[40:43], v[160:167], v5
    v_exp_f32 v183, v183
    v_exp_f32 v184, v184
    v_exp_f32 v185, v185
    v_smfmac_f32_16x16x64_bf16 v[140:143], v[20:23], v[160:167], v5
    ds_read_b64_tr_b16 a[32:33], v3 offset:40960
    v_exp_f32 v186, v186
    v_smfmac_f32_32x32x32_bf16 v[112:127], a[44:47], v[168:175], v5
    s_waitcnt lgkmcnt(1)
    v_exp_f32 v187, v187
    v_exp_f32 v188, v188
    v_exp_f32 v189, v189
    v_smfmac_f32_16x16x64_bf16 v[140:143], v[20:23], v[168:175], v5
    ds_read_b64_tr_b16 a[34:35], v3 offset:41216
    v_exp_f32 v190, v190
    v_exp_f32 v191, v191
    v_mfma_f32_32x32x16_bf16 v[160:175], a[0:3], v[32:35], 4.0
    v_exp_f32 v144, v144
    v_exp_f32 v145, v145
    v_exp_f32 v146, v146
    v_mfma_f32_32x32x16_bf16 v[160:175], a[4:7], v[36:39], v[160:175]
    v_exp_f32 v147, v147
    v_exp_f32 v148, v148
    v_exp_f32 v149, v149
    v_exp_f32 v150, v150
    v_smfmac_f32_32x32x32_bf16 v[112:127], a[48:51], v[176:183], v5
    v_exp_f32 v151, v151
    v_exp_f32 v152, v152
    v_exp_f32 v153, v153
    v_smfmac_f32_16x16x64_bf16 v[140:143], v[20:23], v[176:183], v5
    ds_read_b64_tr_b16 a[36:37], v3 offset:41984
    v_exp_f32 v154, v154
    v_smfmac_f32_32x32x32_bf16 v[112:127], a[52:55], v[184:191], v5
    v_exp_f32 v155, v155
    v_exp_f32 v156, v156
    v_exp_f32 v157, v157
    v_smfmac_f32_16x16x64_bf16 v[140:143], v[20:23], v[184:191], v5
    ds_read_b64_tr_b16 a[38:39], v3 offset:42240
    v_exp_f32 v158, v158
    v_exp_f32 v159, v159
    v_mfma_f32_32x32x16_bf16 v[176:191], a[0:3], v[40:43], 4.0
    v_exp_f32 v160, v160
    v_exp_f32 v161, v161
    v_exp_f32 v162, v162
    v_mfma_f32_32x32x16_bf16 v[176:191], a[4:7], v[44:47], v[176:191]
    v_exp_f32 v163, v163
    v_exp_f32 v164, v164
    v_exp_f32 v165, v165
    v_exp_f32 v166, v166
    v_smfmac_f32_32x32x32_bf16 v[112:127], a[56:59], v[144:151], v5
    v_exp_f32 v167, v167
    v_exp_f32 v168, v168
    v_exp_f32 v169, v169
    v_smfmac_f32_16x16x64_bf16 v[140:143], v[20:23], v[144:151], v5
    v_exp_f32 v170, v170
    v_smfmac_f32_32x32x32_bf16 v[112:127], a[60:63], v[152:159], v5
    v_exp_f32 v171, v171
    v_exp_f32 v172, v172
    v_exp_f32 v173, v173
    v_smfmac_f32_16x16x64_bf16 v[140:143], v[20:23], v[152:159], v5
    v_exp_f32 v174, v174
    v_exp_f32 v175, v175
    v_mfma_f32_32x32x16_bf16 v[144:159], a[0:3], v[48:51], 4.0
    s_add_u32 s34, s34, 8192
    v_exp_f32 v176, v176
    v_exp_f32 v177, v177
    v_exp_f32 v178, v178
    v_mfma_f32_32x32x16_bf16 v[144:159], a[4:7], v[52:55], v[144:159]
    s_waitcnt lgkmcnt(0)
    v_exp_f32 v179, v179
    v_exp_f32 v180, v180
    v_exp_f32 v181, v181
    v_exp_f32 v182, v182
    v_smfmac_f32_32x32x32_bf16 v[64:79], a[32:35], v[160:167], v5
    v_exp_f32 v183, v183
    v_exp_f32 v184, v184
    v_exp_f32 v185, v185
    v_smfmac_f32_16x16x64_bf16 v[128:131], v[20:23], v[160:167], v5
    ds_read_b128 a[8:11], v7 offset:10240
    v_exp_f32 v186, v186
    v_smfmac_f32_32x32x32_bf16 v[64:79], a[36:39], v[168:175], v5
    v_exp_f32 v187, v187
    v_exp_f32 v188, v188
    v_exp_f32 v189, v189
    v_smfmac_f32_16x16x64_bf16 v[128:131], v[20:23], v[168:175], v5
    ds_read_b128 a[12:15], v8 offset:10240
    v_exp_f32 v190, v190
    v_exp_f32 v191, v191
    v_mfma_f32_32x32x16_bf16 v[160:175], a[0:3], v[56:59], 4.0
    s_and_b32 s34, s34, 0x1ffff
    v_exp_f32 v144, v144
    v_exp_f32 v145, v145
    v_exp_f32 v146, v146
    v_mfma_f32_32x32x16_bf16 v[160:175], a[4:7], v[60:63], v[160:175]
    v_exp_f32 v147, v147
    v_exp_f32 v148, v148
    v_exp_f32 v149, v149
    v_exp_f32 v150, v150
    v_smfmac_f32_32x32x32_bf16 v[80:95], a[32:35], v[176:183], v5
    v_exp_f32 v151, v151
    v_exp_f32 v152, v152
    v_exp_f32 v153, v153
    v_smfmac_f32_16x16x64_bf16 v[132:135], v[20:23], v[176:183], v5
    ds_read_b64_tr_b16 a[40:41], v3 offset:43008
    v_exp_f32 v154, v154
    v_smfmac_f32_32x32x32_bf16 v[80:95], a[36:39], v[184:191], v5
    s_waitcnt lgkmcnt(1)
    v_exp_f32 v155, v155
    v_exp_f32 v156, v156
    v_exp_f32 v157, v157
    v_smfmac_f32_16x16x64_bf16 v[132:135], v[20:23], v[184:191], v5
    ds_read_b64_tr_b16 a[42:43], v3 offset:43264
    v_exp_f32 v158, v158
    v_exp_f32 v159, v159
    v_mfma_f32_32x32x16_bf16 v[176:191], a[8:11], v[32:35], 4.0
    v_exp_f32 v160, v160
    v_exp_f32 v161, v161
    v_exp_f32 v162, v162
    v_mfma_f32_32x32x16_bf16 v[176:191], a[12:15], v[36:39], v[176:191]
    v_exp_f32 v163, v163
    v_exp_f32 v164, v164
    v_exp_f32 v165, v165
    v_exp_f32 v166, v166
    v_smfmac_f32_32x32x32_bf16 v[96:111], a[32:35], v[144:151], v5
    s_cmp_eq_u32 s34, s58
    s_cselect_b32 s34, s3, s34
    v_exp_f32 v167, v167
    v_exp_f32 v168, v168
    v_exp_f32 v169, v169
    v_smfmac_f32_16x16x64_bf16 v[136:139], v[20:23], v[144:151], v5
    ds_read_b64_tr_b16 a[44:45], v3 offset:44032
    v_exp_f32 v170, v170
    v_smfmac_f32_32x32x32_bf16 v[96:111], a[36:39], v[152:159], v5
    v_exp_f32 v171, v171
    v_exp_f32 v172, v172
    v_exp_f32 v173, v173
    v_smfmac_f32_16x16x64_bf16 v[136:139], v[20:23], v[152:159], v5
    ds_read_b64_tr_b16 a[46:47], v3 offset:44288
    v_exp_f32 v174, v174
    v_exp_f32 v175, v175
    v_mfma_f32_32x32x16_bf16 v[144:159], a[8:11], v[40:43], 4.0
    v_exp_f32 v176, v176
    v_exp_f32 v177, v177
    v_exp_f32 v178, v178
    v_mfma_f32_32x32x16_bf16 v[144:159], a[12:15], v[44:47], v[144:159]
    v_exp_f32 v179, v179
    v_exp_f32 v180, v180
    v_exp_f32 v181, v181
    v_exp_f32 v182, v182
    v_smfmac_f32_32x32x32_bf16 v[112:127], a[32:35], v[160:167], v5
    v_exp_f32 v183, v183
    v_exp_f32 v184, v184
    v_exp_f32 v185, v185
    v_smfmac_f32_16x16x64_bf16 v[140:143], v[20:23], v[160:167], v5
    buffer_store_dwordx4 v[24:27], v4, s[20:23], s34 offen sc1
    v_exp_f32 v186, v186
    v_smfmac_f32_32x32x32_bf16 v[112:127], a[36:39], v[168:175], v5
    v_exp_f32 v187, v187
    v_exp_f32 v188, v188
    v_exp_f32 v189, v189
    v_smfmac_f32_16x16x64_bf16 v[140:143], v[20:23], v[168:175], v5
    buffer_store_dwordx4 v[28:31], v4, s[20:23], s34 offen offset:1024 sc1
    v_exp_f32 v190, v190
    v_exp_f32 v191, v191
    v_mfma_f32_32x32x16_bf16 v[160:175], a[8:11], v[48:51], 4.0
    v_exp_f32 v144, v144
    v_exp_f32 v145, v145
    v_exp_f32 v146, v146
    v_mfma_f32_32x32x16_bf16 v[160:175], a[12:15], v[52:55], v[160:175]
    s_waitcnt lgkmcnt(0)
    v_exp_f32 v147, v147
    v_exp_f32 v148, v148
    v_exp_f32 v149, v149
    v_exp_f32 v150, v150
    v_smfmac_f32_32x32x32_bf16 v[64:79], a[40:43], v[176:183], v5
    v_exp_f32 v151, v151
    v_exp_f32 v152, v152
    v_exp_f32 v153, v153
    v_smfmac_f32_16x16x64_bf16 v[128:131], v[20:23], v[176:183], v5
    ds_read_b128 a[0:3], v7 offset:12288
    v_exp_f32 v154, v154
    v_smfmac_f32_32x32x32_bf16 v[64:79], a[44:47], v[184:191], v5
    v_exp_f32 v155, v155
    v_exp_f32 v156, v156
    v_exp_f32 v157, v157
    v_smfmac_f32_16x16x64_bf16 v[128:131], v[20:23], v[184:191], v5
    ds_read_b128 a[4:7], v8 offset:12288
    v_exp_f32 v158, v158
    v_exp_f32 v159, v159
    v_mfma_f32_32x32x16_bf16 v[176:191], a[8:11], v[56:59], 4.0
    v_exp_f32 v160, v160
    v_exp_f32 v161, v161
    v_exp_f32 v162, v162
    v_mfma_f32_32x32x16_bf16 v[176:191], a[12:15], v[60:63], v[176:191]
    v_exp_f32 v163, v163
    v_exp_f32 v164, v164
    v_exp_f32 v165, v165
    v_exp_f32 v166, v166
    v_smfmac_f32_32x32x32_bf16 v[80:95], a[40:43], v[144:151], v5
    v_exp_f32 v167, v167
    v_exp_f32 v168, v168
    v_exp_f32 v169, v169
    v_smfmac_f32_16x16x64_bf16 v[132:135], v[20:23], v[144:151], v5
    ds_read_b64_tr_b16 a[32:33], v3 offset:45056
    v_exp_f32 v170, v170
    v_smfmac_f32_32x32x32_bf16 v[80:95], a[44:47], v[152:159], v5
    s_waitcnt lgkmcnt(1)
    v_exp_f32 v171, v171
    v_exp_f32 v172, v172
    v_exp_f32 v173, v173
    v_smfmac_f32_16x16x64_bf16 v[132:135], v[20:23], v[152:159], v5
    ds_read_b64_tr_b16 a[34:35], v3 offset:45312
    v_exp_f32 v174, v174
    v_exp_f32 v175, v175
    v_mfma_f32_32x32x16_bf16 v[144:159], a[0:3], v[32:35], 4.0
    v_exp_f32 v176, v176
    v_exp_f32 v177, v177
    v_exp_f32 v178, v178
    v_mfma_f32_32x32x16_bf16 v[144:159], a[4:7], v[36:39], v[144:159]
    v_exp_f32 v179, v179
    v_exp_f32 v180, v180
    v_exp_f32 v181, v181
    v_exp_f32 v182, v182
    v_smfmac_f32_32x32x32_bf16 v[96:111], a[40:43], v[160:167], v5
    v_exp_f32 v183, v183
    v_exp_f32 v184, v184
    v_exp_f32 v185, v185
    v_smfmac_f32_16x16x64_bf16 v[136:139], v[20:23], v[160:167], v5
    ds_read_b64_tr_b16 a[36:37], v3 offset:46080
    v_exp_f32 v186, v186
    v_smfmac_f32_32x32x32_bf16 v[96:111], a[44:47], v[168:175], v5
    v_exp_f32 v187, v187
    v_exp_f32 v188, v188
    v_exp_f32 v189, v189
    v_smfmac_f32_16x16x64_bf16 v[136:139], v[20:23], v[168:175], v5
    ds_read_b64_tr_b16 a[38:39], v3 offset:46336
    v_exp_f32 v190, v190
    v_exp_f32 v191, v191
    v_mfma_f32_32x32x16_bf16 v[160:175], a[0:3], v[40:43], 4.0
    v_exp_f32 v144, v144
    v_exp_f32 v145, v145
    v_exp_f32 v146, v146
    v_mfma_f32_32x32x16_bf16 v[160:175], a[4:7], v[44:47], v[160:175]
    v_exp_f32 v147, v147
    v_exp_f32 v148, v148
    v_exp_f32 v149, v149
    v_exp_f32 v150, v150
    v_smfmac_f32_32x32x32_bf16 v[112:127], a[40:43], v[176:183], v5
    s_barrier
    v_exp_f32 v151, v151
    v_exp_f32 v152, v152
    v_exp_f32 v153, v153
    v_smfmac_f32_16x16x64_bf16 v[140:143], v[20:23], v[176:183], v5
    ds_read_b128 v[24:27], v4 offset:16384
    v_exp_f32 v154, v154
    v_smfmac_f32_32x32x32_bf16 v[112:127], a[44:47], v[184:191], v5
    v_exp_f32 v155, v155
    v_exp_f32 v156, v156
    v_exp_f32 v157, v157
    v_smfmac_f32_16x16x64_bf16 v[140:143], v[20:23], v[184:191], v5
    ds_read_b128 v[28:31], v4 offset:17408
    v_exp_f32 v158, v158
    v_exp_f32 v159, v159
    v_mfma_f32_32x32x16_bf16 v[176:191], a[0:3], v[48:51], 4.0
    v_exp_f32 v160, v160
    v_exp_f32 v161, v161
    v_exp_f32 v162, v162
    v_mfma_f32_32x32x16_bf16 v[176:191], a[4:7], v[52:55], v[176:191]
    s_waitcnt lgkmcnt(2)
    v_exp_f32 v163, v163
    v_exp_f32 v164, v164
    v_exp_f32 v165, v165
    v_exp_f32 v166, v166
    v_smfmac_f32_32x32x32_bf16 v[64:79], a[32:35], v[144:151], v5
    v_exp_f32 v167, v167
    v_exp_f32 v168, v168
    v_exp_f32 v169, v169
    v_smfmac_f32_16x16x64_bf16 v[128:131], v[20:23], v[144:151], v5
    ds_read_b128 a[8:11], v7 offset:14336
    v_exp_f32 v170, v170
    v_smfmac_f32_32x32x32_bf16 v[64:79], a[36:39], v[152:159], v5
    v_exp_f32 v171, v171
    v_exp_f32 v172, v172
    v_exp_f32 v173, v173
    v_smfmac_f32_16x16x64_bf16 v[128:131], v[20:23], v[152:159], v5
    ds_read_b128 a[12:15], v8 offset:14336
    v_exp_f32 v174, v174
    v_exp_f32 v175, v175
    v_mfma_f32_32x32x16_bf16 v[144:159], a[0:3], v[56:59], 4.0
    v_exp_f32 v176, v176
    v_exp_f32 v177, v177
    v_exp_f32 v178, v178
    v_mfma_f32_32x32x16_bf16 v[144:159], a[4:7], v[60:63], v[144:159]
    v_exp_f32 v179, v179
    v_exp_f32 v180, v180
    v_exp_f32 v181, v181
    v_exp_f32 v182, v182
    v_smfmac_f32_32x32x32_bf16 v[80:95], a[32:35], v[160:167], v5
    v_exp_f32 v183, v183
    v_exp_f32 v184, v184
    v_exp_f32 v185, v185
    v_smfmac_f32_16x16x64_bf16 v[132:135], v[20:23], v[160:167], v5
    ds_read_b64_tr_b16 a[40:41], v3 offset:47104
    v_exp_f32 v186, v186
    v_smfmac_f32_32x32x32_bf16 v[80:95], a[36:39], v[168:175], v5
    s_waitcnt lgkmcnt(1)
    v_exp_f32 v187, v187
    v_exp_f32 v188, v188
    v_exp_f32 v189, v189
    v_smfmac_f32_16x16x64_bf16 v[132:135], v[20:23], v[168:175], v5
    ds_read_b64_tr_b16 a[42:43], v3 offset:47360
    v_exp_f32 v190, v190
    v_exp_f32 v191, v191
    v_mfma_f32_32x32x16_bf16 v[160:175], a[8:11], v[32:35], 4.0
    v_exp_f32 v144, v144
    v_exp_f32 v145, v145
    v_exp_f32 v146, v146
    v_mfma_f32_32x32x16_bf16 v[160:175], a[12:15], v[36:39], v[160:175]
    v_exp_f32 v147, v147
    v_exp_f32 v148, v148
    v_exp_f32 v149, v149
    v_exp_f32 v150, v150
    v_dot2_f32_bf16 v12, v24, v24, 0
    v_dot2_f32_bf16 v12, v25, v25, v12
    v_dot2_f32_bf16 v12, v26, v26, v12
    v_dot2_f32_bf16 v12, v27, v27, v12
    v_dot2_f32_bf16 v12, v28, v28, v12
    v_dot2_f32_bf16 v12, v29, v29, v12
    v_dot2_f32_bf16 v12, v30, v30, v12
    v_dot2_f32_bf16 v12, v31, v31, v12
    v_lshlrev_b32 v14, 16, v24
    v_and_b32 v15, 0xffff0000, v24
    v_lshlrev_b32 v16, 16, v25
    v_add_f32_dpp v12, v12, v12 quad_perm:[1,0,3,2] row_mask:0xf bank_mask:0xf
    v_sqrt_f32 v12, v12
    v_and_b32 v17, 0xffff0000, v25
    v_add_f32 v12, s61, v12
    v_rcp_f32 v12, v12
    v_lshlrev_b32 v18, 16, v26
    v_pk_mul_f32 v[14:15], v[14:15], v[12:13] op_sel_hi:[1,0]
    v_cvt_pk_bf16_f32 v24, v14, v15
    v_pk_mul_f32 v[16:17], v[16:17], v[12:13] op_sel_hi:[1,0]
    v_cvt_pk_bf16_f32 v25, v16, v17
    v_and_b32 v19, 0xffff0000, v26
    v_pk_mul_f32 v[18:19], v[18:19], v[12:13] op_sel_hi:[1,0]
    v_cvt_pk_bf16_f32 v26, v18, v19
    v_lshlrev_b32 v14, 16, v27
    v_and_b32 v15, 0xffff0000, v27
    v_pk_mul_f32 v[14:15], v[14:15], v[12:13] op_sel_hi:[1,0]
    v_cvt_pk_bf16_f32 v27, v14, v15
    v_lshlrev_b32 v16, 16, v28
    v_and_b32 v17, 0xffff0000, v28
    v_pk_mul_f32 v[16:17], v[16:17], v[12:13] op_sel_hi:[1,0]
    v_cvt_pk_bf16_f32 v28, v16, v17
    v_lshlrev_b32 v18, 16, v29
    v_and_b32 v19, 0xffff0000, v29
    v_pk_mul_f32 v[18:19], v[18:19], v[12:13] op_sel_hi:[1,0]
    v_cvt_pk_bf16_f32 v29, v18, v19
    v_lshlrev_b32 v14, 16, v30
    v_and_b32 v15, 0xffff0000, v30
    v_pk_mul_f32 v[14:15], v[14:15], v[12:13] op_sel_hi:[1,0]
    v_cvt_pk_bf16_f32 v30, v14, v15
    v_lshlrev_b32 v16, 16, v31
    v_and_b32 v17, 0xffff0000, v31
    v_pk_mul_f32 v[16:17], v[16:17], v[12:13] op_sel_hi:[1,0]
    v_cvt_pk_bf16_f32 v31, v16, v17
    v_smfmac_f32_32x32x32_bf16 v[96:111], a[32:35], v[176:183], v5
    v_exp_f32 v151, v151
    v_exp_f32 v152, v152
    v_exp_f32 v153, v153
    v_smfmac_f32_16x16x64_bf16 v[136:139], v[20:23], v[176:183], v5
    ds_read_b64_tr_b16 a[44:45], v3 offset:48128
    v_exp_f32 v154, v154
    v_smfmac_f32_32x32x32_bf16 v[96:111], a[36:39], v[184:191], v5
    v_exp_f32 v155, v155
    v_exp_f32 v156, v156
    v_exp_f32 v157, v157
    v_smfmac_f32_16x16x64_bf16 v[136:139], v[20:23], v[184:191], v5
    ds_read_b64_tr_b16 a[46:47], v3 offset:48384
    v_exp_f32 v158, v158
    v_exp_f32 v159, v159
    v_mfma_f32_32x32x16_bf16 v[176:191], a[8:11], v[40:43], 4.0
    v_exp_f32 v160, v160
    v_exp_f32 v161, v161
    v_exp_f32 v162, v162
    v_mfma_f32_32x32x16_bf16 v[176:191], a[12:15], v[44:47], v[176:191]
    v_exp_f32 v163, v163
    v_exp_f32 v164, v164
    v_exp_f32 v165, v165
    v_exp_f32 v166, v166
    v_smfmac_f32_32x32x32_bf16 v[112:127], a[32:35], v[144:151], v5
    v_exp_f32 v167, v167
    v_exp_f32 v168, v168
    v_exp_f32 v169, v169
    v_smfmac_f32_16x16x64_bf16 v[140:143], v[20:23], v[144:151], v5
    ds_write_b128 v4, v[24:27] offset:16384
    v_exp_f32 v170, v170
    v_smfmac_f32_32x32x32_bf16 v[112:127], a[36:39], v[152:159], v5
    v_exp_f32 v171, v171
    v_exp_f32 v172, v172
    v_exp_f32 v173, v173
    v_smfmac_f32_16x16x64_bf16 v[140:143], v[20:23], v[152:159], v5
    ds_write_b128 v4, v[28:31] offset:17408
    v_exp_f32 v174, v174
    v_exp_f32 v175, v175
    v_mfma_f32_32x32x16_bf16 v[144:159], a[8:11], v[48:51], 4.0
    s_add_u32 s34, s34, 8192
    v_exp_f32 v176, v176
    v_exp_f32 v177, v177
    v_exp_f32 v178, v178
    v_mfma_f32_32x32x16_bf16 v[144:159], a[12:15], v[52:55], v[144:159]
    s_waitcnt lgkmcnt(2)
    v_exp_f32 v179, v179
    v_exp_f32 v180, v180
    v_exp_f32 v181, v181
    v_exp_f32 v182, v182
    v_smfmac_f32_32x32x32_bf16 v[64:79], a[40:43], v[160:167], v5
    s_waitcnt lgkmcnt(0)
    s_barrier
    v_exp_f32 v183, v183
    v_exp_f32 v184, v184
    v_exp_f32 v185, v185
    v_smfmac_f32_16x16x64_bf16 v[128:131], v[20:23], v[160:167], v5
    ds_read_b128 a[0:3], v7 offset:16384
    v_exp_f32 v186, v186
    v_smfmac_f32_32x32x32_bf16 v[64:79], a[44:47], v[168:175], v5
    v_exp_f32 v187, v187
    v_exp_f32 v188, v188
    v_exp_f32 v189, v189
    v_smfmac_f32_16x16x64_bf16 v[128:131], v[20:23], v[168:175], v5
    ds_read_b128 a[4:7], v8 offset:16384
    v_exp_f32 v190, v190
    v_exp_f32 v191, v191
    v_mfma_f32_32x32x16_bf16 v[160:175], a[8:11], v[56:59], 4.0
    s_and_b32 s34, s34, 0x1ffff
    v_exp_f32 v144, v144
    v_exp_f32 v145, v145
    v_exp_f32 v146, v146
    v_mfma_f32_32x32x16_bf16 v[160:175], a[12:15], v[60:63], v[160:175]
    v_exp_f32 v147, v147
    v_exp_f32 v148, v148
    v_exp_f32 v149, v149
    v_exp_f32 v150, v150
    v_smfmac_f32_32x32x32_bf16 v[80:95], a[40:43], v[176:183], v5
    v_exp_f32 v151, v151
    v_exp_f32 v152, v152
    v_exp_f32 v153, v153
    v_smfmac_f32_16x16x64_bf16 v[132:135], v[20:23], v[176:183], v5
    ds_read_b64_tr_b16 a[32:33], v3 offset:49152
    v_exp_f32 v154, v154
    v_smfmac_f32_32x32x32_bf16 v[80:95], a[44:47], v[184:191], v5
    s_waitcnt lgkmcnt(1)
    v_exp_f32 v155, v155
    v_exp_f32 v156, v156
    v_exp_f32 v157, v157
    v_smfmac_f32_16x16x64_bf16 v[132:135], v[20:23], v[184:191], v5
    ds_read_b64_tr_b16 a[34:35], v3 offset:49408
    v_exp_f32 v158, v158
    v_exp_f32 v159, v159
    v_mfma_f32_32x32x16_bf16 v[176:191], a[0:3], v[32:35], 4.0
    v_exp_f32 v160, v160
    v_exp_f32 v161, v161
    v_exp_f32 v162, v162
    v_mfma_f32_32x32x16_bf16 v[176:191], a[4:7], v[36:39], v[176:191]
    v_exp_f32 v163, v163
    v_exp_f32 v164, v164
    v_exp_f32 v165, v165
    v_exp_f32 v166, v166
    v_smfmac_f32_32x32x32_bf16 v[96:111], a[40:43], v[144:151], v5
    s_cmp_eq_u32 s34, s58
    s_cselect_b32 s34, s3, s34
    v_exp_f32 v167, v167
    v_exp_f32 v168, v168
    v_exp_f32 v169, v169
    v_smfmac_f32_16x16x64_bf16 v[136:139], v[20:23], v[144:151], v5
    ds_read_b64_tr_b16 a[36:37], v3 offset:50176
    v_exp_f32 v170, v170
    v_smfmac_f32_32x32x32_bf16 v[96:111], a[44:47], v[152:159], v5
    v_exp_f32 v171, v171
    v_exp_f32 v172, v172
    v_exp_f32 v173, v173
    v_smfmac_f32_16x16x64_bf16 v[136:139], v[20:23], v[152:159], v5
    ds_read_b64_tr_b16 a[38:39], v3 offset:50432
    v_exp_f32 v174, v174
    v_exp_f32 v175, v175
    v_mfma_f32_32x32x16_bf16 v[144:159], a[0:3], v[40:43], 4.0
    v_exp_f32 v176, v176
    v_exp_f32 v177, v177
    v_exp_f32 v178, v178
    v_mfma_f32_32x32x16_bf16 v[144:159], a[4:7], v[44:47], v[144:159]
    v_exp_f32 v179, v179
    v_exp_f32 v180, v180
    v_exp_f32 v181, v181
    v_exp_f32 v182, v182
    v_smfmac_f32_32x32x32_bf16 v[112:127], a[40:43], v[160:167], v5
    v_exp_f32 v183, v183
    v_exp_f32 v184, v184
    v_exp_f32 v185, v185
    v_smfmac_f32_16x16x64_bf16 v[140:143], v[20:23], v[160:167], v5
    buffer_store_dwordx4 v[24:27], v4, s[20:23], s34 offen sc1
    v_exp_f32 v186, v186
    v_smfmac_f32_32x32x32_bf16 v[112:127], a[44:47], v[168:175], v5
    v_exp_f32 v187, v187
    v_exp_f32 v188, v188
    v_exp_f32 v189, v189
    v_smfmac_f32_16x16x64_bf16 v[140:143], v[20:23], v[168:175], v5
    buffer_store_dwordx4 v[28:31], v4, s[20:23], s34 offen offset:1024 sc1
    v_exp_f32 v190, v190
    v_exp_f32 v191, v191
    v_mfma_f32_32x32x16_bf16 v[160:175], a[0:3], v[48:51], 4.0
    v_exp_f32 v144, v144
    v_exp_f32 v145, v145
    v_exp_f32 v146, v146
    v_mfma_f32_32x32x16_bf16 v[160:175], a[4:7], v[52:55], v[160:175]
    s_waitcnt lgkmcnt(0)
    v_exp_f32 v147, v147
    v_exp_f32 v148, v148
    v_exp_f32 v149, v149
    v_exp_f32 v150, v150
    v_smfmac_f32_32x32x32_bf16 v[64:79], a[32:35], v[176:183], v5
    v_exp_f32 v151, v151
    v_exp_f32 v152, v152
    v_exp_f32 v153, v153
    v_smfmac_f32_16x16x64_bf16 v[128:131], v[20:23], v[176:183], v5
    ds_read_b128 a[8:11], v7 offset:18432
    v_exp_f32 v154, v154
    v_smfmac_f32_32x32x32_bf16 v[64:79], a[36:39], v[184:191], v5
    v_exp_f32 v155, v155
    v_exp_f32 v156, v156
    v_exp_f32 v157, v157
    v_smfmac_f32_16x16x64_bf16 v[128:131], v[20:23], v[184:191], v5
    ds_read_b128 a[12:15], v8 offset:18432
    v_exp_f32 v158, v158
    v_exp_f32 v159, v159
    v_mfma_f32_32x32x16_bf16 v[176:191], a[0:3], v[56:59], 4.0
    v_exp_f32 v160, v160
    v_exp_f32 v161, v161
    v_exp_f32 v162, v162
    v_mfma_f32_32x32x16_bf16 v[176:191], a[4:7], v[60:63], v[176:191]
    v_exp_f32 v163, v163
    v_exp_f32 v164, v164
    v_exp_f32 v165, v165
    v_exp_f32 v166, v166
    v_smfmac_f32_32x32x32_bf16 v[80:95], a[32:35], v[144:151], v5
    v_exp_f32 v167, v167
    v_exp_f32 v168, v168
    v_exp_f32 v169, v169
    v_smfmac_f32_16x16x64_bf16 v[132:135], v[20:23], v[144:151], v5
    ds_read_b64_tr_b16 a[40:41], v3 offset:51200
    v_exp_f32 v170, v170
    v_smfmac_f32_32x32x32_bf16 v[80:95], a[36:39], v[152:159], v5
    s_waitcnt lgkmcnt(1)
    v_exp_f32 v171, v171
    v_exp_f32 v172, v172
    v_exp_f32 v173, v173
    v_smfmac_f32_16x16x64_bf16 v[132:135], v[20:23], v[152:159], v5
    ds_read_b64_tr_b16 a[42:43], v3 offset:51456
    v_exp_f32 v174, v174
    v_exp_f32 v175, v175
    v_mfma_f32_32x32x16_bf16 v[144:159], a[8:11], v[32:35], 4.0
    v_exp_f32 v176, v176
    v_exp_f32 v177, v177
    v_exp_f32 v178, v178
    v_mfma_f32_32x32x16_bf16 v[144:159], a[12:15], v[36:39], v[144:159]
    v_exp_f32 v179, v179
    v_exp_f32 v180, v180
    v_exp_f32 v181, v181
    v_exp_f32 v182, v182
    v_smfmac_f32_32x32x32_bf16 v[96:111], a[32:35], v[160:167], v5
    v_exp_f32 v183, v183
    v_exp_f32 v184, v184
    v_exp_f32 v185, v185
    v_smfmac_f32_16x16x64_bf16 v[136:139], v[20:23], v[160:167], v5
    ds_read_b64_tr_b16 a[44:45], v3 offset:52224
    v_exp_f32 v186, v186
    v_smfmac_f32_32x32x32_bf16 v[96:111], a[36:39], v[168:175], v5
    v_exp_f32 v187, v187
    v_exp_f32 v188, v188
    v_exp_f32 v189, v189
    v_smfmac_f32_16x16x64_bf16 v[136:139], v[20:23], v[168:175], v5
    ds_read_b64_tr_b16 a[46:47], v3 offset:52480
    v_exp_f32 v190, v190
    v_exp_f32 v191, v191
    v_mfma_f32_32x32x16_bf16 v[160:175], a[8:11], v[40:43], 4.0
    v_exp_f32 v144, v144
    v_exp_f32 v145, v145
    v_exp_f32 v146, v146
    v_mfma_f32_32x32x16_bf16 v[160:175], a[12:15], v[44:47], v[160:175]
    v_exp_f32 v147, v147
    v_exp_f32 v148, v148
    v_exp_f32 v149, v149
    v_exp_f32 v150, v150
    v_smfmac_f32_32x32x32_bf16 v[112:127], a[32:35], v[176:183], v5
    v_exp_f32 v151, v151
    v_exp_f32 v152, v152
    v_exp_f32 v153, v153
    v_smfmac_f32_16x16x64_bf16 v[140:143], v[20:23], v[176:183], v5
    v_exp_f32 v154, v154
    v_smfmac_f32_32x32x32_bf16 v[112:127], a[36:39], v[184:191], v5
    v_exp_f32 v155, v155
    v_exp_f32 v156, v156
    v_exp_f32 v157, v157
    v_smfmac_f32_16x16x64_bf16 v[140:143], v[20:23], v[184:191], v5
    v_exp_f32 v158, v158
    v_exp_f32 v159, v159
    v_mfma_f32_32x32x16_bf16 v[176:191], a[8:11], v[48:51], 4.0
    v_exp_f32 v160, v160
    v_exp_f32 v161, v161
    v_exp_f32 v162, v162
    v_mfma_f32_32x32x16_bf16 v[176:191], a[12:15], v[52:55], v[176:191]
    s_waitcnt lgkmcnt(0)
    v_exp_f32 v163, v163
    v_exp_f32 v164, v164
    v_exp_f32 v165, v165
    v_exp_f32 v166, v166
    v_smfmac_f32_32x32x32_bf16 v[64:79], a[40:43], v[144:151], v5
    v_exp_f32 v167, v167
    v_exp_f32 v168, v168
    v_exp_f32 v169, v169
    v_smfmac_f32_16x16x64_bf16 v[128:131], v[20:23], v[144:151], v5
    ds_read_b128 a[0:3], v7 offset:20480
    v_exp_f32 v170, v170
    v_smfmac_f32_32x32x32_bf16 v[64:79], a[44:47], v[152:159], v5
    v_exp_f32 v171, v171
    v_exp_f32 v172, v172
    v_exp_f32 v173, v173
    v_smfmac_f32_16x16x64_bf16 v[128:131], v[20:23], v[152:159], v5
    ds_read_b128 a[4:7], v8 offset:20480
    v_exp_f32 v174, v174
    v_exp_f32 v175, v175
    v_mfma_f32_32x32x16_bf16 v[144:159], a[8:11], v[56:59], 4.0
    v_exp_f32 v176, v176
    v_exp_f32 v177, v177
    v_exp_f32 v178, v178
    v_mfma_f32_32x32x16_bf16 v[144:159], a[12:15], v[60:63], v[144:159]
    v_exp_f32 v179, v179
    v_exp_f32 v180, v180
    v_exp_f32 v181, v181
    v_exp_f32 v182, v182
    v_smfmac_f32_32x32x32_bf16 v[80:95], a[40:43], v[160:167], v5
    v_exp_f32 v183, v183
    v_exp_f32 v184, v184
    v_exp_f32 v185, v185
    v_smfmac_f32_16x16x64_bf16 v[132:135], v[20:23], v[160:167], v5
    ds_read_b64_tr_b16 a[32:33], v3 offset:53248
    v_exp_f32 v186, v186
    v_smfmac_f32_32x32x32_bf16 v[80:95], a[44:47], v[168:175], v5
    s_waitcnt lgkmcnt(1)
    v_exp_f32 v187, v187
    v_exp_f32 v188, v188
    v_exp_f32 v189, v189
    v_smfmac_f32_16x16x64_bf16 v[132:135], v[20:23], v[168:175], v5
    ds_read_b64_tr_b16 a[34:35], v3 offset:53504
    v_exp_f32 v190, v190
    v_exp_f32 v191, v191
    v_mfma_f32_32x32x16_bf16 v[160:175], a[0:3], v[32:35], 4.0
    v_exp_f32 v144, v144
    v_exp_f32 v145, v145
    v_exp_f32 v146, v146
    v_mfma_f32_32x32x16_bf16 v[160:175], a[4:7], v[36:39], v[160:175]
    v_exp_f32 v147, v147
    v_exp_f32 v148, v148
    v_exp_f32 v149, v149
    v_exp_f32 v150, v150
    v_smfmac_f32_32x32x32_bf16 v[96:111], a[40:43], v[176:183], v5
    v_exp_f32 v151, v151
    v_exp_f32 v152, v152
    v_exp_f32 v153, v153
    v_smfmac_f32_16x16x64_bf16 v[136:139], v[20:23], v[176:183], v5
    ds_read_b64_tr_b16 a[36:37], v3 offset:54272
    v_exp_f32 v154, v154
    v_smfmac_f32_32x32x32_bf16 v[96:111], a[44:47], v[184:191], v5
    v_exp_f32 v155, v155
    v_exp_f32 v156, v156
    v_exp_f32 v157, v157
    v_smfmac_f32_16x16x64_bf16 v[136:139], v[20:23], v[184:191], v5
    ds_read_b64_tr_b16 a[38:39], v3 offset:54528
    v_exp_f32 v158, v158
    v_exp_f32 v159, v159
    v_mfma_f32_32x32x16_bf16 v[176:191], a[0:3], v[40:43], 4.0
    v_exp_f32 v160, v160
    v_exp_f32 v161, v161
    v_exp_f32 v162, v162
    v_mfma_f32_32x32x16_bf16 v[176:191], a[4:7], v[44:47], v[176:191]
    v_exp_f32 v163, v163
    v_exp_f32 v164, v164
    v_exp_f32 v165, v165
    v_exp_f32 v166, v166
    v_smfmac_f32_32x32x32_bf16 v[112:127], a[40:43], v[144:151], v5
    s_barrier
    v_exp_f32 v167, v167
    v_exp_f32 v168, v168
    v_exp_f32 v169, v169
    v_smfmac_f32_16x16x64_bf16 v[140:143], v[20:23], v[144:151], v5
    ds_read_b128 v[24:27], v4 offset:24576
    v_exp_f32 v170, v170
    v_smfmac_f32_32x32x32_bf16 v[112:127], a[44:47], v[152:159], v5
    v_exp_f32 v171, v171
    v_exp_f32 v172, v172
    v_exp_f32 v173, v173
    v_smfmac_f32_16x16x64_bf16 v[140:143], v[20:23], v[152:159], v5
    ds_read_b128 v[28:31], v4 offset:25600
    v_exp_f32 v174, v174
    v_exp_f32 v175, v175
    v_mfma_f32_32x32x16_bf16 v[144:159], a[0:3], v[48:51], 4.0
    v_exp_f32 v176, v176
    v_exp_f32 v177, v177
    v_exp_f32 v178, v178
    v_mfma_f32_32x32x16_bf16 v[144:159], a[4:7], v[52:55], v[144:159]
    s_waitcnt lgkmcnt(2)
    v_exp_f32 v179, v179
    v_exp_f32 v180, v180
    v_exp_f32 v181, v181
    v_exp_f32 v182, v182
    v_smfmac_f32_32x32x32_bf16 v[64:79], a[32:35], v[160:167], v5
    v_exp_f32 v183, v183
    v_exp_f32 v184, v184
    v_exp_f32 v185, v185
    v_smfmac_f32_16x16x64_bf16 v[128:131], v[20:23], v[160:167], v5
    ds_read_b128 a[8:11], v7 offset:22528
    v_exp_f32 v186, v186
    v_smfmac_f32_32x32x32_bf16 v[64:79], a[36:39], v[168:175], v5
L_pad2:
    s_cbranch_vccnz L_hop2
    v_exp_f32 v187, v187
    v_exp_f32 v188, v188
    v_exp_f32 v189, v189
    v_smfmac_f32_16x16x64_bf16 v[128:131], v[20:23], v[168:175], v5
    ds_read_b128 a[12:15], v8 offset:22528
    v_exp_f32 v190, v190
    v_exp_f32 v191, v191
    v_mfma_f32_32x32x16_bf16 v[160:175], a[0:3], v[56:59], 4.0
    v_exp_f32 v144, v144
    v_exp_f32 v145, v145
    v_exp_f32 v146, v146
    v_mfma_f32_32x32x16_bf16 v[160:175], a[4:7], v[60:63], v[160:175]
    v_exp_f32 v147, v147
    v_exp_f32 v148, v148
    v_exp_f32 v149, v149
    v_exp_f32 v150, v150
    v_smfmac_f32_32x32x32_bf16 v[80:95], a[32:35], v[176:183], v5
    v_exp_f32 v151, v151
    v_exp_f32 v152, v152
    v_exp_f32 v153, v153
    v_smfmac_f32_16x16x64_bf16 v[132:135], v[20:23], v[176:183], v5
    ds_read_b64_tr_b16 a[40:41], v3 offset:55296
    v_exp_f32 v154, v154
    v_smfmac_f32_32x32x32_bf16 v[80:95], a[36:39], v[184:191], v5
    s_waitcnt lgkmcnt(1)
    v_exp_f32 v155, v155
    v_exp_f32 v156, v156
    v_exp_f32 v157, v157
    v_smfmac_f32_16x16x64_bf16 v[132:135], v[20:23], v[184:191], v5
    ds_read_b64_tr_b16 a[42:43], v3 offset:55552
    v_exp_f32 v158, v158
    v_exp_f32 v159, v159
    v_mfma_f32_32x32x16_bf16 v[176:191], a[8:11], v[32:35], 4.0
    v_exp_f32 v160, v160
    v_exp_f32 v161, v161
    v_exp_f32 v162, v162
    v_mfma_f32_32x32x16_bf16 v[176:191], a[12:15], v[36:39], v[176:191]
    v_exp_f32 v163, v163
    v_exp_f32 v164, v164
    v_exp_f32 v165, v165
    v_exp_f32 v166, v166
    v_dot2_f32_bf16 v12, v24, v24, 0
    v_dot2_f32_bf16 v12, v25, v25, v12
    v_dot2_f32_bf16 v12, v26, v26, v12
    v_dot2_f32_bf16 v12, v27, v27, v12
    v_dot2_f32_bf16 v12, v28, v28, v12
    v_dot2_f32_bf16 v12, v29, v29, v12
    v_dot2_f32_bf16 v12, v30, v30, v12
    v_dot2_f32_bf16 v12, v31, v31, v12
    v_lshlrev_b32 v14, 16, v24
    v_and_b32 v15, 0xffff0000, v24
    v_lshlrev_b32 v16, 16, v25
    v_add_f32_dpp v12, v12, v12 quad_perm:[1,0,3,2] row_mask:0xf bank_mask:0xf
    v_sqrt_f32 v12, v12
    v_and_b32 v17, 0xffff0000, v25
    v_add_f32 v12, s61, v12
    v_rcp_f32 v12, v12
    v_lshlrev_b32 v18, 16, v26
    v_pk_mul_f32 v[14:15], v[14:15], v[12:13] op_sel_hi:[1,0]
    v_cvt_pk_bf16_f32 v24, v14, v15
    v_pk_mul_f32 v[16:17], v[16:17], v[12:13] op_sel_hi:[1,0]
    v_cvt_pk_bf16_f32 v25, v16, v17
    v_and_b32 v19, 0xffff0000, v26
    v_pk_mul_f32 v[18:19], v[18:19], v[12:13] op_sel_hi:[1,0]
    v_cvt_pk_bf16_f32 v26, v18, v19
    v_lshlrev_b32 v14, 16, v27
    v_and_b32 v15, 0xffff0000, v27
    v_pk_mul_f32 v[14:15], v[14:15], v[12:13] op_sel_hi:[1,0]
    v_cvt_pk_bf16_f32 v27, v14, v15
    v_lshlrev_b32 v16, 16, v28
    v_and_b32 v17, 0xffff0000, v28
    v_pk_mul_f32 v[16:17], v[16:17], v[12:13] op_sel_hi:[1,0]
    v_cvt_pk_bf16_f32 v28, v16, v17
    v_lshlrev_b32 v18, 16, v29
    v_and_b32 v19, 0xffff0000, v29
    v_pk_mul_f32 v[18:19], v[18:19], v[12:13] op_sel_hi:[1,0]
    v_cvt_pk_bf16_f32 v29, v18, v19
    v_lshlrev_b32 v14, 16, v30
    v_and_b32 v15, 0xffff0000, v30
    v_pk_mul_f32 v[14:15], v[14:15], v[12:13] op_sel_hi:[1,0]
    v_cvt_pk_bf16_f32 v30, v14, v15
    v_lshlrev_b32 v16, 16, v31
    v_and_b32 v17, 0xffff0000, v31
    v_pk_mul_f32 v[16:17], v[16:17], v[12:13] op_sel_hi:[1,0]
    v_cvt_pk_bf16_f32 v31, v16, v17
    v_smfmac_f32_32x32x32_bf16 v[96:111], a[32:35], v[144:151], v5
    v_exp_f32 v167, v167
    v_exp_f32 v168, v168
    v_exp_f32 v169, v169
    v_smfmac_f32_16x16x64_bf16 v[136:139], v[20:23], v[144:151], v5
    ds_read_b64_tr_b16 a[44:45], v3 offset:56320
    v_exp_f32 v170, v170
    v_smfmac_f32_32x32x32_bf16 v[96:111], a[36:39], v[152:159], v5
    v_exp_f32 v171, v171
    v_exp_f32 v172, v172
    v_exp_f32 v173, v173
    v_smfmac_f32_16x16x64_bf16 v[136:139], v[20:23], v[152:159], v5
    ds_read_b64_tr_b16 a[46:47], v3 offset:56576
    v_exp_f32 v174, v174
    v_exp_f32 v175, v175
    v_mfma_f32_32x32x16_bf16 v[144:159], a[8:11], v[40:43], 4.0
    v_exp_f32 v176, v176
    v_exp_f32 v177, v177
    v_exp_f32 v178, v178
    v_mfma_f32_32x32x16_bf16 v[144:159], a[12:15], v[44:47], v[144:159]
    v_exp_f32 v179, v179
    v_exp_f32 v180, v180
    v_exp_f32 v181, v181
    v_exp_f32 v182, v182
    v_smfmac_f32_32x32x32_bf16 v[112:127], a[32:35], v[160:167], v5
    v_exp_f32 v183, v183
    v_exp_f32 v184, v184
    v_exp_f32 v185, v185
    v_smfmac_f32_16x16x64_bf16 v[140:143], v[20:23], v[160:167], v5
    ds_write_b128 v4, v[24:27] offset:24576
    v_exp_f32 v186, v186
    v_smfmac_f32_32x32x32_bf16 v[112:127], a[36:39], v[168:175], v5
    v_exp_f32 v187, v187
    v_exp_f32 v188, v188
    v_exp_f32 v189, v189
    v_smfmac_f32_16x16x64_bf16 v[140:143], v[20:23], v[168:175], v5
    ds_write_b128 v4, v[28:31] offset:25600
    v_exp_f32 v190, v190
    v_exp_f32 v191, v191
    v_mfma_f32_32x32x16_bf16 v[160:175], a[8:11], v[48:51], 4.0
    s_add_u32 s34, s34, 8192
    v_exp_f32 v144, v144
    v_exp_f32 v145, v145
    v_exp_f32 v146, v146
    v_mfma_f32_32x32x16_bf16 v[160:175], a[12:15], v[52:55], v[160:175]
    s_waitcnt lgkmcnt(2)
    v_exp_f32 v147, v147
    v_exp_f32 v148, v148
    v_exp_f32 v149, v149
    v_exp_f32 v150, v150
    v_smfmac_f32_32x32x32_bf16 v[64:79], a[40:43], v[176:183], v5
    s_waitcnt vmcnt(0) lgkmcnt(0)
    s_barrier
    v_exp_f32 v151, v151
    v_exp_f32 v152, v152
    v_exp_f32 v153, v153
    v_smfmac_f32_16x16x64_bf16 v[128:131], v[20:23], v[176:183], v5
    ds_read_b128 a[0:3], v7 offset:24576
    v_exp_f32 v154, v154
    v_smfmac_f32_32x32x32_bf16 v[64:79], a[44:47], v[184:191], v5
    v_exp_f32 v155, v155
    v_exp_f32 v156, v156
    v_exp_f32 v157, v157
    v_smfmac_f32_16x16x64_bf16 v[128:131], v[20:23], v[184:191], v5
    ds_read_b128 a[4:7], v8 offset:24576
    v_exp_f32 v158, v158
    v_exp_f32 v159, v159
    v_mfma_f32_32x32x16_bf16 v[176:191], a[8:11], v[56:59], 4.0
    s_and_b32 s34, s34, 0x1ffff
    v_exp_f32 v160, v160
    v_exp_f32 v161, v161
    v_exp_f32 v162, v162
    v_mfma_f32_32x32x16_bf16 v[176:191], a[12:15], v[60:63], v[176:191]
    v_exp_f32 v163, v163
    v_exp_f32 v164, v164
    v_exp_f32 v165, v165
    v_exp_f32 v166, v166
    v_smfmac_f32_32x32x32_bf16 v[80:95], a[40:43], v[144:151], v5
    v_exp_f32 v167, v167
    v_exp_f32 v168, v168
    v_exp_f32 v169, v169
    v_smfmac_f32_16x16x64_bf16 v[132:135], v[20:23], v[144:151], v5
    ds_read_b64_tr_b16 a[32:33], v3 offset:57344
    v_exp_f32 v170, v170
    v_smfmac_f32_32x32x32_bf16 v[80:95], a[44:47], v[152:159], v5
    s_waitcnt lgkmcnt(1)
    v_exp_f32 v171, v171
    v_exp_f32 v172, v172
    v_exp_f32 v173, v173
    v_smfmac_f32_16x16x64_bf16 v[132:135], v[20:23], v[152:159], v5
    ds_read_b64_tr_b16 a[34:35], v3 offset:57600
    v_exp_f32 v174, v174
    v_exp_f32 v175, v175
    v_mfma_f32_32x32x16_bf16 v[144:159], a[0:3], v[32:35], 4.0
    v_exp_f32 v176, v176
    v_exp_f32 v177, v177
    v_exp_f32 v178, v178
    v_mfma_f32_32x32x16_bf16 v[144:159], a[4:7], v[36:39], v[144:159]
    v_exp_f32 v179, v179
    v_exp_f32 v180, v180
    v_exp_f32 v181, v181
    v_exp_f32 v182, v182
    v_smfmac_f32_32x32x32_bf16 v[96:111], a[40:43], v[160:167], v5
    s_cmp_eq_u32 s34, s58
    s_cselect_b32 s34, s3, s34
    v_exp_f32 v183, v183
    v_exp_f32 v184, v184
    v_exp_f32 v185, v185
    v_smfmac_f32_16x16x64_bf16 v[136:139], v[20:23], v[160:167], v5
    ds_read_b64_tr_b16 a[36:37], v3 offset:58368
    v_exp_f32 v186, v186
    v_smfmac_f32_32x32x32_bf16 v[96:111], a[44:47], v[168:175], v5
    v_exp_f32 v187, v187
    v_exp_f32 v188, v188
    v_exp_f32 v189, v189
    v_smfmac_f32_16x16x64_bf16 v[136:139], v[20:23], v[168:175], v5
    ds_read_b64_tr_b16 a[38:39], v3 offset:58624
    v_exp_f32 v190, v190
    v_exp_f32 v191, v191
    v_mfma_f32_32x32x16_bf16 v[160:175], a[0:3], v[40:43], 4.0
    v_exp_f32 v144, v144
    v_exp_f32 v145, v145
    v_exp_f32 v146, v146
    v_mfma_f32_32x32x16_bf16 v[160:175], a[4:7], v[44:47], v[160:175]
    v_exp_f32 v147, v147
    v_exp_f32 v148, v148
    v_exp_f32 v149, v149
    v_exp_f32 v150, v150
    v_smfmac_f32_32x32x32_bf16 v[112:127], a[40:43], v[176:183], v5
    v_exp_f32 v151, v151
    v_exp_f32 v152, v152
    v_exp_f32 v153, v153
    v_smfmac_f32_16x16x64_bf16 v[140:143], v[20:23], v[176:183], v5
    buffer_store_dwordx4 v[24:27], v4, s[20:23], s34 offen sc1
    v_exp_f32 v154, v154
    v_smfmac_f32_32x32x32_bf16 v[112:127], a[44:47], v[184:191], v5
    v_exp_f32 v155, v155
    v_exp_f32 v156, v156
    v_exp_f32 v157, v157
    v_smfmac_f32_16x16x64_bf16 v[140:143], v[20:23], v[184:191], v5
    buffer_store_dwordx4 v[28:31], v4, s[20:23], s34 offen offset:1024 sc1
    v_exp_f32 v158, v158
    v_exp_f32 v159, v159
    v_mfma_f32_32x32x16_bf16 v[176:191], a[0:3], v[48:51], 4.0
    v_exp_f32 v160, v160
    v_exp_f32 v161, v161
    v_exp_f32 v162, v162
    v_mfma_f32_32x32x16_bf16 v[176:191], a[4:7], v[52:55], v[176:191]
    s_waitcnt lgkmcnt(0)
    v_exp_f32 v163, v163
    v_exp_f32 v164, v164
    v_exp_f32 v165, v165
    v_exp_f32 v166, v166
    v_smfmac_f32_32x32x32_bf16 v[64:79], a[32:35], v[144:151], v5
    v_exp_f32 v167, v167
    v_exp_f32 v168, v168
    v_exp_f32 v169, v169
    v_smfmac_f32_16x16x64_bf16 v[128:131], v[20:23], v[144:151], v5
    ds_read_b128 a[8:11], v7 offset:26624
    v_exp_f32 v170, v170
    v_smfmac_f32_32x32x32_bf16 v[64:79], a[36:39], v[152:159], v5
    v_exp_f32 v171, v171
    v_exp_f32 v172, v172
    v_exp_f32 v173, v173
    v_smfmac_f32_16x16x64_bf16 v[128:131], v[20:23], v[152:159], v5
    ds_read_b128 a[12:15], v8 offset:26624
    v_exp_f32 v174, v174
    v_exp_f32 v175, v175
    v_mfma_f32_32x32x16_bf16 v[144:159], a[0:3], v[56:59], 4.0
    v_exp_f32 v176, v176
    v_exp_f32 v177, v177
    v_exp_f32 v178, v178
    v_mfma_f32_32x32x16_bf16 v[144:159], a[4:7], v[60:63], v[144:159]
    v_exp_f32 v179, v179
    v_exp_f32 v180, v180
    v_exp_f32 v181, v181
    v_exp_f32 v182, v182
    v_smfmac_f32_32x32x32_bf16 v[80:95], a[32:35], v[160:167], v5
    v_exp_f32 v183, v183
    v_exp_f32 v184, v184
    v_exp_f32 v185, v185
    v_smfmac_f32_16x16x64_bf16 v[132:135], v[20:23], v[160:167], v5
    ds_read_b64_tr_b16 a[40:41], v3 offset:59392
    v_exp_f32 v186, v186
    v_smfmac_f32_32x32x32_bf16 v[80:95], a[36:39], v[168:175], v5
    s_waitcnt lgkmcnt(1)
    v_exp_f32 v187, v187
    v_exp_f32 v188, v188
    v_exp_f32 v189, v189
    v_smfmac_f32_16x16x64_bf16 v[132:135], v[20:23], v[168:175], v5
    ds_read_b64_tr_b16 a[42:43], v3 offset:59648
    v_exp_f32 v190, v190
    v_exp_f32 v191, v191
    v_mfma_f32_32x32x16_bf16 v[160:175], a[8:11], v[32:35], 4.0
    v_exp_f32 v144, v144
    v_exp_f32 v145, v145
    v_exp_f32 v146, v146
    v_mfma_f32_32x32x16_bf16 v[160:175], a[12:15], v[36:39], v[160:175]
    v_exp_f32 v147, v147
    v_exp_f32 v148, v148
    v_exp_f32 v149, v149
    v_exp_f32 v150, v150
    v_smfmac_f32_32x32x32_bf16 v[96:111], a[32:35], v[176:183], v5
    v_exp_f32 v151, v151
    v_exp_f32 v152, v152
    v_exp_f32 v153, v153
    v_smfmac_f32_16x16x64_bf16 v[136:139], v[20:23], v[176:183], v5
    ds_read_b64_tr_b16 a[44:45], v3 offset:60416
    v_exp_f32 v154, v154
    v_smfmac_f32_32x32x32_bf16 v[96:111], a[36:39], v[184:191], v5
    v_exp_f32 v155, v155
    v_exp_f32 v156, v156
    v_exp_f32 v157, v157
    v_smfmac_f32_16x16x64_bf16 v[136:139], v[20:23], v[184:191], v5
    ds_read_b64_tr_b16 a[46:47], v3 offset:60672
    v_exp_f32 v158, v158
    v_exp_f32 v159, v159
    v_mfma_f32_32x32x16_bf16 v[176:191], a[8:11], v[40:43], 4.0
    v_exp_f32 v160, v160
    v_exp_f32 v161, v161
    v_exp_f32 v162, v162
    v_mfma_f32_32x32x16_bf16 v[176:191], a[12:15], v[44:47], v[176:191]
    v_exp_f32 v163, v163
    v_exp_f32 v164, v164
    v_exp_f32 v165, v165
    v_exp_f32 v166, v166
    v_smfmac_f32_32x32x32_bf16 v[112:127], a[32:35], v[144:151], v5
    v_exp_f32 v167, v167
    v_exp_f32 v168, v168
    v_exp_f32 v169, v169
    v_smfmac_f32_16x16x64_bf16 v[140:143], v[20:23], v[144:151], v5
    v_exp_f32 v170, v170
    v_smfmac_f32_32x32x32_bf16 v[112:127], a[36:39], v[152:159], v5
    v_exp_f32 v171, v171
    v_exp_f32 v172, v172
    v_exp_f32 v173, v173
    v_smfmac_f32_16x16x64_bf16 v[140:143], v[20:23], v[152:159], v5
    v_exp_f32 v174, v174
    v_exp_f32 v175, v175
    v_mfma_f32_32x32x16_bf16 v[144:159], a[8:11], v[48:51], 4.0
    v_exp_f32 v176, v176
    v_exp_f32 v177, v177
    v_exp_f32 v178, v178
    v_mfma_f32_32x32x16_bf16 v[144:159], a[12:15], v[52:55], v[144:159]
    s_waitcnt lgkmcnt(0)
    v_exp_f32 v179, v179
    v_exp_f32 v180, v180
    v_exp_f32 v181, v181
    v_exp_f32 v182, v182
    v_smfmac_f32_32x32x32_bf16 v[64:79], a[40:43], v[160:167], v5
    v_exp_f32 v183, v183
    v_exp_f32 v184, v184
    v_exp_f32 v185, v185
    v_smfmac_f32_16x16x64_bf16 v[128:131], v[20:23], v[160:167], v5
    ds_read_b128 a[0:3], v7 offset:28672
    v_exp_f32 v186, v186
    v_smfmac_f32_32x32x32_bf16 v[64:79], a[44:47], v[168:175], v5
    v_exp_f32 v187, v187
    v_exp_f32 v188, v188
    v_exp_f32 v189, v189
    v_smfmac_f32_16x16x64_bf16 v[128:131], v[20:23], v[168:175], v5
    ds_read_b128 a[4:7], v8 offset:28672
    v_exp_f32 v190, v190
    v_exp_f32 v191, v191
    v_mfma_f32_32x32x16_bf16 v[160:175], a[8:11], v[56:59], 4.0
    v_exp_f32 v144, v144
    v_exp_f32 v145, v145
    v_exp_f32 v146, v146
    v_mfma_f32_32x32x16_bf16 v[160:175], a[12:15], v[60:63], v[160:175]
    v_exp_f32 v147, v147
    v_exp_f32 v148, v148
    v_exp_f32 v149, v149
    v_exp_f32 v150, v150
    v_smfmac_f32_32x32x32_bf16 v[80:95], a[40:43], v[176:183], v5
    v_exp_f32 v151, v151
    v_exp_f32 v152, v152
    v_exp_f32 v153, v153
    v_smfmac_f32_16x16x64_bf16 v[132:135], v[20:23], v[176:183], v5
    ds_read_b64_tr_b16 a[32:33], v3 offset:61440
    v_exp_f32 v154, v154
    v_smfmac_f32_32x32x32_bf16 v[80:95], a[44:47], v[184:191], v5
    s_waitcnt lgkmcnt(1)
    v_exp_f32 v155, v155
    v_exp_f32 v156, v156
    v_exp_f32 v157, v157
    v_smfmac_f32_16x16x64_bf16 v[132:135], v[20:23], v[184:191], v5
    ds_read_b64_tr_b16 a[34:35], v3 offset:61696
    v_exp_f32 v158, v158
    v_exp_f32 v159, v159
    v_mfma_f32_32x32x16_bf16 v[176:191], a[0:3], v[32:35], 4.0
    v_exp_f32 v160, v160
    v_exp_f32 v161, v161
    v_exp_f32 v162, v162
    v_mfma_f32_32x32x16_bf16 v[176:191], a[4:7], v[36:39], v[176:191]
    v_exp_f32 v163, v163
    v_exp_f32 v164, v164
    v_exp_f32 v165, v165
    v_exp_f32 v166, v166
    v_smfmac_f32_32x32x32_bf16 v[96:111], a[40:43], v[144:151], v5
    v_exp_f32 v167, v167
    v_exp_f32 v168, v168
    v_exp_f32 v169, v169
    v_smfmac_f32_16x16x64_bf16 v[136:139], v[20:23], v[144:151], v5
    ds_read_b64_tr_b16 a[36:37], v3 offset:62464
    v_exp_f32 v170, v170
    v_smfmac_f32_32x32x32_bf16 v[96:111], a[44:47], v[152:159], v5
    v_exp_f32 v171, v171
    v_exp_f32 v172, v172
    v_exp_f32 v173, v173
    v_smfmac_f32_16x16x64_bf16 v[136:139], v[20:23], v[152:159], v5
    ds_read_b64_tr_b16 a[38:39], v3 offset:62720
    v_exp_f32 v174, v174
    v_exp_f32 v175, v175
    v_mfma_f32_32x32x16_bf16 v[144:159], a[0:3], v[40:43], 4.0
    v_exp_f32 v176, v176
    v_exp_f32 v177, v177
    v_exp_f32 v178, v178
    v_mfma_f32_32x32x16_bf16 v[144:159], a[4:7], v[44:47], v[144:159]
    v_exp_f32 v179, v179
    v_exp_f32 v180, v180
    v_exp_f32 v181, v181
    v_exp_f32 v182, v182
    v_smfmac_f32_32x32x32_bf16 v[112:127], a[40:43], v[160:167], v5
    s_barrier
    v_exp_f32 v183, v183
    v_exp_f32 v184, v184
    v_exp_f32 v185, v185
    v_smfmac_f32_16x16x64_bf16 v[140:143], v[20:23], v[160:167], v5
    ds_read_b128 v[24:27], v4 offset:0
    v_exp_f32 v186, v186
    v_smfmac_f32_32x32x32_bf16 v[112:127], a[44:47], v[168:175], v5
    v_exp_f32 v187, v187
    v_exp_f32 v188, v188
    v_exp_f32 v189, v189
    v_smfmac_f32_16x16x64_bf16 v[140:143], v[20:23], v[168:175], v5
    ds_read_b128 v[28:31], v4 offset:1024
    v_exp_f32 v190, v190
    v_exp_f32 v191, v191
    v_mfma_f32_32x32x16_bf16 v[160:175], a[0:3], v[48:51], 4.0
    v_exp_f32 v144, v144
    v_exp_f32 v145, v145
    v_exp_f32 v146, v146
    v_mfma_f32_32x32x16_bf16 v[160:175], a[4:7], v[52:55], v[160:175]
    s_waitcnt lgkmcnt(2)
    v_exp_f32 v147, v147
    v_exp_f32 v148, v148
    v_exp_f32 v149, v149
    v_exp_f32 v150, v150
    v_smfmac_f32_32x32x32_bf16 v[64:79], a[32:35], v[176:183], v5
    v_exp_f32 v151, v151
    v_exp_f32 v152, v152
    v_exp_f32 v153, v153
    v_smfmac_f32_16x16x64_bf16 v[128:131], v[20:23], v[176:183], v5
    ds_read_b128 a[8:11], v7 offset:30720
    v_exp_f32 v154, v154
    v_smfmac_f32_32x32x32_bf16 v[64:79], a[36:39], v[184:191], v5
    v_exp_f32 v155, v155
    v_exp_f32 v156, v156
    v_exp_f32 v157, v157
    v_smfmac_f32_16x16x64_bf16 v[128:131], v[20:23], v[184:191], v5
    ds_read_b128 a[12:15], v8 offset:30720
    v_exp_f32 v158, v158
    v_exp_f32 v159, v159
    v_mfma_f32_32x32x16_bf16 v[176:191], a[0:3], v[56:59], 4.0
    v_exp_f32 v160, v160
    v_exp_f32 v161, v161
    v_exp_f32 v162, v162
    v_mfma_f32_32x32x16_bf16 v[176:191], a[4:7], v[60:63], v[176:191]
    v_exp_f32 v163, v163
    v_exp_f32 v164, v164
    v_exp_f32 v165, v165
    v_exp_f32 v166, v166
    v_smfmac_f32_32x32x32_bf16 v[80:95], a[32:35], v[144:151], v5
    v_exp_f32 v167, v167
    v_exp_f32 v168, v168
    v_exp_f32 v169, v169
    v_smfmac_f32_16x16x64_bf16 v[132:135], v[20:23], v[144:151], v5
    ds_read_b64_tr_b16 a[40:41], v3 offset:63488
    v_exp_f32 v170, v170
    v_smfmac_f32_32x32x32_bf16 v[80:95], a[36:39], v[152:159], v5
    s_waitcnt lgkmcnt(1)
    v_exp_f32 v171, v171
    v_exp_f32 v172, v172
    v_exp_f32 v173, v173
    v_smfmac_f32_16x16x64_bf16 v[132:135], v[20:23], v[152:159], v5
    ds_read_b64_tr_b16 a[42:43], v3 offset:63744
    v_exp_f32 v174, v174
    v_exp_f32 v175, v175
    v_mfma_f32_32x32x16_bf16 v[144:159], a[8:11], v[32:35], 4.0
    v_exp_f32 v176, v176
    v_exp_f32 v177, v177
    v_exp_f32 v178, v178
    v_mfma_f32_32x32x16_bf16 v[144:159], a[12:15], v[36:39], v[144:159]
    v_exp_f32 v179, v179
    v_exp_f32 v180, v180
    v_exp_f32 v181, v181
    v_exp_f32 v182, v182
    v_dot2_f32_bf16 v12, v24, v24, 0
    v_dot2_f32_bf16 v12, v25, v25, v12
    v_dot2_f32_bf16 v12, v26, v26, v12
    v_dot2_f32_bf16 v12, v27, v27, v12
    v_dot2_f32_bf16 v12, v28, v28, v12
    v_dot2_f32_bf16 v12, v29, v29, v12
    v_dot2_f32_bf16 v12, v30, v30, v12
    v_dot2_f32_bf16 v12, v31, v31, v12
    v_lshlrev_b32 v14, 16, v24
    v_and_b32 v15, 0xffff0000, v24
    v_lshlrev_b32 v16, 16, v25
    v_add_f32_dpp v12, v12, v12 quad_perm:[1,0,3,2] row_mask:0xf bank_mask:0xf
    v_sqrt_f32 v12, v12
    v_and_b32 v17, 0xffff0000, v25
    v_add_f32 v12, s61, v12
    v_rcp_f32 v12, v12
    v_lshlrev_b32 v18, 16, v26
    v_pk_mul_f32 v[14:15], v[14:15], v[12:13] op_sel_hi:[1,0]
    v_cvt_pk_bf16_f32 v24, v14, v15
    v_pk_mul_f32 v[16:17], v[16:17], v[12:13] op_sel_hi:[1,0]
    v_cvt_pk_bf16_f32 v25, v16, v17
    v_and_b32 v19, 0xffff0000, v26
    v_pk_mul_f32 v[18:19], v[18:19], v[12:13] op_sel_hi:[1,0]
    v_cvt_pk_bf16_f32 v26, v18, v19
    v_lshlrev_b32 v14, 16, v27
    v_and_b32 v15, 0xffff0000, v27
    v_pk_mul_f32 v[14:15], v[14:15], v[12:13] op_sel_hi:[1,0]
    v_cvt_pk_bf16_f32 v27, v14, v15
    v_lshlrev_b32 v16, 16, v28
    v_and_b32 v17, 0xffff0000, v28
    v_pk_mul_f32 v[16:17], v[16:17], v[12:13] op_sel_hi:[1,0]
    v_cvt_pk_bf16_f32 v28, v16, v17
    v_lshlrev_b32 v18, 16, v29
    v_and_b32 v19, 0xffff0000, v29
    v_pk_mul_f32 v[18:19], v[18:19], v[12:13] op_sel_hi:[1,0]
    v_cvt_pk_bf16_f32 v29, v18, v19
    v_lshlrev_b32 v14, 16, v30
    v_and_b32 v15, 0xffff0000, v30
    v_pk_mul_f32 v[14:15], v[14:15], v[12:13] op_sel_hi:[1,0]
    v_cvt_pk_bf16_f32 v30, v14, v15
    v_lshlrev_b32 v16, 16, v31
    v_and_b32 v17, 0xffff0000, v31
    v_pk_mul_f32 v[16:17], v[16:17], v[12:13] op_sel_hi:[1,0]
    v_cvt_pk_bf16_f32 v31, v16, v17
    v_smfmac_f32_32x32x32_bf16 v[96:111], a[32:35], v[160:167], v5
    v_exp_f32 v183, v183
    v_exp_f32 v184, v184
    v_exp_f32 v185, v185
    v_smfmac_f32_16x16x64_bf16 v[136:139], v[20:23], v[160:167], v5
    ds_read_b64_tr_b16 a[44:45], v3 offset:64512
    v_exp_f32 v186, v186
    v_smfmac_f32_32x32x32_bf16 v[96:111], a[36:39], v[168:175], v5
    v_exp_f32 v187, v187
    v_exp_f32 v188, v188
    v_exp_f32 v189, v189
    v_smfmac_f32_16x16x64_bf16 v[136:139], v[20:23], v[168:175], v5
    ds_read_b64_tr_b16 a[46:47], v3 offset:64768
    v_exp_f32 v190, v190
    v_exp_f32 v191, v191
    v_mfma_f32_32x32x16_bf16 v[160:175], a[8:11], v[40:43], 4.0
    v_exp_f32 v144, v144
    v_exp_f32 v145, v145
    v_exp_f32 v146, v146
    v_mfma_f32_32x32x16_bf16 v[160:175], a[12:15], v[44:47], v[160:175]
    v_exp_f32 v147, v147
    v_exp_f32 v148, v148
    v_exp_f32 v149, v149
    v_exp_f32 v150, v150
    v_smfmac_f32_32x32x32_bf16 v[112:127], a[32:35], v[176:183], v5
    v_exp_f32 v151, v151
    v_exp_f32 v152, v152
    v_exp_f32 v153, v153
    v_smfmac_f32_16x16x64_bf16 v[140:143], v[20:23], v[176:183], v5
    ds_write_b128 v4, v[24:27] offset:0
    v_exp_f32 v154, v154
    v_smfmac_f32_32x32x32_bf16 v[112:127], a[36:39], v[184:191], v5
    v_exp_f32 v155, v155
    v_exp_f32 v156, v156
    v_exp_f32 v157, v157
    v_smfmac_f32_16x16x64_bf16 v[140:143], v[20:23], v[184:191], v5
    ds_write_b128 v4, v[28:31] offset:1024
    v_exp_f32 v158, v158
    v_exp_f32 v159, v159
    v_mfma_f32_32x32x16_bf16 v[176:191], a[8:11], v[48:51], 4.0
    s_add_u32 s34, s34, 8192
    v_exp_f32 v160, v160
    v_exp_f32 v161, v161
    v_exp_f32 v162, v162
    v_mfma_f32_32x32x16_bf16 v[176:191], a[12:15], v[52:55], v[176:191]
    s_waitcnt lgkmcnt(2)
    v_exp_f32 v163, v163
    v_exp_f32 v164, v164
    v_exp_f32 v165, v165
    v_exp_f32 v166, v166
    v_smfmac_f32_32x32x32_bf16 v[64:79], a[40:43], v[144:151], v5
    s_waitcnt vmcnt(0) lgkmcnt(0)
    s_barrier
    v_exp_f32 v167, v167
    v_exp_f32 v168, v168
    v_exp_f32 v169, v169
    v_smfmac_f32_16x16x64_bf16 v[128:131], v[20:23], v[144:151], v5
    ds_read_b128 a[0:3], v7 offset:0
    v_exp_f32 v170, v170
    v_smfmac_f32_32x32x32_bf16 v[64:79], a[44:47], v[152:159], v5
    v_exp_f32 v171, v171
    v_exp_f32 v172, v172
    v_exp_f32 v173, v173
    v_smfmac_f32_16x16x64_bf16 v[128:131], v[20:23], v[152:159], v5
    ds_read_b128 a[4:7], v8 offset:0
    v_exp_f32 v174, v174
    v_exp_f32 v175, v175
    v_mfma_f32_32x32x16_bf16 v[144:159], a[8:11], v[56:59], 4.0
    s_and_b32 s34, s34, 0x1ffff
    v_exp_f32 v176, v176
    v_exp_f32 v177, v177
    v_exp_f32 v178, v178
    v_mfma_f32_32x32x16_bf16 v[144:159], a[12:15], v[60:63], v[144:159]
    v_exp_f32 v179, v179
    v_exp_f32 v180, v180
    v_exp_f32 v181, v181
    v_exp_f32 v182, v182
    v_smfmac_f32_32x32x32_bf16 v[80:95], a[40:43], v[160:167], v5
    v_exp_f32 v183, v183
    v_exp_f32 v184, v184
    v_exp_f32 v185, v185
    v_smfmac_f32_16x16x64_bf16 v[132:135], v[20:23], v[160:167], v5
    ds_read_b64_tr_b16 a[32:33], v3 offset:32768
    v_exp_f32 v186, v186
    v_smfmac_f32_32x32x32_bf16 v[80:95], a[44:47], v[168:175], v5
    s_waitcnt lgkmcnt(1)
    v_exp_f32 v187, v187
    v_exp_f32 v188, v188
    v_exp_f32 v189, v189
    v_smfmac_f32_16x16x64_bf16 v[132:135], v[20:23], v[168:175], v5
    ds_read_b64_tr_b16 a[34:35], v3 offset:33024
    v_exp_f32 v190, v190
    v_exp_f32 v191, v191
    v_mfma_f32_32x32x16_bf16 v[160:175], a[0:3], v[32:35], 4.0
    v_exp_f32 v144, v144
    v_exp_f32 v145, v145
    v_exp_f32 v146, v146
    v_mfma_f32_32x32x16_bf16 v[160:175], a[4:7], v[36:39], v[160:175]
    v_exp_f32 v147, v147
    v_exp_f32 v148, v148
    v_exp_f32 v149, v149
    v_exp_f32 v150, v150
    v_smfmac_f32_32x32x32_bf16 v[96:111], a[40:43], v[176:183], v5
    s_cmp_eq_u32 s34, s58
    s_cselect_b32 s34, s3, s34
    v_exp_f32 v151, v151
    v_exp_f32 v152, v152
    v_exp_f32 v153, v153
    v_smfmac_f32_16x16x64_bf16 v[136:139], v[20:23], v[176:183], v5
    ds_read_b64_tr_b16 a[36:37], v3 offset:33792
    v_exp_f32 v154, v154
    v_smfmac_f32_32x32x32_bf16 v[96:111], a[44:47], v[184:191], v5
    v_exp_f32 v155, v155
    v_exp_f32 v156, v156
    v_exp_f32 v157, v157
    v_smfmac_f32_16x16x64_bf16 v[136:139], v[20:23], v[184:191], v5
    ds_read_b64_tr_b16 a[38:39], v3 offset:34048
    v_exp_f32 v158, v158
    v_exp_f32 v159, v159
    v_mfma_f32_32x32x16_bf16 v[176:191], a[0:3], v[40:43], 4.0
    v_exp_f32 v160, v160
    v_exp_f32 v161, v161
    v_exp_f32 v162, v162
    v_mfma_f32_32x32x16_bf16 v[176:191], a[4:7], v[44:47], v[176:191]
    v_exp_f32 v163, v163
    v_exp_f32 v164, v164
    v_exp_f32 v165, v165
    v_exp_f32 v166, v166
    v_smfmac_f32_32x32x32_bf16 v[112:127], a[40:43], v[144:151], v5
    v_exp_f32 v167, v167
    v_exp_f32 v168, v168
    v_exp_f32 v169, v169
    v_smfmac_f32_16x16x64_bf16 v[140:143], v[20:23], v[144:151], v5
    buffer_store_dwordx4 v[24:27], v4, s[20:23], s34 offen sc1
    v_exp_f32 v170, v170
    v_smfmac_f32_32x32x32_bf16 v[112:127], a[44:47], v[152:159], v5
    v_exp_f32 v171, v171
    v_exp_f32 v172, v172
    v_exp_f32 v173, v173
    v_smfmac_f32_16x16x64_bf16 v[140:143], v[20:23], v[152:159], v5
    buffer_store_dwordx4 v[28:31], v4, s[20:23], s34 offen offset:1024 sc1
    v_exp_f32 v174, v174
    v_exp_f32 v175, v175
    v_mfma_f32_32x32x16_bf16 v[144:159], a[0:3], v[48:51], 4.0
    v_exp_f32 v176, v176
    v_exp_f32 v177, v177
    v_exp_f32 v178, v178
    v_mfma_f32_32x32x16_bf16 v[144:159], a[4:7], v[52:55], v[144:159]
    s_waitcnt lgkmcnt(0)
    v_exp_f32 v179, v179
    v_exp_f32 v180, v180
    v_exp_f32 v181, v181
    v_exp_f32 v182, v182
    v_smfmac_f32_32x32x32_bf16 v[64:79], a[32:35], v[160:167], v5
    v_exp_f32 v183, v183
    v_exp_f32 v184, v184
    v_exp_f32 v185, v185
    v_smfmac_f32_16x16x64_bf16 v[128:131], v[20:23], v[160:167], v5
    ds_read_b128 a[8:11], v7 offset:2048
    v_exp_f32 v186, v186
    v_smfmac_f32_32x32x32_bf16 v[64:79], a[36:39], v[168:175], v5
    v_exp_f32 v187, v187
    v_exp_f32 v188, v188
    v_exp_f32 v189, v189
    v_smfmac_f32_16x16x64_bf16 v[128:131], v[20:23], v[168:175], v5
    ds_read_b128 a[12:15], v8 offset:2048
    v_exp_f32 v190, v190
    v_exp_f32 v191, v191
    v_mfma_f32_32x32x16_bf16 v[160:175], a[0:3], v[56:59], 4.0
    v_exp_f32 v144, v144
    v_exp_f32 v145, v145
    v_exp_f32 v146, v146
    v_mfma_f32_32x32x16_bf16 v[160:175], a[4:7], v[60:63], v[160:175]
    v_exp_f32 v147, v147
    v_exp_f32 v148, v148
    v_exp_f32 v149, v149
    v_exp_f32 v150, v150
    v_smfmac_f32_32x32x32_bf16 v[80:95], a[32:35], v[176:183], v5
    v_exp_f32 v151, v151
    v_exp_f32 v152, v152
    v_exp_f32 v153, v153
    v_smfmac_f32_16x16x64_bf16 v[132:135], v[20:23], v[176:183], v5
    ds_read_b64_tr_b16 a[40:41], v3 offset:34816
    v_exp_f32 v154, v154
    v_smfmac_f32_32x32x32_bf16 v[80:95], a[36:39], v[184:191], v5
    s_waitcnt lgkmcnt(1)
    v_exp_f32 v155, v155
    v_exp_f32 v156, v156
    v_exp_f32 v157, v157
    v_smfmac_f32_16x16x64_bf16 v[132:135], v[20:23], v[184:191], v5
    ds_read_b64_tr_b16 a[42:43], v3 offset:35072
    v_exp_f32 v158, v158
    v_exp_f32 v159, v159
    v_mfma_f32_32x32x16_bf16 v[176:191], a[8:11], v[32:35], 4.0
    v_exp_f32 v160, v160
    v_exp_f32 v161, v161
    v_exp_f32 v162, v162
    v_mfma_f32_32x32x16_bf16 v[176:191], a[12:15], v[36:39], v[176:191]
    v_exp_f32 v163, v163
    v_exp_f32 v164, v164
    v_exp_f32 v165, v165
    v_exp_f32 v166, v166
    v_smfmac_f32_32x32x32_bf16 v[96:111], a[32:35], v[144:151], v5
    v_exp_f32 v167, v167
    v_exp_f32 v168, v168
    v_exp_f32 v169, v169
    v_smfmac_f32_16x16x64_bf16 v[136:139], v[20:23], v[144:151], v5
    ds_read_b64_tr_b16 a[44:45], v3 offset:35840
    v_exp_f32 v170, v170
    v_smfmac_f32_32x32x32_bf16 v[96:111], a[36:39], v[152:159], v5
    v_exp_f32 v171, v171
    v_exp_f32 v172, v172
    v_exp_f32 v173, v173
    v_smfmac_f32_16x16x64_bf16 v[136:139], v[20:23], v[152:159], v5
    ds_read_b64_tr_b16 a[46:47], v3 offset:36096
    v_exp_f32 v174, v174
    v_exp_f32 v175, v175
    v_mfma_f32_32x32x16_bf16 v[144:159], a[8:11], v[40:43], 4.0
L_pad3:
    s_cbranch_vccnz L_hop3
    v_exp_f32 v176, v176
    v_exp_f32 v177, v177
    v_exp_f32 v178, v178
    v_mfma_f32_32x32x16_bf16 v[144:159], a[12:15], v[44:47], v[144:159]
    v_exp_f32 v179, v179
    v_exp_f32 v180, v180
    v_exp_f32 v181, v181
    v_exp_f32 v182, v182
    v_smfmac_f32_32x32x32_bf16 v[112:127], a[32:35], v[160:167], v5
    v_exp_f32 v183, v183
    v_exp_f32 v184, v184
    v_exp_f32 v185, v185
    v_smfmac_f32_16x16x64_bf16 v[140:143], v[20:23], v[160:167], v5
    v_exp_f32 v186, v186
    v_smfmac_f32_32x32x32_bf16 v[112:127], a[36:39], v[168:175], v5
    v_exp_f32 v187, v187
    v_exp_f32 v188, v188
    v_exp_f32 v189, v189
    v_smfmac_f32_16x16x64_bf16 v[140:143], v[20:23], v[168:175], v5
    v_exp_f32 v190, v190
    v_exp_f32 v191, v191
    v_mfma_f32_32x32x16_bf16 v[160:175], a[8:11], v[48:51], 4.0
    v_exp_f32 v144, v144
    v_exp_f32 v145, v145
    v_exp_f32 v146, v146
    v_mfma_f32_32x32x16_bf16 v[160:175], a[12:15], v[52:55], v[160:175]
    s_waitcnt lgkmcnt(0)
    v_exp_f32 v147, v147
    v_exp_f32 v148, v148
    v_exp_f32 v149, v149
    v_exp_f32 v150, v150
    v_smfmac_f32_32x32x32_bf16 v[64:79], a[40:43], v[176:183], v5
    v_exp_f32 v151, v151
    v_exp_f32 v152, v152
    v_exp_f32 v153, v153
    v_smfmac_f32_16x16x64_bf16 v[128:131], v[20:23], v[176:183], v5
    ds_read_b128 a[0:3], v7 offset:4096
    v_exp_f32 v154, v154
    v_smfmac_f32_32x32x32_bf16 v[64:79], a[44:47], v[184:191], v5
    v_exp_f32 v155, v155
    v_exp_f32 v156, v156
    v_exp_f32 v157, v157
    v_smfmac_f32_16x16x64_bf16 v[128:131], v[20:23], v[184:191], v5
    ds_read_b128 a[4:7], v8 offset:4096
    v_exp_f32 v158, v158
    v_exp_f32 v159, v159
    v_mfma_f32_32x32x16_bf16 v[176:191], a[8:11], v[56:59], 4.0
    v_exp_f32 v160, v160
    v_exp_f32 v161, v161
    v_exp_f32 v162, v162
    v_mfma_f32_32x32x16_bf16 v[176:191], a[12:15], v[60:63], v[176:191]
    v_exp_f32 v163, v163
    v_exp_f32 v164, v164
    v_exp_f32 v165, v165
    v_exp_f32 v166, v166
    v_smfmac_f32_32x32x32_bf16 v[80:95], a[40:43], v[144:151], v5
    v_exp_f32 v167, v167
    v_exp_f32 v168, v168
    v_exp_f32 v169, v169
    v_smfmac_f32_16x16x64_bf16 v[132:135], v[20:23], v[144:151], v5
    ds_read_b64_tr_b16 a[32:33], v3 offset:36864
    v_exp_f32 v170, v170
    v_smfmac_f32_32x32x32_bf16 v[80:95], a[44:47], v[152:159], v5
    s_waitcnt lgkmcnt(1)
    v_exp_f32 v171, v171
    v_exp_f32 v172, v172
    v_exp_f32 v173, v173
    v_smfmac_f32_16x16x64_bf16 v[132:135], v[20:23], v[152:159], v5
    ds_read_b64_tr_b16 a[34:35], v3 offset:37120
    v_exp_f32 v174, v174
    v_exp_f32 v175, v175
    v_mfma_f32_32x32x16_bf16 v[144:159], a[0:3], v[32:35], 4.0
    v_exp_f32 v176, v176
    v_exp_f32 v177, v177
    v_exp_f32 v178, v178
    v_mfma_f32_32x32x16_bf16 v[144:159], a[4:7], v[36:39], v[144:159]
    v_exp_f32 v179, v179
    v_exp_f32 v180, v180
    v_exp_f32 v181, v181
    v_exp_f32 v182, v182
    v_smfmac_f32_32x32x32_bf16 v[96:111], a[40:43], v[160:167], v5
    v_exp_f32 v183, v183
    v_exp_f32 v184, v184
    v_exp_f32 v185, v185
    v_smfmac_f32_16x16x64_bf16 v[136:139], v[20:23], v[160:167], v5
    ds_read_b64_tr_b16 a[36:37], v3 offset:37888
    v_exp_f32 v186, v186
    v_smfmac_f32_32x32x32_bf16 v[96:111], a[44:47], v[168:175], v5
    v_exp_f32 v187, v187
    v_exp_f32 v188, v188
    v_exp_f32 v189, v189
    v_smfmac_f32_16x16x64_bf16 v[136:139], v[20:23], v[168:175], v5
    ds_read_b64_tr_b16 a[38:39], v3 offset:38144
    v_exp_f32 v190, v190
    v_exp_f32 v191, v191
    v_mfma_f32_32x32x16_bf16 v[160:175], a[0:3], v[40:43], 4.0
    v_exp_f32 v144, v144
    v_exp_f32 v145, v145
    v_exp_f32 v146, v146
    v_mfma_f32_32x32x16_bf16 v[160:175], a[4:7], v[44:47], v[160:175]
    v_exp_f32 v147, v147
    v_exp_f32 v148, v148
    v_exp_f32 v149, v149
    v_exp_f32 v150, v150
    v_smfmac_f32_32x32x32_bf16 v[112:127], a[40:43], v[176:183], v5
    v_exp_f32 v151, v151
    v_exp_f32 v152, v152
    v_exp_f32 v153, v153
    v_smfmac_f32_16x16x64_bf16 v[140:143], v[20:23], v[176:183], v5
    v_exp_f32 v154, v154
    v_smfmac_f32_32x32x32_bf16 v[112:127], a[44:47], v[184:191], v5
    v_exp_f32 v155, v155
    v_exp_f32 v156, v156
    v_exp_f32 v157, v157
    v_smfmac_f32_16x16x64_bf16 v[140:143], v[20:23], v[184:191], v5
    v_exp_f32 v158, v158
    v_exp_f32 v159, v159
    v_mfma_f32_32x32x16_bf16 v[176:191], a[0:3], v[48:51], 4.0
    v_exp_f32 v160, v160
    v_exp_f32 v161, v161
    v_exp_f32 v162, v162
    v_mfma_f32_32x32x16_bf16 v[176:191], a[4:7], v[52:55], v[176:191]
    s_waitcnt lgkmcnt(0)
    v_exp_f32 v163, v163
    v_exp_f32 v164, v164
    v_exp_f32 v165, v165
    v_exp_f32 v166, v166
    v_smfmac_f32_32x32x32_bf16 v[64:79], a[32:35], v[144:151], v5
    v_exp_f32 v167, v167
    v_exp_f32 v168, v168
    v_exp_f32 v169, v169
    v_smfmac_f32_16x16x64_bf16 v[128:131], v[20:23], v[144:151], v5
    ds_read_b128 a[8:11], v7 offset:6144
    v_exp_f32 v170, v170
    v_smfmac_f32_32x32x32_bf16 v[64:79], a[36:39], v[152:159], v5
    v_exp_f32 v171, v171
    v_exp_f32 v172, v172
    v_exp_f32 v173, v173
    v_smfmac_f32_16x16x64_bf16 v[128:131], v[20:23], v[152:159], v5
    ds_read_b128 a[12:15], v8 offset:6144
    v_exp_f32 v174, v174
    v_exp_f32 v175, v175
    v_mfma_f32_32x32x16_bf16 v[144:159], a[0:3], v[56:59], 4.0
    v_exp_f32 v176, v176
    v_exp_f32 v177, v177
    v_exp_f32 v178, v178
    v_mfma_f32_32x32x16_bf16 v[144:159], a[4:7], v[60:63], v[144:159]
    v_exp_f32 v179, v179
    v_exp_f32 v180, v180
    v_exp_f32 v181, v181
    v_exp_f32 v182, v182
    v_smfmac_f32_32x32x32_bf16 v[80:95], a[32:35], v[160:167], v5
    v_exp_f32 v183, v183
    v_exp_f32 v184, v184
    v_exp_f32 v185, v185
    v_smfmac_f32_16x16x64_bf16 v[132:135], v[20:23], v[160:167], v5
    ds_read_b64_tr_b16 a[40:41], v3 offset:38912
    v_exp_f32 v186, v186
    v_smfmac_f32_32x32x32_bf16 v[80:95], a[36:39], v[168:175], v5
    s_waitcnt lgkmcnt(1)
    v_exp_f32 v187, v187
    v_exp_f32 v188, v188
    v_exp_f32 v189, v189
    v_smfmac_f32_16x16x64_bf16 v[132:135], v[20:23], v[168:175], v5
    ds_read_b64_tr_b16 a[42:43], v3 offset:39168
    v_exp_f32 v190, v190
    v_exp_f32 v191, v191
    v_mfma_f32_32x32x16_bf16 v[160:175], a[8:11], v[32:35], 4.0
    v_exp_f32 v144, v144
    v_exp_f32 v145, v145
    v_exp_f32 v146, v146
    v_mfma_f32_32x32x16_bf16 v[160:175], a[12:15], v[36:39], v[160:175]
    v_exp_f32 v147, v147
    v_exp_f32 v148, v148
    v_exp_f32 v149, v149
    v_exp_f32 v150, v150
    v_smfmac_f32_32x32x32_bf16 v[96:111], a[32:35], v[176:183], v5
    v_exp_f32 v151, v151
    v_exp_f32 v152, v152
    v_exp_f32 v153, v153
    v_smfmac_f32_16x16x64_bf16 v[136:139], v[20:23], v[176:183], v5
    ds_read_b64_tr_b16 a[44:45], v3 offset:39936
    v_exp_f32 v154, v154
    v_smfmac_f32_32x32x32_bf16 v[96:111], a[36:39], v[184:191], v5
    v_exp_f32 v155, v155
    v_exp_f32 v156, v156
    v_exp_f32 v157, v157
    v_smfmac_f32_16x16x64_bf16 v[136:139], v[20:23], v[184:191], v5
    ds_read_b64_tr_b16 a[46:47], v3 offset:40192
    v_exp_f32 v158, v158
    v_exp_f32 v159, v159
    v_mfma_f32_32x32x16_bf16 v[176:191], a[8:11], v[40:43], 4.0
    v_exp_f32 v160, v160
    v_exp_f32 v161, v161
    v_exp_f32 v162, v162
    v_mfma_f32_32x32x16_bf16 v[176:191], a[12:15], v[44:47], v[176:191]
    v_exp_f32 v163, v163
    v_exp_f32 v164, v164
    v_exp_f32 v165, v165
    v_exp_f32 v166, v166
    v_smfmac_f32_32x32x32_bf16 v[112:127], a[32:35], v[144:151], v5
    v_exp_f32 v167, v167
    v_exp_f32 v168, v168
    v_exp_f32 v169, v169
    v_smfmac_f32_16x16x64_bf16 v[140:143], v[20:23], v[144:151], v5
    v_exp_f32 v170, v170
    v_smfmac_f32_32x32x32_bf16 v[112:127], a[36:39], v[152:159], v5
    v_exp_f32 v171, v171
    v_exp_f32 v172, v172
    v_exp_f32 v173, v173
    v_smfmac_f32_16x16x64_bf16 v[140:143], v[20:23], v[152:159], v5
    v_exp_f32 v174, v174
    v_exp_f32 v175, v175
    v_mfma_f32_32x32x16_bf16 v[144:159], a[8:11], v[48:51], 4.0
    v_exp_f32 v176, v176
    v_exp_f32 v177, v177
    v_exp_f32 v178, v178
    v_mfma_f32_32x32x16_bf16 v[144:159], a[12:15], v[52:55], v[144:159]
    s_waitcnt lgkmcnt(0)
    v_exp_f32 v179, v179
    v_exp_f32 v180, v180
    v_exp_f32 v181, v181
    v_exp_f32 v182, v182
    v_smfmac_f32_32x32x32_bf16 v[64:79], a[40:43], v[160:167], v5
    s_waitcnt vmcnt(0)
    s_barrier
    v_exp_f32 v183, v183
    v_exp_f32 v184, v184
    v_exp_f32 v185, v185
    v_smfmac_f32_16x16x64_bf16 v[128:131], v[20:23], v[160:167], v5
    ds_read_b128 a[0:3], v7 offset:8192
    v_exp_f32 v186, v186
    v_smfmac_f32_32x32x32_bf16 v[64:79], a[44:47], v[168:175], v5
    v_exp_f32 v187, v187
    v_exp_f32 v188, v188
    v_exp_f32 v189, v189
    v_smfmac_f32_16x16x64_bf16 v[128:131], v[20:23], v[168:175], v5
    ds_read_b128 a[4:7], v8 offset:8192
    v_exp_f32 v190, v190
    v_exp_f32 v191, v191
    v_mfma_f32_32x32x16_bf16 v[160:175], a[8:11], v[56:59], 4.0
    v_exp_f32 v144, v144
    v_exp_f32 v145, v145
    v_exp_f32 v146, v146
    v_mfma_f32_32x32x16_bf16 v[160:175], a[12:15], v[60:63], v[160:175]
    v_exp_f32 v147, v147
    v_exp_f32 v148, v148
    v_exp_f32 v149, v149
    v_exp_f32 v150, v150
    v_smfmac_f32_32x32x32_bf16 v[80:95], a[40:43], v[176:183], v5
    v_exp_f32 v151, v151
    v_exp_f32 v152, v152
    v_exp_f32 v153, v153
    v_smfmac_f32_16x16x64_bf16 v[132:135], v[20:23], v[176:183], v5
    ds_read_b64_tr_b16 a[32:33], v3 offset:40960
    v_exp_f32 v154, v154
    v_smfmac_f32_32x32x32_bf16 v[80:95], a[44:47], v[184:191], v5
    s_waitcnt lgkmcnt(1)
    v_exp_f32 v155, v155
    v_exp_f32 v156, v156
    v_exp_f32 v157, v157
    v_smfmac_f32_16x16x64_bf16 v[132:135], v[20:23], v[184:191], v5
    ds_read_b64_tr_b16 a[34:35], v3 offset:41216
    v_exp_f32 v158, v158
    v_exp_f32 v159, v159
    v_mfma_f32_32x32x16_bf16 v[176:191], a[0:3], v[32:35], 4.0
    v_exp_f32 v160, v160
    v_exp_f32 v161, v161
    v_exp_f32 v162, v162
    v_mfma_f32_32x32x16_bf16 v[176:191], a[4:7], v[36:39], v[176:191]
    v_exp_f32 v163, v163
    v_exp_f32 v164, v164
    v_exp_f32 v165, v165
    v_exp_f32 v166, v166
    v_smfmac_f32_32x32x32_bf16 v[96:111], a[40:43], v[144:151], v5
    v_exp_f32 v167, v167
    v_exp_f32 v168, v168
    v_exp_f32 v169, v169
    v_smfmac_f32_16x16x64_bf16 v[136:139], v[20:23], v[144:151], v5
    ds_read_b64_tr_b16 a[36:37], v3 offset:41984
    v_exp_f32 v170, v170
    v_smfmac_f32_32x32x32_bf16 v[96:111], a[44:47], v[152:159], v5
    v_exp_f32 v171, v171
    v_exp_f32 v172, v172
    v_exp_f32 v173, v173
    v_smfmac_f32_16x16x64_bf16 v[136:139], v[20:23], v[152:159], v5
    ds_read_b64_tr_b16 a[38:39], v3 offset:42240
    v_exp_f32 v174, v174
    v_exp_f32 v175, v175
    v_mfma_f32_32x32x16_bf16 v[144:159], a[0:3], v[40:43], 4.0
    v_exp_f32 v176, v176
    v_exp_f32 v177, v177
    v_exp_f32 v178, v178
    v_mfma_f32_32x32x16_bf16 v[144:159], a[4:7], v[44:47], v[144:159]
    v_exp_f32 v179, v179
    v_exp_f32 v180, v180
    v_exp_f32 v181, v181
    v_exp_f32 v182, v182
    v_smfmac_f32_32x32x32_bf16 v[112:127], a[40:43], v[160:167], v5
    v_exp_f32 v183, v183
    v_exp_f32 v184, v184
    v_exp_f32 v185, v185
    v_smfmac_f32_16x16x64_bf16 v[140:143], v[20:23], v[160:167], v5
    v_exp_f32 v186, v186
    v_smfmac_f32_32x32x32_bf16 v[112:127], a[44:47], v[168:175], v5
    v_exp_f32 v187, v187
    v_exp_f32 v188, v188
    v_exp_f32 v189, v189
    v_smfmac_f32_16x16x64_bf16 v[140:143], v[20:23], v[168:175], v5
    v_exp_f32 v190, v190
    v_exp_f32 v191, v191
    v_mfma_f32_32x32x16_bf16 v[160:175], a[0:3], v[48:51], 4.0
    v_exp_f32 v144, v144
    v_exp_f32 v145, v145
    v_exp_f32 v146, v146
    v_mfma_f32_32x32x16_bf16 v[160:175], a[4:7], v[52:55], v[160:175]
    s_waitcnt lgkmcnt(0)
    v_exp_f32 v147, v147
    v_exp_f32 v148, v148
    v_exp_f32 v149, v149
    v_exp_f32 v150, v150
    v_smfmac_f32_32x32x32_bf16 v[64:79], a[32:35], v[176:183], v5
    v_exp_f32 v151, v151
    v_exp_f32 v152, v152
    v_exp_f32 v153, v153
    v_smfmac_f32_16x16x64_bf16 v[128:131], v[20:23], v[176:183], v5
    ds_read_b128 a[8:11], v7 offset:10240
    v_exp_f32 v154, v154
    v_smfmac_f32_32x32x32_bf16 v[64:79], a[36:39], v[184:191], v5
    v_exp_f32 v155, v155
    v_exp_f32 v156, v156
    v_exp_f32 v157, v157
    v_smfmac_f32_16x16x64_bf16 v[128:131], v[20:23], v[184:191], v5
    ds_read_b128 a[12:15], v8 offset:10240
    v_exp_f32 v158, v158
    v_exp_f32 v159, v159
    v_mfma_f32_32x32x16_bf16 v[176:191], a[0:3], v[56:59], 4.0
    v_exp_f32 v160, v160
    v_exp_f32 v161, v161
    v_exp_f32 v162, v162
    v_mfma_f32_32x32x16_bf16 v[176:191], a[4:7], v[60:63], v[176:191]
    v_exp_f32 v163, v163
    v_exp_f32 v164, v164
    v_exp_f32 v165, v165
    v_exp_f32 v166, v166
    v_smfmac_f32_32x32x32_bf16 v[80:95], a[32:35], v[144:151], v5
    v_exp_f32 v167, v167
    v_exp_f32 v168, v168
    v_exp_f32 v169, v169
    v_smfmac_f32_16x16x64_bf16 v[132:135], v[20:23], v[144:151], v5
    ds_read_b64_tr_b16 a[40:41], v3 offset:43008
    v_exp_f32 v170, v170
    v_smfmac_f32_32x32x32_bf16 v[80:95], a[36:39], v[152:159], v5
    s_waitcnt lgkmcnt(1)
    v_exp_f32 v171, v171
    v_exp_f32 v172, v172
    v_exp_f32 v173, v173
    v_smfmac_f32_16x16x64_bf16 v[132:135], v[20:23], v[152:159], v5
    ds_read_b64_tr_b16 a[42:43], v3 offset:43264
    v_exp_f32 v174, v174
    v_exp_f32 v175, v175
    v_mfma_f32_32x32x16_bf16 v[144:159], a[8:11], v[32:35], 4.0
    v_exp_f32 v176, v176
    v_exp_f32 v177, v177
    v_exp_f32 v178, v178
    v_mfma_f32_32x32x16_bf16 v[144:159], a[12:15], v[36:39], v[144:159]
    v_exp_f32 v179, v179
    v_exp_f32 v180, v180
    v_exp_f32 v181, v181
    v_exp_f32 v182, v182
    v_smfmac_f32_32x32x32_bf16 v[96:111], a[32:35], v[160:167], v5
    v_exp_f32 v183, v183
    v_exp_f32 v184, v184
    v_exp_f32 v185, v185
    v_smfmac_f32_16x16x64_bf16 v[136:139], v[20:23], v[160:167], v5
    ds_read_b64_tr_b16 a[44:45], v3 offset:44032
    v_exp_f32 v186, v186
    v_smfmac_f32_32x32x32_bf16 v[96:111], a[36:39], v[168:175], v5
    v_exp_f32 v187, v187
    v_exp_f32 v188, v188
    v_exp_f32 v189, v189
    v_smfmac_f32_16x16x64_bf16 v[136:139], v[20:23], v[168:175], v5
    ds_read_b64_tr_b16 a[46:47], v3 offset:44288
    v_exp_f32 v190, v190
    v_exp_f32 v191, v191
    v_mfma_f32_32x32x16_bf16 v[160:175], a[8:11], v[40:43], 4.0
    v_exp_f32 v144, v144
    v_exp_f32 v145, v145
    v_exp_f32 v146, v146
    v_mfma_f32_32x32x16_bf16 v[160:175], a[12:15], v[44:47], v[160:175]
    v_exp_f32 v147, v147
    v_exp_f32 v148, v148
    v_exp_f32 v149, v149
    v_exp_f32 v150, v150
    v_smfmac_f32_32x32x32_bf16 v[112:127], a[32:35], v[176:183], v5
    v_exp_f32 v151, v151
    v_exp_f32 v152, v152
    v_exp_f32 v153, v153
    v_smfmac_f32_16x16x64_bf16 v[140:143], v[20:23], v[176:183], v5
    v_exp_f32 v154, v154
    v_smfmac_f32_32x32x32_bf16 v[112:127], a[36:39], v[184:191], v5
    v_exp_f32 v155, v155
    v_exp_f32 v156, v156
    v_exp_f32 v157, v157
    v_smfmac_f32_16x16x64_bf16 v[140:143], v[20:23], v[184:191], v5
    v_exp_f32 v158, v158
    v_exp_f32 v159, v159
    v_mfma_f32_32x32x16_bf16 v[176:191], a[8:11], v[48:51], 4.0
    v_exp_f32 v160, v160
    v_exp_f32 v161, v161
    v_exp_f32 v162, v162
    v_mfma_f32_32x32x16_bf16 v[176:191], a[12:15], v[52:55], v[176:191]
    s_waitcnt lgkmcnt(0)
    v_exp_f32 v163, v163
    v_exp_f32 v164, v164
    v_exp_f32 v165, v165
    v_exp_f32 v166, v166
    v_smfmac_f32_32x32x32_bf16 v[64:79], a[40:43], v[144:151], v5
    v_exp_f32 v167, v167
    v_exp_f32 v168, v168
    v_exp_f32 v169, v169
    v_smfmac_f32_16x16x64_bf16 v[128:131], v[20:23], v[144:151], v5
    ds_read_b128 a[0:3], v7 offset:12288
    v_exp_f32 v170, v170
    v_smfmac_f32_32x32x32_bf16 v[64:79], a[44:47], v[152:159], v5
    v_exp_f32 v171, v171
    v_exp_f32 v172, v172
    v_exp_f32 v173, v173
    v_smfmac_f32_16x16x64_bf16 v[128:131], v[20:23], v[152:159], v5
    ds_read_b128 a[4:7], v8 offset:12288
    v_exp_f32 v174, v174
    v_exp_f32 v175, v175
    v_mfma_f32_32x32x16_bf16 v[144:159], a[8:11], v[56:59], 4.0
    v_exp_f32 v176, v176
    v_exp_f32 v177, v177
    v_exp_f32 v178, v178
    v_mfma_f32_32x32x16_bf16 v[144:159], a[12:15], v[60:63], v[144:159]
    v_exp_f32 v179, v179
    v_exp_f32 v180, v180
    v_exp_f32 v181, v181
    v_exp_f32 v182, v182
    v_smfmac_f32_32x32x32_bf16 v[80:95], a[40:43], v[160:167], v5
    v_exp_f32 v183, v183
    v_exp_f32 v184, v184
    v_exp_f32 v185, v185
    v_smfmac_f32_16x16x64_bf16 v[132:135], v[20:23], v[160:167], v5
    ds_read_b64_tr_b16 a[32:33], v3 offset:45056
    v_exp_f32 v186, v186
    v_smfmac_f32_32x32x32_bf16 v[80:95], a[44:47], v[168:175], v5
    s_waitcnt lgkmcnt(1)
    v_exp_f32 v187, v187
    v_exp_f32 v188, v188
    v_exp_f32 v189, v189
    v_smfmac_f32_16x16x64_bf16 v[132:135], v[20:23], v[168:175], v5
    ds_read_b64_tr_b16 a[34:35], v3 offset:45312
    v_exp_f32 v190, v190
    v_exp_f32 v191, v191
    v_mfma_f32_32x32x16_bf16 v[160:175], a[0:3], v[32:35], 4.0
    v_exp_f32 v144, v144
    v_exp_f32 v145, v145
    v_exp_f32 v146, v146
    v_mfma_f32_32x32x16_bf16 v[160:175], a[4:7], v[36:39], v[160:175]
    v_exp_f32 v147, v147
    v_exp_f32 v148, v148
    v_exp_f32 v149, v149
    v_exp_f32 v150, v150
    v_smfmac_f32_32x32x32_bf16 v[96:111], a[40:43], v[176:183], v5
    v_exp_f32 v151, v151
    v_exp_f32 v152, v152
    v_exp_f32 v153, v153
    v_smfmac_f32_16x16x64_bf16 v[136:139], v[20:23], v[176:183], v5
    ds_read_b64_tr_b16 a[36:37], v3 offset:46080
    v_exp_f32 v154, v154
    v_smfmac_f32_32x32x32_bf16 v[96:111], a[44:47], v[184:191], v5
    v_exp_f32 v155, v155
    v_exp_f32 v156, v156
    v_exp_f32 v157, v157
    v_smfmac_f32_16x16x64_bf16 v[136:139], v[20:23], v[184:191], v5
    ds_read_b64_tr_b16 a[38:39], v3 offset:46336
    v_exp_f32 v158, v158
    v_exp_f32 v159, v159
    v_mfma_f32_32x32x16_bf16 v[176:191], a[0:3], v[40:43], 4.0
    v_exp_f32 v160, v160
    v_exp_f32 v161, v161
    v_exp_f32 v162, v162
    v_mfma_f32_32x32x16_bf16 v[176:191], a[4:7], v[44:47], v[176:191]
    v_exp_f32 v163, v163
    v_exp_f32 v164, v164
    v_exp_f32 v165, v165
    v_exp_f32 v166, v166
    v_smfmac_f32_32x32x32_bf16 v[112:127], a[40:43], v[144:151], v5
    v_exp_f32 v167, v167
    v_exp_f32 v168, v168
    v_exp_f32 v169, v169
    v_smfmac_f32_16x16x64_bf16 v[140:143], v[20:23], v[144:151], v5
    v_exp_f32 v170, v170
    v_smfmac_f32_32x32x32_bf16 v[112:127], a[44:47], v[152:159], v5
    v_exp_f32 v171, v171
    v_exp_f32 v172, v172
    v_exp_f32 v173, v173
    v_smfmac_f32_16x16x64_bf16 v[140:143], v[20:23], v[152:159], v5
    v_exp_f32 v174, v174
    v_exp_f32 v175, v175
    v_mfma_f32_32x32x16_bf16 v[144:159], a[0:3], v[48:51], 4.0
    v_exp_f32 v176, v176
    v_exp_f32 v177, v177
    v_exp_f32 v178, v178
    v_mfma_f32_32x32x16_bf16 v[144:159], a[4:7], v[52:55], v[144:159]
    s_waitcnt lgkmcnt(0)
    v_exp_f32 v179, v179
    v_exp_f32 v180, v180
    v_exp_f32 v181, v181
    v_exp_f32 v182, v182
    v_smfmac_f32_32x32x32_bf16 v[64:79], a[32:35], v[160:167], v5
    v_exp_f32 v183, v183
    v_exp_f32 v184, v184
    v_exp_f32 v185, v185
    v_smfmac_f32_16x16x64_bf16 v[128:131], v[20:23], v[160:167], v5
    ds_read_b128 a[8:11], v7 offset:14336
    v_exp_f32 v186, v186
    v_smfmac_f32_32x32x32_bf16 v[64:79], a[36:39], v[168:175], v5
    v_exp_f32 v187, v187
    v_exp_f32 v188, v188
    v_exp_f32 v189, v189
    v_smfmac_f32_16x16x64_bf16 v[128:131], v[20:23], v[168:175], v5
    ds_read_b128 a[12:15], v8 offset:14336
    v_exp_f32 v190, v190
    v_exp_f32 v191, v191
    v_mfma_f32_32x32x16_bf16 v[160:175], a[0:3], v[56:59], 4.0
    v_exp_f32 v144, v144
    v_exp_f32 v145, v145
    v_exp_f32 v146, v146
    v_mfma_f32_32x32x16_bf16 v[160:175], a[4:7], v[60:63], v[160:175]
    v_exp_f32 v147, v147
    v_exp_f32 v148, v148
    v_exp_f32 v149, v149
    v_exp_f32 v150, v150
    v_smfmac_f32_32x32x32_bf16 v[80:95], a[32:35], v[176:183], v5
    v_exp_f32 v151, v151
    v_exp_f32 v152, v152
    v_exp_f32 v153, v153
    v_smfmac_f32_16x16x64_bf16 v[132:135], v[20:23], v[176:183], v5
    ds_read_b64_tr_b16 a[40:41], v3 offset:47104
    v_exp_f32 v154, v154
    v_smfmac_f32_32x32x32_bf16 v[80:95], a[36:39], v[184:191], v5
    s_waitcnt lgkmcnt(1)
    v_exp_f32 v155, v155
    v_exp_f32 v156, v156
    v_exp_f32 v157, v157
    v_smfmac_f32_16x16x64_bf16 v[132:135], v[20:23], v[184:191], v5
    ds_read_b64_tr_b16 a[42:43], v3 offset:47360
    v_exp_f32 v158, v158
    v_exp_f32 v159, v159
    v_mfma_f32_32x32x16_bf16 v[176:191], a[8:11], v[32:35], 4.0
    v_exp_f32 v160, v160
    v_exp_f32 v161, v161
    v_exp_f32 v162, v162
    v_mfma_f32_32x32x16_bf16 v[176:191], a[12:15], v[36:39], v[176:191]
    v_exp_f32 v163, v163
    v_exp_f32 v164, v164
    v_exp_f32 v165, v165
    v_exp_f32 v166, v166
    v_smfmac_f32_32x32x32_bf16 v[96:111], a[32:35], v[144:151], v5
    v_exp_f32 v167, v167
    v_exp_f32 v168, v168
    v_exp_f32 v169, v169
    v_smfmac_f32_16x16x64_bf16 v[136:139], v[20:23], v[144:151], v5
    ds_read_b64_tr_b16 a[44:45], v3 offset:48128
    v_exp_f32 v170, v170
    v_smfmac_f32_32x32x32_bf16 v[96:111], a[36:39], v[152:159], v5
    v_exp_f32 v171, v171
    v_exp_f32 v172, v172
    v_exp_f32 v173, v173
    v_smfmac_f32_16x16x64_bf16 v[136:139], v[20:23], v[152:159], v5
    ds_read_b64_tr_b16 a[46:47], v3 offset:48384
    v_exp_f32 v174, v174
    v_exp_f32 v175, v175
    v_mfma_f32_32x32x16_bf16 v[144:159], a[8:11], v[40:43], 4.0
    v_exp_f32 v176, v176
    v_exp_f32 v177, v177
    v_exp_f32 v178, v178
    v_mfma_f32_32x32x16_bf16 v[144:159], a[12:15], v[44:47], v[144:159]
    v_exp_f32 v179, v179
    v_exp_f32 v180, v180
    v_exp_f32 v181, v181
    v_exp_f32 v182, v182
    v_smfmac_f32_32x32x32_bf16 v[112:127], a[32:35], v[160:167], v5
    v_exp_f32 v183, v183
    v_exp_f32 v184, v184
    v_exp_f32 v185, v185
    v_smfmac_f32_16x16x64_bf16 v[140:143], v[20:23], v[160:167], v5
    v_exp_f32 v186, v186
    v_smfmac_f32_32x32x32_bf16 v[112:127], a[36:39], v[168:175], v5
    v_exp_f32 v187, v187
    v_exp_f32 v188, v188
    v_exp_f32 v189, v189
    v_smfmac_f32_16x16x64_bf16 v[140:143], v[20:23], v[168:175], v5
    v_exp_f32 v190, v190
    v_exp_f32 v191, v191
    v_mfma_f32_32x32x16_bf16 v[160:175], a[8:11], v[48:51], 4.0
    v_exp_f32 v144, v144
    v_exp_f32 v145, v145
    v_exp_f32 v146, v146
    v_mfma_f32_32x32x16_bf16 v[160:175], a[12:15], v[52:55], v[160:175]
    s_waitcnt lgkmcnt(0)
    v_exp_f32 v147, v147
    v_exp_f32 v148, v148
    v_exp_f32 v149, v149
    v_exp_f32 v150, v150
    v_smfmac_f32_32x32x32_bf16 v[64:79], a[40:43], v[176:183], v5
    s_barrier
    v_exp_f32 v151, v151
    v_exp_f32 v152, v152
    v_exp_f32 v153, v153
    v_smfmac_f32_16x16x64_bf16 v[128:131], v[20:23], v[176:183], v5
    ds_read_b128 a[0:3], v7 offset:16384
    v_exp_f32 v154, v154
    v_smfmac_f32_32x32x32_bf16 v[64:79], a[44:47], v[184:191], v5
    v_exp_f32 v155, v155
    v_exp_f32 v156, v156
    v_exp_f32 v157, v157
    v_smfmac_f32_16x16x64_bf16 v[128:131], v[20:23], v[184:191], v5
    ds_read_b128 a[4:7], v8 offset:16384
    v_exp_f32 v158, v158
    v_exp_f32 v159, v159
    v_mfma_f32_32x32x16_bf16 v[176:191], a[8:11], v[56:59], 4.0
    v_exp_f32 v160, v160
    v_exp_f32 v161, v161
    v_exp_f32 v162, v162
    v_mfma_f32_32x32x16_bf16 v[176:191], a[12:15], v[60:63], v[176:191]
    v_exp_f32 v163, v163
    v_exp_f32 v164, v164
    v_exp_f32 v165, v165
    v_exp_f32 v166, v166
    v_smfmac_f32_32x32x32_bf16 v[80:95], a[40:43], v[144:151], v5
    v_exp_f32 v167, v167
    v_exp_f32 v168, v168
    v_exp_f32 v169, v169
    v_smfmac_f32_16x16x64_bf16 v[132:135], v[20:23], v[144:151], v5
    ds_read_b64_tr_b16 a[32:33], v3 offset:49152
    v_exp_f32 v170, v170
    v_smfmac_f32_32x32x32_bf16 v[80:95], a[44:47], v[152:159], v5
    s_waitcnt lgkmcnt(1)
    v_exp_f32 v171, v171
    v_exp_f32 v172, v172
    v_exp_f32 v173, v173
    v_smfmac_f32_16x16x64_bf16 v[132:135], v[20:23], v[152:159], v5
    ds_read_b64_tr_b16 a[34:35], v3 offset:49408
    v_exp_f32 v174, v174
    v_exp_f32 v175, v175
    v_mfma_f32_32x32x16_bf16 v[144:159], a[0:3], v[32:35], 4.0
    v_exp_f32 v176, v176
    v_exp_f32 v177, v177
    v_exp_f32 v178, v178
    v_mfma_f32_32x32x16_bf16 v[144:159], a[4:7], v[36:39], v[144:159]
    v_exp_f32 v179, v179
    v_exp_f32 v180, v180
    v_exp_f32 v181, v181
    v_exp_f32 v182, v182
    v_smfmac_f32_32x32x32_bf16 v[96:111], a[40:43], v[160:167], v5
    v_exp_f32 v183, v183
    v_exp_f32 v184, v184
    v_exp_f32 v185, v185
    v_smfmac_f32_16x16x64_bf16 v[136:139], v[20:23], v[160:167], v5
    ds_read_b64_tr_b16 a[36:37], v3 offset:50176
    v_exp_f32 v186, v186
    v_smfmac_f32_32x32x32_bf16 v[96:111], a[44:47], v[168:175], v5
    v_exp_f32 v187, v187
    v_exp_f32 v188, v188
    v_exp_f32 v189, v189
    v_smfmac_f32_16x16x64_bf16 v[136:139], v[20:23], v[168:175], v5
    ds_read_b64_tr_b16 a[38:39], v3 offset:50432
    v_exp_f32 v190, v190
    v_exp_f32 v191, v191
    v_mfma_f32_32x32x16_bf16 v[160:175], a[0:3], v[40:43], 4.0
    v_exp_f32 v144, v144
    v_exp_f32 v145, v145
    v_exp_f32 v146, v146
    v_mfma_f32_32x32x16_bf16 v[160:175], a[4:7], v[44:47], v[160:175]
    v_exp_f32 v147, v147
    v_exp_f32 v148, v148
    v_exp_f32 v149, v149
    v_exp_f32 v150, v150
    v_smfmac_f32_32x32x32_bf16 v[112:127], a[40:43], v[176:183], v5
    v_exp_f32 v151, v151
    v_exp_f32 v152, v152
    v_exp_f32 v153, v153
    v_smfmac_f32_16x16x64_bf16 v[140:143], v[20:23], v[176:183], v5
    v_exp_f32 v154, v154
    v_smfmac_f32_32x32x32_bf16 v[112:127], a[44:47], v[184:191], v5
    v_exp_f32 v155, v155
    v_exp_f32 v156, v156
    v_exp_f32 v157, v157
    v_smfmac_f32_16x16x64_bf16 v[140:143], v[20:23], v[184:191], v5
    v_exp_f32 v158, v158
    v_exp_f32 v159, v159
    v_mfma_f32_32x32x16_bf16 v[176:191], a[0:3], v[48:51], 4.0
    v_exp_f32 v160, v160
    v_exp_f32 v161, v161
    v_exp_f32 v162, v162
    v_mfma_f32_32x32x16_bf16 v[176:191], a[4:7], v[52:55], v[176:191]
    s_waitcnt lgkmcnt(0)
    v_exp_f32 v163, v163
    v_exp_f32 v164, v164
    v_exp_f32 v165, v165
    v_exp_f32 v166, v166
    v_smfmac_f32_32x32x32_bf16 v[64:79], a[32:35], v[144:151], v5
    v_exp_f32 v167, v167
    v_exp_f32 v168, v168
    v_exp_f32 v169, v169
    v_smfmac_f32_16x16x64_bf16 v[128:131], v[20:23], v[144:151], v5
    ds_read_b128 a[8:11], v7 offset:18432
    v_exp_f32 v170, v170
    v_smfmac_f32_32x32x32_bf16 v[64:79], a[36:39], v[152:159], v5
    v_exp_f32 v171, v171
    v_exp_f32 v172, v172
    v_exp_f32 v173, v173
    v_smfmac_f32_16x16x64_bf16 v[128:131], v[20:23], v[152:159], v5
    ds_read_b128 a[12:15], v8 offset:18432
    v_exp_f32 v174, v174
    v_exp_f32 v175, v175
    v_mfma_f32_32x32x16_bf16 v[144:159], a[0:3], v[56:59], 4.0
    v_exp_f32 v176, v176
    v_exp_f32 v177, v177
    v_exp_f32 v178, v178
    v_mfma_f32_32x32x16_bf16 v[144:159], a[4:7], v[60:63], v[144:159]
    v_exp_f32 v179, v179
    v_exp_f32 v180, v180
    v_exp_f32 v181, v181
    v_exp_f32 v182, v182
    v_smfmac_f32_32x32x32_bf16 v[80:95], a[32:35], v[160:167], v5
    v_exp_f32 v183, v183
    v_exp_f32 v184, v184
    v_exp_f32 v185, v185
    v_smfmac_f32_16x16x64_bf16 v[132:135], v[20:23], v[160:167], v5
    ds_read_b64_tr_b16 a[40:41], v3 offset:51200
    v_exp_f32 v186, v186
    v_smfmac_f32_32x32x32_bf16 v[80:95], a[36:39], v[168:175], v5
    s_waitcnt lgkmcnt(1)
    v_exp_f32 v187, v187
    v_exp_f32 v188, v188
    v_exp_f32 v189, v189
    v_smfmac_f32_16x16x64_bf16 v[132:135], v[20:23], v[168:175], v5
    ds_read_b64_tr_b16 a[42:43], v3 offset:51456
    v_exp_f32 v190, v190
    v_exp_f32 v191, v191
    v_mfma_f32_32x32x16_bf16 v[160:175], a[8:11], v[32:35], 4.0
    v_exp_f32 v144, v144
    v_exp_f32 v145, v145
    v_exp_f32 v146, v146
    v_mfma_f32_32x32x16_bf16 v[160:175], a[12:15], v[36:39], v[160:175]
    v_exp_f32 v147, v147
    v_exp_f32 v148, v148
    v_exp_f32 v149, v149
    v_exp_f32 v150, v150
    v_smfmac_f32_32x32x32_bf16 v[96:111], a[32:35], v[176:183], v5
    v_exp_f32 v151, v151
    v_exp_f32 v152, v152
    v_exp_f32 v153, v153
    v_smfmac_f32_16x16x64_bf16 v[136:139], v[20:23], v[176:183], v5
    ds_read_b64_tr_b16 a[44:45], v3 offset:52224
    v_exp_f32 v154, v154
    v_smfmac_f32_32x32x32_bf16 v[96:111], a[36:39], v[184:191], v5
    v_exp_f32 v155, v155
    v_exp_f32 v156, v156
    v_exp_f32 v157, v157
    v_smfmac_f32_16x16x64_bf16 v[136:139], v[20:23], v[184:191], v5
    ds_read_b64_tr_b16 a[46:47], v3 offset:52480
    v_exp_f32 v158, v158
    v_exp_f32 v159, v159
    v_mfma_f32_32x32x16_bf16 v[176:191], a[8:11], v[40:43], 4.0
    v_exp_f32 v160, v160
    v_exp_f32 v161, v161
    v_exp_f32 v162, v162
    v_mfma_f32_32x32x16_bf16 v[176:191], a[12:15], v[44:47], v[176:191]
    v_exp_f32 v163, v163
    v_exp_f32 v164, v164
    v_exp_f32 v165, v165
    v_exp_f32 v166, v166
    v_smfmac_f32_32x32x32_bf16 v[112:127], a[32:35], v[144:151], v5
L_pad4:
    s_cbranch_vccnz L_hop4
    v_exp_f32 v167, v167
    v_exp_f32 v168, v168
    v_exp_f32 v169, v169
    v_smfmac_f32_16x16x64_bf16 v[140:143], v[20:23], v[144:151], v5
    v_exp_f32 v170, v170
    v_smfmac_f32_32x32x32_bf16 v[112:127], a[36:39], v[152:159], v5
    v_exp_f32 v171, v171
    v_exp_f32 v172, v172
    v_exp_f32 v173, v173
    v_smfmac_f32_16x16x64_bf16 v[140:143], v[20:23], v[152:159], v5
    v_exp_f32 v174, v174
    v_exp_f32 v175, v175
    v_mfma_f32_32x32x16_bf16 v[144:159], a[8:11], v[48:51], 4.0
    v_exp_f32 v176, v176
    v_exp_f32 v177, v177
    v_exp_f32 v178, v178
    v_mfma_f32_32x32x16_bf16 v[144:159], a[12:15], v[52:55], v[144:159]
    s_waitcnt lgkmcnt(0)
    v_exp_f32 v179, v179
    v_exp_f32 v180, v180
    v_exp_f32 v181, v181
    v_exp_f32 v182, v182
    v_smfmac_f32_32x32x32_bf16 v[64:79], a[40:43], v[160:167], v5
    v_exp_f32 v183, v183
    v_exp_f32 v184, v184
    v_exp_f32 v185, v185
    v_smfmac_f32_16x16x64_bf16 v[128:131], v[20:23], v[160:167], v5
    ds_read_b128 a[0:3], v7 offset:20480
    v_exp_f32 v186, v186
    v_smfmac_f32_32x32x32_bf16 v[64:79], a[44:47], v[168:175], v5
    v_exp_f32 v187, v187
    v_exp_f32 v188, v188
    v_exp_f32 v189, v189
    v_smfmac_f32_16x16x64_bf16 v[128:131], v[20:23], v[168:175], v5
    ds_read_b128 a[4:7], v8 offset:20480
    v_exp_f32 v190, v190
    v_exp_f32 v191, v191
    v_mfma_f32_32x32x16_bf16 v[160:175], a[8:11], v[56:59], 4.0
    v_exp_f32 v144, v144
    v_exp_f32 v145, v145
    v_exp_f32 v146, v146
    v_mfma_f32_32x32x16_bf16 v[160:175], a[12:15], v[60:63], v[160:175]
    v_exp_f32 v147, v147
    v_exp_f32 v148, v148
    v_exp_f32 v149, v149
    v_exp_f32 v150, v150
    v_smfmac_f32_32x32x32_bf16 v[80:95], a[40:43], v[176:183], v5
    v_exp_f32 v151, v151
    v_exp_f32 v152, v152
    v_exp_f32 v153, v153
    v_smfmac_f32_16x16x64_bf16 v[132:135], v[20:23], v[176:183], v5
    ds_read_b64_tr_b16 a[32:33], v3 offset:53248
    v_exp_f32 v154, v154
    v_smfmac_f32_32x32x32_bf16 v[80:95], a[44:47], v[184:191], v5
    s_waitcnt lgkmcnt(1)
    v_exp_f32 v155, v155
    v_exp_f32 v156, v156
    v_exp_f32 v157, v157
    v_smfmac_f32_16x16x64_bf16 v[132:135], v[20:23], v[184:191], v5
    ds_read_b64_tr_b16 a[34:35], v3 offset:53504
    v_exp_f32 v158, v158
    v_exp_f32 v159, v159
    v_mfma_f32_32x32x16_bf16 v[176:191], a[0:3], v[32:35], 4.0
    v_exp_f32 v160, v160
    v_exp_f32 v161, v161
    v_exp_f32 v162, v162
    v_mfma_f32_32x32x16_bf16 v[176:191], a[4:7], v[36:39], v[176:191]
    v_exp_f32 v163, v163
    v_exp_f32 v164, v164
    v_exp_f32 v165, v165
    v_exp_f32 v166, v166
    v_smfmac_f32_32x32x32_bf16 v[96:111], a[40:43], v[144:151], v5
    v_exp_f32 v167, v167
    v_exp_f32 v168, v168
    v_exp_f32 v169, v169
    v_smfmac_f32_16x16x64_bf16 v[136:139], v[20:23], v[144:151], v5
    ds_read_b64_tr_b16 a[36:37], v3 offset:54272
    v_exp_f32 v170, v170
    v_smfmac_f32_32x32x32_bf16 v[96:111], a[44:47], v[152:159], v5
    v_exp_f32 v171, v171
    v_exp_f32 v172, v172
    v_exp_f32 v173, v173
    v_smfmac_f32_16x16x64_bf16 v[136:139], v[20:23], v[152:159], v5
    ds_read_b64_tr_b16 a[38:39], v3 offset:54528
    v_exp_f32 v174, v174
    v_exp_f32 v175, v175
    v_mfma_f32_32x32x16_bf16 v[144:159], a[0:3], v[40:43], 4.0
    v_exp_f32 v176, v176
    v_exp_f32 v177, v177
    v_exp_f32 v178, v178
    v_mfma_f32_32x32x16_bf16 v[144:159], a[4:7], v[44:47], v[144:159]
    v_exp_f32 v179, v179
    v_exp_f32 v180, v180
    v_exp_f32 v181, v181
    v_exp_f32 v182, v182
    v_smfmac_f32_32x32x32_bf16 v[112:127], a[40:43], v[160:167], v5
    v_exp_f32 v183, v183
    v_exp_f32 v184, v184
    v_exp_f32 v185, v185
    v_smfmac_f32_16x16x64_bf16 v[140:143], v[20:23], v[160:167], v5
    v_exp_f32 v186, v186
    v_smfmac_f32_32x32x32_bf16 v[112:127], a[44:47], v[168:175], v5
    v_exp_f32 v187, v187
    v_exp_f32 v188, v188
    v_exp_f32 v189, v189
    v_smfmac_f32_16x16x64_bf16 v[140:143], v[20:23], v[168:175], v5
    v_exp_f32 v190, v190
    v_exp_f32 v191, v191
    v_mfma_f32_32x32x16_bf16 v[160:175], a[0:3], v[48:51], 4.0
    v_exp_f32 v144, v144
    v_exp_f32 v145, v145
    v_exp_f32 v146, v146
    v_mfma_f32_32x32x16_bf16 v[160:175], a[4:7], v[52:55], v[160:175]
    s_waitcnt lgkmcnt(0)
    v_exp_f32 v147, v147
    v_exp_f32 v148, v148
    v_exp_f32 v149, v149
    v_exp_f32 v150, v150
    v_smfmac_f32_32x32x32_bf16 v[64:79], a[32:35], v[176:183], v5
    v_exp_f32 v151, v151
    v_exp_f32 v152, v152
    v_exp_f32 v153, v153
    v_smfmac_f32_16x16x64_bf16 v[128:131], v[20:23], v[176:183], v5
    ds_read_b128 a[8:11], v7 offset:22528
    v_exp_f32 v154, v154
    v_smfmac_f32_32x32x32_bf16 v[64:79], a[36:39], v[184:191], v5
    v_exp_f32 v155, v155
    v_exp_f32 v156, v156
    v_exp_f32 v157, v157
    v_smfmac_f32_16x16x64_bf16 v[128:131], v[20:23], v[184:191], v5
    ds_read_b128 a[12:15], v8 offset:22528
    v_exp_f32 v158, v158
    v_exp_f32 v159, v159
    v_mfma_f32_32x32x16_bf16 v[176:191], a[0:3], v[56:59], 4.0
    v_exp_f32 v160, v160
    v_exp_f32 v161, v161
    v_exp_f32 v162, v162
    v_mfma_f32_32x32x16_bf16 v[176:191], a[4:7], v[60:63], v[176:191]
    v_exp_f32 v163, v163
    v_exp_f32 v164, v164
    v_exp_f32 v165, v165
    v_exp_f32 v166, v166
    v_smfmac_f32_32x32x32_bf16 v[80:95], a[32:35], v[144:151], v5
    v_exp_f32 v167, v167
    v_exp_f32 v168, v168
    v_exp_f32 v169, v169
    v_smfmac_f32_16x16x64_bf16 v[132:135], v[20:23], v[144:151], v5
    ds_read_b64_tr_b16 a[40:41], v3 offset:55296
    v_exp_f32 v170, v170
    v_smfmac_f32_32x32x32_bf16 v[80:95], a[36:39], v[152:159], v5
    s_waitcnt lgkmcnt(1)
    v_exp_f32 v171, v171
    v_exp_f32 v172, v172
    v_exp_f32 v173, v173
    v_smfmac_f32_16x16x64_bf16 v[132:135], v[20:23], v[152:159], v5
    ds_read_b64_tr_b16 a[42:43], v3 offset:55552
    v_exp_f32 v174, v174
    v_exp_f32 v175, v175
    v_mfma_f32_32x32x16_bf16 v[144:159], a[8:11], v[32:35], 4.0
    v_exp_f32 v176, v176
    v_exp_f32 v177, v177
    v_exp_f32 v178, v178
    v_mfma_f32_32x32x16_bf16 v[144:159], a[12:15], v[36:39], v[144:159]
    v_exp_f32 v179, v179
    v_exp_f32 v180, v180
    v_exp_f32 v181, v181
    v_exp_f32 v182, v182
    v_smfmac_f32_32x32x32_bf16 v[96:111], a[32:35], v[160:167], v5
    v_exp_f32 v183, v183
    v_exp_f32 v184, v184
    v_exp_f32 v185, v185
    v_smfmac_f32_16x16x64_bf16 v[136:139], v[20:23], v[160:167], v5
    ds_read_b64_tr_b16 a[44:45], v3 offset:56320
    v_exp_f32 v186, v186
    v_smfmac_f32_32x32x32_bf16 v[96:111], a[36:39], v[168:175], v5
    v_exp_f32 v187, v187
    v_exp_f32 v188, v188
    v_exp_f32 v189, v189
    v_smfmac_f32_16x16x64_bf16 v[136:139], v[20:23], v[168:175], v5
    ds_read_b64_tr_b16 a[46:47], v3 offset:56576
    v_exp_f32 v190, v190
    v_exp_f32 v191, v191
    v_mfma_f32_32x32x16_bf16 v[160:175], a[8:11], v[40:43], 4.0
    v_exp_f32 v144, v144
    v_exp_f32 v145, v145
    v_exp_f32 v146, v146
    v_mfma_f32_32x32x16_bf16 v[160:175], a[12:15], v[44:47], v[160:175]
    v_exp_f32 v147, v147
    v_exp_f32 v148, v148
    v_exp_f32 v149, v149
    v_exp_f32 v150, v150
    v_smfmac_f32_32x32x32_bf16 v[112:127], a[32:35], v[176:183], v5
    v_exp_f32 v151, v151
    v_exp_f32 v152, v152
    v_exp_f32 v153, v153
    v_smfmac_f32_16x16x64_bf16 v[140:143], v[20:23], v[176:183], v5
    v_exp_f32 v154, v154
    v_smfmac_f32_32x32x32_bf16 v[112:127], a[36:39], v[184:191], v5
    v_exp_f32 v155, v155
    v_exp_f32 v156, v156
    v_exp_f32 v157, v157
    v_smfmac_f32_16x16x64_bf16 v[140:143], v[20:23], v[184:191], v5
    v_exp_f32 v158, v158
    v_exp_f32 v159, v159
    v_mfma_f32_32x32x16_bf16 v[176:191], a[8:11], v[48:51], 4.0
    v_exp_f32 v160, v160
    v_exp_f32 v161, v161
    v_exp_f32 v162, v162
    v_mfma_f32_32x32x16_bf16 v[176:191], a[12:15], v[52:55], v[176:191]
    s_waitcnt lgkmcnt(0)
    v_exp_f32 v163, v163
    v_exp_f32 v164, v164
    v_exp_f32 v165, v165
    v_exp_f32 v166, v166
    v_smfmac_f32_32x32x32_bf16 v[64:79], a[40:43], v[144:151], v5
    s_barrier
    v_exp_f32 v167, v167
    v_exp_f32 v168, v168
    v_exp_f32 v169, v169
    v_smfmac_f32_16x16x64_bf16 v[128:131], v[20:23], v[144:151], v5
    ds_read_b128 a[0:3], v7 offset:24576
    v_exp_f32 v170, v170
    v_smfmac_f32_32x32x32_bf16 v[64:79], a[44:47], v[152:159], v5
    v_exp_f32 v171, v171
    v_exp_f32 v172, v172
    v_exp_f32 v173, v173
    v_smfmac_f32_16x16x64_bf16 v[128:131], v[20:23], v[152:159], v5
    ds_read_b128 a[4:7], v8 offset:24576
    v_exp_f32 v174, v174
    v_exp_f32 v175, v175
    v_mfma_f32_32x32x16_bf16 v[144:159], a[8:11], v[56:59], 4.0
    v_exp_f32 v176, v176
    v_exp_f32 v177, v177
    v_exp_f32 v178, v178
    v_mfma_f32_32x32x16_bf16 v[144:159], a[12:15], v[60:63], v[144:159]
    v_exp_f32 v179, v179
    v_exp_f32 v180, v180
    v_exp_f32 v181, v181
    v_exp_f32 v182, v182
    v_smfmac_f32_32x32x32_bf16 v[80:95], a[40:43], v[160:167], v5
    v_exp_f32 v183, v183
    v_exp_f32 v184, v184
    v_exp_f32 v185, v185
    v_smfmac_f32_16x16x64_bf16 v[132:135], v[20:23], v[160:167], v5
    ds_read_b64_tr_b16 a[32:33], v3 offset:57344
    v_exp_f32 v186, v186
    v_smfmac_f32_32x32x32_bf16 v[80:95], a[44:47], v[168:175], v5
    s_waitcnt lgkmcnt(1)
    v_exp_f32 v187, v187
    v_exp_f32 v188, v188
    v_exp_f32 v189, v189
    v_smfmac_f32_16x16x64_bf16 v[132:135], v[20:23], v[168:175], v5
    ds_read_b64_tr_b16 a[34:35], v3 offset:57600
    v_exp_f32 v190, v190
    v_exp_f32 v191, v191
    v_mfma_f32_32x32x16_bf16 v[160:175], a[0:3], v[32:35], 4.0
    v_exp_f32 v144, v144
    v_exp_f32 v145, v145
    v_exp_f32 v146, v146
    v_mfma_f32_32x32x16_bf16 v[160:175], a[4:7], v[36:39], v[160:175]
    v_exp_f32 v147, v147
    v_exp_f32 v148, v148
    v_exp_f32 v149, v149
    v_exp_f32 v150, v150
    v_smfmac_f32_32x32x32_bf16 v[96:111], a[40:43], v[176:183], v5
    v_exp_f32 v151, v151
    v_exp_f32 v152, v152
    v_exp_f32 v153, v153
    v_smfmac_f32_16x16x64_bf16 v[136:139], v[20:23], v[176:183], v5
    ds_read_b64_tr_b16 a[36:37], v3 offset:58368
    v_exp_f32 v154, v154
    v_smfmac_f32_32x32x32_bf16 v[96:111], a[44:47], v[184:191], v5
    v_exp_f32 v155, v155
    v_exp_f32 v156, v156
    v_exp_f32 v157, v157
    v_smfmac_f32_16x16x64_bf16 v[136:139], v[20:23], v[184:191], v5
    ds_read_b64_tr_b16 a[38:39], v3 offset:58624
    v_exp_f32 v158, v158
    v_exp_f32 v159, v159
    v_mfma_f32_32x32x16_bf16 v[176:191], a[0:3], v[40:43], 4.0
    v_exp_f32 v160, v160
    v_exp_f32 v161, v161
    v_exp_f32 v162, v162
    v_mfma_f32_32x32x16_bf16 v[176:191], a[4:7], v[44:47], v[176:191]
    v_exp_f32 v163, v163
    v_exp_f32 v164, v164
    v_exp_f32 v165, v165
    v_exp_f32 v166, v166
    v_smfmac_f32_32x32x32_bf16 v[112:127], a[40:43], v[144:151], v5
    v_exp_f32 v167, v167
    v_exp_f32 v168, v168
    v_exp_f32 v169, v169
    v_smfmac_f32_16x16x64_bf16 v[140:143], v[20:23], v[144:151], v5
    v_exp_f32 v170, v170
    v_smfmac_f32_32x32x32_bf16 v[112:127], a[44:47], v[152:159], v5
    v_exp_f32 v171, v171
    v_exp_f32 v172, v172
    v_exp_f32 v173, v173
    v_smfmac_f32_16x16x64_bf16 v[140:143], v[20:23], v[152:159], v5
    v_exp_f32 v174, v174
    v_exp_f32 v175, v175
    v_mfma_f32_32x32x16_bf16 v[144:159], a[0:3], v[48:51], 4.0
    v_exp_f32 v176, v176
    v_exp_f32 v177, v177
    v_exp_f32 v178, v178
    v_mfma_f32_32x32x16_bf16 v[144:159], a[4:7], v[52:55], v[144:159]
    s_waitcnt lgkmcnt(0)
    v_exp_f32 v179, v179
    v_exp_f32 v180, v180
    v_exp_f32 v181, v181
    v_exp_f32 v182, v182
    v_smfmac_f32_32x32x32_bf16 v[64:79], a[32:35], v[160:167], v5
    v_exp_f32 v183, v183
    v_exp_f32 v184, v184
    v_exp_f32 v185, v185
    v_smfmac_f32_16x16x64_bf16 v[128:131], v[20:23], v[160:167], v5
    ds_read_b128 a[8:11], v7 offset:26624
    v_exp_f32 v186, v186
    v_smfmac_f32_32x32x32_bf16 v[64:79], a[36:39], v[168:175], v5
    v_exp_f32 v187, v187
    v_exp_f32 v188, v188
    v_exp_f32 v189, v189
    v_smfmac_f32_16x16x64_bf16 v[128:131], v[20:23], v[168:175], v5
    ds_read_b128 a[12:15], v8 offset:26624
    v_exp_f32 v190, v190
    v_exp_f32 v191, v191
    v_mfma_f32_32x32x16_bf16 v[160:175], a[0:3], v[56:59], 4.0
    v_exp_f32 v144, v144
    v_exp_f32 v145, v145
    v_exp_f32 v146, v146
    v_mfma_f32_32x32x16_bf16 v[160:175], a[4:7], v[60:63], v[160:175]
    v_exp_f32 v147, v147
    v_exp_f32 v148, v148
    v_exp_f32 v149, v149
    v_exp_f32 v150, v150
    v_smfmac_f32_32x32x32_bf16 v[80:95], a[32:35], v[176:183], v5
    v_exp_f32 v151, v151
    v_exp_f32 v152, v152
    v_exp_f32 v153, v153
    v_smfmac_f32_16x16x64_bf16 v[132:135], v[20:23], v[176:183], v5
    ds_read_b64_tr_b16 a[40:41], v3 offset:59392
    v_exp_f32 v154, v154
    v_smfmac_f32_32x32x32_bf16 v[80:95], a[36:39], v[184:191], v5
    s_waitcnt lgkmcnt(1)
    v_exp_f32 v155, v155
    v_exp_f32 v156, v156
    v_exp_f32 v157, v157
    v_smfmac_f32_16x16x64_bf16 v[132:135], v[20:23], v[184:191], v5
    ds_read_b64_tr_b16 a[42:43], v3 offset:59648
    v_exp_f32 v158, v158
    v_exp_f32 v159, v159
    v_mfma_f32_32x32x16_bf16 v[176:191], a[8:11], v[32:35], 4.0
    v_exp_f32 v160, v160
    v_exp_f32 v161, v161
    v_exp_f32 v162, v162
    v_mfma_f32_32x32x16_bf16 v[176:191], a[12:15], v[36:39], v[176:191]
    v_exp_f32 v163, v163
    v_exp_f32 v164, v164
    v_exp_f32 v165, v165
    v_exp_f32 v166, v166
    v_smfmac_f32_32x32x32_bf16 v[96:111], a[32:35], v[144:151], v5
    v_exp_f32 v167, v167
    v_exp_f32 v168, v168
    v_exp_f32 v169, v169
    v_smfmac_f32_16x16x64_bf16 v[136:139], v[20:23], v[144:151], v5
    ds_read_b64_tr_b16 a[44:45], v3 offset:60416
    v_exp_f32 v170, v170
    v_smfmac_f32_32x32x32_bf16 v[96:111], a[36:39], v[152:159], v5
    v_exp_f32 v171, v171
    v_exp_f32 v172, v172
    v_exp_f32 v173, v173
    v_smfmac_f32_16x16x64_bf16 v[136:139], v[20:23], v[152:159], v5
    ds_read_b64_tr_b16 a[46:47], v3 offset:60672
    v_exp_f32 v174, v174
    v_exp_f32 v175, v175
    v_mfma_f32_32x32x16_bf16 v[144:159], a[8:11], v[40:43], 4.0
    v_exp_f32 v176, v176
    v_exp_f32 v177, v177
    v_exp_f32 v178, v178
    v_mfma_f32_32x32x16_bf16 v[144:159], a[12:15], v[44:47], v[144:159]
    v_exp_f32 v179, v179
    v_exp_f32 v180, v180
    v_exp_f32 v181, v181
    v_exp_f32 v182, v182
    v_smfmac_f32_32x32x32_bf16 v[112:127], a[32:35], v[160:167], v5
    v_exp_f32 v183, v183
    v_exp_f32 v184, v184
    v_exp_f32 v185, v185
    v_smfmac_f32_16x16x64_bf16 v[140:143], v[20:23], v[160:167], v5
    v_exp_f32 v186, v186
    v_smfmac_f32_32x32x32_bf16 v[112:127], a[36:39], v[168:175], v5
    v_exp_f32 v187, v187
    v_exp_f32 v188, v188
    v_exp_f32 v189, v189
    v_smfmac_f32_16x16x64_bf16 v[140:143], v[20:23], v[168:175], v5
    v_exp_f32 v190, v190
    v_exp_f32 v191, v191
    v_mfma_f32_32x32x16_bf16 v[160:175], a[8:11], v[48:51], 4.0
    v_exp_f32 v144, v144
    v_exp_f32 v145, v145
    v_exp_f32 v146, v146
    v_mfma_f32_32x32x16_bf16 v[160:175], a[12:15], v[52:55], v[160:175]
    s_waitcnt lgkmcnt(0)
    v_exp_f32 v147, v147
    v_exp_f32 v148, v148
    v_exp_f32 v149, v149
    v_exp_f32 v150, v150
    v_smfmac_f32_32x32x32_bf16 v[64:79], a[40:43], v[176:183], v5
    v_exp_f32 v151, v151
    v_exp_f32 v152, v152
    v_exp_f32 v153, v153
    v_smfmac_f32_16x16x64_bf16 v[128:131], v[20:23], v[176:183], v5
    ds_read_b128 a[0:3], v7 offset:28672
    v_exp_f32 v154, v154
    v_smfmac_f32_32x32x32_bf16 v[64:79], a[44:47], v[184:191], v5
    v_exp_f32 v155, v155
    v_exp_f32 v156, v156
    v_exp_f32 v157, v157
    v_smfmac_f32_16x16x64_bf16 v[128:131], v[20:23], v[184:191], v5
    ds_read_b128 a[4:7], v8 offset:28672
    v_exp_f32 v158, v158
    v_exp_f32 v159, v159
    v_mfma_f32_32x32x16_bf16 v[176:191], a[8:11], v[56:59], 4.0
    v_exp_f32 v160, v160
    v_exp_f32 v161, v161
    v_exp_f32 v162, v162
    v_mfma_f32_32x32x16_bf16 v[176:191], a[12:15], v[60:63], v[176:191]
    v_exp_f32 v163, v163
    v_exp_f32 v164, v164
    v_exp_f32 v165, v165
    v_exp_f32 v166, v166
    v_smfmac_f32_32x32x32_bf16 v[80:95], a[40:43], v[144:151], v5
    v_exp_f32 v167, v167
    v_exp_f32 v168, v168
    v_exp_f32 v169, v169
    v_smfmac_f32_16x16x64_bf16 v[132:135], v[20:23], v[144:151], v5
    ds_read_b64_tr_b16 a[32:33], v3 offset:61440
    v_exp_f32 v170, v170
    v_smfmac_f32_32x32x32_bf16 v[80:95], a[44:47], v[152:159], v5
    s_waitcnt lgkmcnt(1)
    v_exp_f32 v171, v171
    v_exp_f32 v172, v172
    v_exp_f32 v173, v173
    v_smfmac_f32_16x16x64_bf16 v[132:135], v[20:23], v[152:159], v5
    ds_read_b64_tr_b16 a[34:35], v3 offset:61696
    v_exp_f32 v174, v174
    v_exp_f32 v175, v175
    v_mfma_f32_32x32x16_bf16 v[144:159], a[0:3], v[32:35], 4.0
    v_exp_f32 v176, v176
    v_exp_f32 v177, v177
    v_exp_f32 v178, v178
    v_mfma_f32_32x32x16_bf16 v[144:159], a[4:7], v[36:39], v[144:159]
    v_exp_f32 v179, v179
    v_exp_f32 v180, v180
    v_exp_f32 v181, v181
    v_exp_f32 v182, v182
    v_smfmac_f32_32x32x32_bf16 v[96:111], a[40:43], v[160:167], v5
    v_exp_f32 v183, v183
    v_exp_f32 v184, v184
    v_exp_f32 v185, v185
    v_smfmac_f32_16x16x64_bf16 v[136:139], v[20:23], v[160:167], v5
    ds_read_b64_tr_b16 a[36:37], v3 offset:62464
    v_exp_f32 v186, v186
    v_smfmac_f32_32x32x32_bf16 v[96:111], a[44:47], v[168:175], v5
    v_exp_f32 v187, v187
    v_exp_f32 v188, v188
    v_exp_f32 v189, v189
    v_smfmac_f32_16x16x64_bf16 v[136:139], v[20:23], v[168:175], v5
    ds_read_b64_tr_b16 a[38:39], v3 offset:62720
    v_exp_f32 v190, v190
    v_exp_f32 v191, v191
    v_mfma_f32_32x32x16_bf16 v[160:175], a[0:3], v[40:43], 4.0
    v_exp_f32 v144, v144
    v_exp_f32 v145, v145
    v_exp_f32 v146, v146
    v_mfma_f32_32x32x16_bf16 v[160:175], a[4:7], v[44:47], v[160:175]
    v_exp_f32 v147, v147
    v_exp_f32 v148, v148
    v_exp_f32 v149, v149
    v_exp_f32 v150, v150
    v_smfmac_f32_32x32x32_bf16 v[112:127], a[40:43], v[176:183], v5
    v_exp_f32 v151, v151
    v_exp_f32 v152, v152
    v_exp_f32 v153, v153
    v_smfmac_f32_16x16x64_bf16 v[140:143], v[20:23], v[176:183], v5
    v_exp_f32 v154, v154
    v_smfmac_f32_32x32x32_bf16 v[112:127], a[44:47], v[184:191], v5
    v_exp_f32 v155, v155
    v_exp_f32 v156, v156
    v_exp_f32 v157, v157
    v_smfmac_f32_16x16x64_bf16 v[140:143], v[20:23], v[184:191], v5
    v_exp_f32 v158, v158
    v_exp_f32 v159, v159
    v_mfma_f32_32x32x16_bf16 v[176:191], a[0:3], v[48:51], 4.0
    v_exp_f32 v160, v160
    v_exp_f32 v161, v161
    v_exp_f32 v162, v162
    v_mfma_f32_32x32x16_bf16 v[176:191], a[4:7], v[52:55], v[176:191]
    s_waitcnt lgkmcnt(0)
    v_exp_f32 v163, v163
    v_exp_f32 v164, v164
    v_exp_f32 v165, v165
    v_exp_f32 v166, v166
    v_smfmac_f32_32x32x32_bf16 v[64:79], a[32:35], v[144:151], v5
    v_exp_f32 v167, v167
    v_exp_f32 v168, v168
    v_exp_f32 v169, v169
    v_smfmac_f32_16x16x64_bf16 v[128:131], v[20:23], v[144:151], v5
    ds_read_b128 a[8:11], v7 offset:30720
    v_exp_f32 v170, v170
    v_smfmac_f32_32x32x32_bf16 v[64:79], a[36:39], v[152:159], v5
    v_exp_f32 v171, v171
    v_exp_f32 v172, v172
    v_exp_f32 v173, v173
    v_smfmac_f32_16x16x64_bf16 v[128:131], v[20:23], v[152:159], v5
    ds_read_b128 a[12:15], v8 offset:30720
    v_exp_f32 v174, v174
    v_exp_f32 v175, v175
    v_mfma_f32_32x32x16_bf16 v[144:159], a[0:3], v[56:59], 4.0
    v_exp_f32 v176, v176
    v_exp_f32 v177, v177
    v_exp_f32 v178, v178
    v_mfma_f32_32x32x16_bf16 v[144:159], a[4:7], v[60:63], v[144:159]
    v_exp_f32 v179, v179
    v_exp_f32 v180, v180
    v_exp_f32 v181, v181
    v_exp_f32 v182, v182
    v_smfmac_f32_32x32x32_bf16 v[80:95], a[32:35], v[160:167], v5
    v_exp_f32 v183, v183
    v_exp_f32 v184, v184
    v_exp_f32 v185, v185
    v_smfmac_f32_16x16x64_bf16 v[132:135], v[20:23], v[160:167], v5
    ds_read_b64_tr_b16 a[40:41], v3 offset:63488
    v_exp_f32 v186, v186
    v_smfmac_f32_32x32x32_bf16 v[80:95], a[36:39], v[168:175], v5
    s_waitcnt lgkmcnt(1)
    v_exp_f32 v187, v187
    v_exp_f32 v188, v188
    v_exp_f32 v189, v189
    v_smfmac_f32_16x16x64_bf16 v[132:135], v[20:23], v[168:175], v5
    ds_read_b64_tr_b16 a[42:43], v3 offset:63744
    v_exp_f32 v190, v190
    v_exp_f32 v191, v191
    v_mfma_f32_32x32x16_bf16 v[160:175], a[8:11], v[32:35], 4.0
    v_exp_f32 v144, v144
    v_exp_f32 v145, v145
    v_exp_f32 v146, v146
    v_mfma_f32_32x32x16_bf16 v[160:175], a[12:15], v[36:39], v[160:175]
    v_exp_f32 v147, v147
    v_exp_f32 v148, v148
    v_exp_f32 v149, v149
    v_exp_f32 v150, v150
    v_smfmac_f32_32x32x32_bf16 v[96:111], a[32:35], v[176:183], v5
    v_exp_f32 v151, v151
    v_exp_f32 v152, v152
    v_exp_f32 v153, v153
    v_smfmac_f32_16x16x64_bf16 v[136:139], v[20:23], v[176:183], v5
    ds_read_b64_tr_b16 a[44:45], v3 offset:64512
    v_exp_f32 v154, v154
    v_smfmac_f32_32x32x32_bf16 v[96:111], a[36:39], v[184:191], v5
    v_exp_f32 v155, v155
    v_exp_f32 v156, v156
    v_exp_f32 v157, v157
    v_smfmac_f32_16x16x64_bf16 v[136:139], v[20:23], v[184:191], v5
    ds_read_b64_tr_b16 a[46:47], v3 offset:64768
    v_exp_f32 v158, v158
    v_exp_f32 v159, v159
    v_mfma_f32_32x32x16_bf16 v[176:191], a[8:11], v[40:43], 4.0
    v_exp_f32 v160, v160
    v_exp_f32 v161, v161
    v_exp_f32 v162, v162
    v_mfma_f32_32x32x16_bf16 v[176:191], a[12:15], v[44:47], v[176:191]
    v_exp_f32 v163, v163
    v_exp_f32 v164, v164
    v_exp_f32 v165, v165
    v_exp_f32 v166, v166
    v_smfmac_f32_32x32x32_bf16 v[112:127], a[32:35], v[144:151], v5
    v_exp_f32 v167, v167
    v_exp_f32 v168, v168
    v_exp_f32 v169, v169
    v_smfmac_f32_16x16x64_bf16 v[140:143], v[20:23], v[144:151], v5
    v_exp_f32 v170, v170
    v_smfmac_f32_32x32x32_bf16 v[112:127], a[36:39], v[152:159], v5
    v_exp_f32 v171, v171
    v_exp_f32 v172, v172
    v_exp_f32 v173, v173
    v_smfmac_f32_16x16x64_bf16 v[140:143], v[20:23], v[152:159], v5
    v_exp_f32 v174, v174
    v_exp_f32 v175, v175
    v_mfma_f32_32x32x16_bf16 v[144:159], a[8:11], v[48:51], 4.0
    v_exp_f32 v176, v176
    v_exp_f32 v177, v177
    v_exp_f32 v178, v178
    v_mfma_f32_32x32x16_bf16 v[144:159], a[12:15], v[52:55], v[144:159]
    s_waitcnt lgkmcnt(0)
    v_exp_f32 v179, v179
    v_exp_f32 v180, v180
    v_exp_f32 v181, v181
    v_exp_f32 v182, v182
    v_smfmac_f32_32x32x32_bf16 v[64:79], a[40:43], v[160:167], v5
    s_barrier
    v_exp_f32 v183, v183
    v_exp_f32 v184, v184
    v_exp_f32 v185, v185
    v_smfmac_f32_16x16x64_bf16 v[128:131], v[20:23], v[160:167], v5
    ds_read_b128 a[0:3], v7 offset:0
    v_exp_f32 v186, v186
    v_smfmac_f32_32x32x32_bf16 v[64:79], a[44:47], v[168:175], v5
    v_exp_f32 v187, v187
    v_exp_f32 v188, v188
    v_exp_f32 v189, v189
    v_smfmac_f32_16x16x64_bf16 v[128:131], v[20:23], v[168:175], v5
    ds_read_b128 a[4:7], v8 offset:0
    v_exp_f32 v190, v190
    v_exp_f32 v191, v191
    v_mfma_f32_32x32x16_bf16 v[160:175], a[8:11], v[56:59], 4.0
    v_exp_f32 v144, v144
    v_exp_f32 v145, v145
    v_exp_f32 v146, v146
    v_mfma_f32_32x32x16_bf16 v[160:175], a[12:15], v[60:63], v[160:175]
    v_exp_f32 v147, v147
    v_exp_f32 v148, v148
    v_exp_f32 v149, v149
    v_exp_f32 v150, v150
    v_smfmac_f32_32x32x32_bf16 v[80:95], a[40:43], v[176:183], v5
    v_exp_f32 v151, v151
    v_exp_f32 v152, v152
    v_exp_f32 v153, v153
    v_smfmac_f32_16x16x64_bf16 v[132:135], v[20:23], v[176:183], v5
    ds_read_b64_tr_b16 a[32:33], v3 offset:32768
    v_exp_f32 v154, v154
    v_smfmac_f32_32x32x32_bf16 v[80:95], a[44:47], v[184:191], v5
    s_waitcnt lgkmcnt(1)
    v_exp_f32 v155, v155
    v_exp_f32 v156, v156
    v_exp_f32 v157, v157
    v_smfmac_f32_16x16x64_bf16 v[132:135], v[20:23], v[184:191], v5
    ds_read_b64_tr_b16 a[34:35], v3 offset:33024
    v_exp_f32 v158, v158
    v_exp_f32 v159, v159
    v_mfma_f32_32x32x16_bf16 v[176:191], a[0:3], v[32:35], 4.0
    v_exp_f32 v160, v160
    v_exp_f32 v161, v161
    v_exp_f32 v162, v162
    v_mfma_f32_32x32x16_bf16 v[176:191], a[4:7], v[36:39], v[176:191]
    v_exp_f32 v163, v163
    v_exp_f32 v164, v164
    v_exp_f32 v165, v165
    v_exp_f32 v166, v166
    v_smfmac_f32_32x32x32_bf16 v[96:111], a[40:43], v[144:151], v5
    v_exp_f32 v167, v167
    v_exp_f32 v168, v168
    v_exp_f32 v169, v169
    v_smfmac_f32_16x16x64_bf16 v[136:139], v[20:23], v[144:151], v5
    ds_read_b64_tr_b16 a[36:37], v3 offset:33792
    v_exp_f32 v170, v170
    v_smfmac_f32_32x32x32_bf16 v[96:111], a[44:47], v[152:159], v5
    v_exp_f32 v171, v171
    v_exp_f32 v172, v172
    v_exp_f32 v173, v173
    v_smfmac_f32_16x16x64_bf16 v[136:139], v[20:23], v[152:159], v5
    ds_read_b64_tr_b16 a[38:39], v3 offset:34048
    v_exp_f32 v174, v174
    v_exp_f32 v175, v175
    v_mfma_f32_32x32x16_bf16 v[144:159], a[0:3], v[40:43], 4.0
    v_exp_f32 v176, v176
    v_exp_f32 v177, v177
    v_exp_f32 v178, v178
    v_mfma_f32_32x32x16_bf16 v[144:159], a[4:7], v[44:47], v[144:159]
    v_exp_f32 v179, v179
    v_exp_f32 v180, v180
    v_exp_f32 v181, v181
    v_exp_f32 v182, v182
    v_smfmac_f32_32x32x32_bf16 v[112:127], a[40:43], v[160:167], v5
    v_exp_f32 v183, v183
    v_exp_f32 v184, v184
    v_exp_f32 v185, v185
    v_smfmac_f32_16x16x64_bf16 v[140:143], v[20:23], v[160:167], v5
    v_exp_f32 v186, v186
    v_smfmac_f32_32x32x32_bf16 v[112:127], a[44:47], v[168:175], v5
    v_exp_f32 v187, v187
    v_exp_f32 v188, v188
    v_exp_f32 v189, v189
    v_smfmac_f32_16x16x64_bf16 v[140:143], v[20:23], v[168:175], v5
    v_exp_f32 v190, v190
    v_exp_f32 v191, v191
    v_mfma_f32_32x32x16_bf16 v[160:175], a[0:3], v[48:51], 4.0
    v_exp_f32 v144, v144
    v_exp_f32 v145, v145
    v_exp_f32 v146, v146
    v_mfma_f32_32x32x16_bf16 v[160:175], a[4:7], v[52:55], v[160:175]
    s_waitcnt lgkmcnt(0)
    v_exp_f32 v147, v147
    v_exp_f32 v148, v148
    v_exp_f32 v149, v149
    v_exp_f32 v150, v150
    v_smfmac_f32_32x32x32_bf16 v[64:79], a[32:35], v[176:183], v5
    v_exp_f32 v151, v151
    v_exp_f32 v152, v152
    v_exp_f32 v153, v153
    v_smfmac_f32_16x16x64_bf16 v[128:131], v[20:23], v[176:183], v5
    ds_read_b128 a[8:11], v7 offset:2048
    v_exp_f32 v154, v154
    v_smfmac_f32_32x32x32_bf16 v[64:79], a[36:39], v[184:191], v5
    v_exp_f32 v155, v155
    v_exp_f32 v156, v156
    v_exp_f32 v157, v157
    v_smfmac_f32_16x16x64_bf16 v[128:131], v[20:23], v[184:191], v5
    ds_read_b128 a[12:15], v8 offset:2048
    v_exp_f32 v158, v158
    v_exp_f32 v159, v159
    v_mfma_f32_32x32x16_bf16 v[176:191], a[0:3], v[56:59], 4.0
    v_exp_f32 v160, v160
    v_exp_f32 v161, v161
    v_exp_f32 v162, v162
    v_mfma_f32_32x32x16_bf16 v[176:191], a[4:7], v[60:63], v[176:191]
    v_exp_f32 v163, v163
    v_exp_f32 v164, v164
    v_exp_f32 v165, v165
    v_exp_f32 v166, v166
    v_smfmac_f32_32x32x32_bf16 v[80:95], a[32:35], v[144:151], v5
    v_exp_f32 v167, v167
    v_exp_f32 v168, v168
    v_exp_f32 v169, v169
    v_smfmac_f32_16x16x64_bf16 v[132:135], v[20:23], v[144:151], v5
    ds_read_b64_tr_b16 a[40:41], v3 offset:34816
    v_exp_f32 v170, v170
    v_smfmac_f32_32x32x32_bf16 v[80:95], a[36:39], v[152:159], v5
    s_waitcnt lgkmcnt(1)
    v_exp_f32 v171, v171
    v_exp_f32 v172, v172
    v_exp_f32 v173, v173
    v_smfmac_f32_16x16x64_bf16 v[132:135], v[20:23], v[152:159], v5
    ds_read_b64_tr_b16 a[42:43], v3 offset:35072
    v_exp_f32 v174, v174
    v_exp_f32 v175, v175
    v_mfma_f32_32x32x16_bf16 v[144:159], a[8:11], v[32:35], 4.0
    v_exp_f32 v176, v176
    v_exp_f32 v177, v177
    v_exp_f32 v178, v178
    v_mfma_f32_32x32x16_bf16 v[144:159], a[12:15], v[36:39], v[144:159]
    v_exp_f32 v179, v179
    v_exp_f32 v180, v180
    v_exp_f32 v181, v181
    v_exp_f32 v182, v182
    v_smfmac_f32_32x32x32_bf16 v[96:111], a[32:35], v[160:167], v5
    v_exp_f32 v183, v183
    v_exp_f32 v184, v184
    v_exp_f32 v185, v185
    v_smfmac_f32_16x16x64_bf16 v[136:139], v[20:23], v[160:167], v5
    ds_read_b64_tr_b16 a[44:45], v3 offset:35840
    v_exp_f32 v186, v186
    v_smfmac_f32_32x32x32_bf16 v[96:111], a[36:39], v[168:175], v5
    v_exp_f32 v187, v187
    v_exp_f32 v188, v188
    v_exp_f32 v189, v189
    v_smfmac_f32_16x16x64_bf16 v[136:139], v[20:23], v[168:175], v5
    ds_read_b64_tr_b16 a[46:47], v3 offset:36096
    v_exp_f32 v190, v190
    v_exp_f32 v191, v191
    v_mfma_f32_32x32x16_bf16 v[160:175], a[8:11], v[40:43], 4.0
    v_exp_f32 v144, v144
    v_exp_f32 v145, v145
    v_exp_f32 v146, v146
    v_mfma_f32_32x32x16_bf16 v[160:175], a[12:15], v[44:47], v[160:175]
    v_exp_f32 v147, v147
    v_exp_f32 v148, v148
    v_exp_f32 v149, v149
    v_exp_f32 v150, v150
    v_smfmac_f32_32x32x32_bf16 v[112:127], a[32:35], v[176:183], v5
    v_exp_f32 v151, v151
    v_exp_f32 v152, v152
    v_exp_f32 v153, v153
    v_smfmac_f32_16x16x64_bf16 v[140:143], v[20:23], v[176:183], v5
    v_exp_f32 v154, v154
    v_smfmac_f32_32x32x32_bf16 v[112:127], a[36:39], v[184:191], v5
    v_exp_f32 v155, v155
    v_exp_f32 v156, v156
    v_exp_f32 v157, v157
    v_smfmac_f32_16x16x64_bf16 v[140:143], v[20:23], v[184:191], v5
L_pad5:
    s_cbranch_vccnz L_hopx
    v_exp_f32 v158, v158
    v_exp_f32 v159, v159
    v_mfma_f32_32x32x16_bf16 v[176:191], a[8:11], v[48:51], 4.0
    v_exp_f32 v160, v160
    v_exp_f32 v161, v161
    v_exp_f32 v162, v162
    v_mfma_f32_32x32x16_bf16 v[176:191], a[12:15], v[52:55], v[176:191]
    s_waitcnt lgkmcnt(0)
    v_exp_f32 v163, v163
    v_exp_f32 v164, v164
    v_exp_f32 v165, v165
    v_exp_f32 v166, v166
    v_smfmac_f32_32x32x32_bf16 v[64:79], a[40:43], v[144:151], v5
    v_exp_f32 v167, v167
    v_exp_f32 v168, v168
    v_exp_f32 v169, v169
    v_smfmac_f32_16x16x64_bf16 v[128:131], v[20:23], v[144:151], v5
    ds_read_b128 a[0:3], v7 offset:4096
    v_exp_f32 v170, v170
    v_smfmac_f32_32x32x32_bf16 v[64:79], a[44:47], v[152:159], v5
    v_exp_f32 v171, v171
    v_exp_f32 v172, v172
    v_exp_f32 v173, v173
    v_smfmac_f32_16x16x64_bf16 v[128:131], v[20:23], v[152:159], v5
    ds_read_b128 a[4:7], v8 offset:4096
    v_exp_f32 v174, v174
    v_exp_f32 v175, v175
    v_mfma_f32_32x32x16_bf16 v[144:159], a[8:11], v[56:59], 4.0
    v_exp_f32 v176, v176
    v_exp_f32 v177, v177
    v_exp_f32 v178, v178
    v_mfma_f32_32x32x16_bf16 v[144:159], a[12:15], v[60:63], v[144:159]
    v_exp_f32 v179, v179
    v_exp_f32 v180, v180
    v_exp_f32 v181, v181
    v_exp_f32 v182, v182
    v_smfmac_f32_32x32x32_bf16 v[80:95], a[40:43], v[160:167], v5
    v_exp_f32 v183, v183
    v_exp_f32 v184, v184
    v_exp_f32 v185, v185
    v_smfmac_f32_16x16x64_bf16 v[132:135], v[20:23], v[160:167], v5
    ds_read_b64_tr_b16 a[32:33], v3 offset:36864
    v_exp_f32 v186, v186
    v_smfmac_f32_32x32x32_bf16 v[80:95], a[44:47], v[168:175], v5
    s_waitcnt lgkmcnt(1)
    v_exp_f32 v187, v187
    v_exp_f32 v188, v188
    v_exp_f32 v189, v189
    v_smfmac_f32_16x16x64_bf16 v[132:135], v[20:23], v[168:175], v5
    ds_read_b64_tr_b16 a[34:35], v3 offset:37120
    v_exp_f32 v190, v190
    v_exp_f32 v191, v191
    v_mfma_f32_32x32x16_bf16 v[160:175], a[0:3], v[32:35], 4.0
    v_exp_f32 v144, v144
    v_exp_f32 v145, v145
    v_exp_f32 v146, v146
    v_mfma_f32_32x32x16_bf16 v[160:175], a[4:7], v[36:39], v[160:175]
    v_exp_f32 v147, v147
    v_exp_f32 v148, v148
    v_exp_f32 v149, v149
    v_exp_f32 v150, v150
    v_smfmac_f32_32x32x32_bf16 v[96:111], a[40:43], v[176:183], v5
    v_exp_f32 v151, v151
    v_exp_f32 v152, v152
    v_exp_f32 v153, v153
    v_smfmac_f32_16x16x64_bf16 v[136:139], v[20:23], v[176:183], v5
    ds_read_b64_tr_b16 a[36:37], v3 offset:37888
    v_exp_f32 v154, v154
    v_smfmac_f32_32x32x32_bf16 v[96:111], a[44:47], v[184:191], v5
    v_exp_f32 v155, v155
    v_exp_f32 v156, v156
    v_exp_f32 v157, v157
    v_smfmac_f32_16x16x64_bf16 v[136:139], v[20:23], v[184:191], v5
    ds_read_b64_tr_b16 a[38:39], v3 offset:38144
    v_exp_f32 v158, v158
    v_exp_f32 v159, v159
    v_mfma_f32_32x32x16_bf16 v[176:191], a[0:3], v[40:43], 4.0
    v_exp_f32 v160, v160
    v_exp_f32 v161, v161
    v_exp_f32 v162, v162
    v_mfma_f32_32x32x16_bf16 v[176:191], a[4:7], v[44:47], v[176:191]
    v_exp_f32 v163, v163
    v_exp_f32 v164, v164
    v_exp_f32 v165, v165
    v_exp_f32 v166, v166
    v_smfmac_f32_32x32x32_bf16 v[112:127], a[40:43], v[144:151], v5
    v_exp_f32 v167, v167
    v_exp_f32 v168, v168
    v_exp_f32 v169, v169
    v_smfmac_f32_16x16x64_bf16 v[140:143], v[20:23], v[144:151], v5
    v_exp_f32 v170, v170
    v_smfmac_f32_32x32x32_bf16 v[112:127], a[44:47], v[152:159], v5
    v_exp_f32 v171, v171
    v_exp_f32 v172, v172
    v_exp_f32 v173, v173
    v_smfmac_f32_16x16x64_bf16 v[140:143], v[20:23], v[152:159], v5
    v_exp_f32 v174, v174
    v_exp_f32 v175, v175
    v_mfma_f32_32x32x16_bf16 v[144:159], a[0:3], v[48:51], 4.0
    v_exp_f32 v176, v176
    v_exp_f32 v177, v177
    v_exp_f32 v178, v178
    v_mfma_f32_32x32x16_bf16 v[144:159], a[4:7], v[52:55], v[144:159]
    s_waitcnt lgkmcnt(0)
    v_exp_f32 v179, v179
    v_exp_f32 v180, v180
    v_exp_f32 v181, v181
    v_exp_f32 v182, v182
    v_smfmac_f32_32x32x32_bf16 v[64:79], a[32:35], v[160:167], v5
    v_exp_f32 v183, v183
    v_exp_f32 v184, v184
    v_exp_f32 v185, v185
    v_smfmac_f32_16x16x64_bf16 v[128:131], v[20:23], v[160:167], v5
    ds_read_b128 a[8:11], v7 offset:6144
    v_exp_f32 v186, v186
    v_smfmac_f32_32x32x32_bf16 v[64:79], a[36:39], v[168:175], v5
    v_exp_f32 v187, v187
    v_exp_f32 v188, v188
    v_exp_f32 v189, v189
    v_smfmac_f32_16x16x64_bf16 v[128:131], v[20:23], v[168:175], v5
    ds_read_b128 a[12:15], v8 offset:6144
    v_exp_f32 v190, v190
    v_exp_f32 v191, v191
    v_mfma_f32_32x32x16_bf16 v[160:175], a[0:3], v[56:59], 4.0
    v_exp_f32 v144, v144
    v_exp_f32 v145, v145
    v_exp_f32 v146, v146
    v_mfma_f32_32x32x16_bf16 v[160:175], a[4:7], v[60:63], v[160:175]
    v_exp_f32 v147, v147
    v_exp_f32 v148, v148
    v_exp_f32 v149, v149
    v_exp_f32 v150, v150
    v_smfmac_f32_32x32x32_bf16 v[80:95], a[32:35], v[176:183], v5
    v_exp_f32 v151, v151
    v_exp_f32 v152, v152
    v_exp_f32 v153, v153
    v_smfmac_f32_16x16x64_bf16 v[132:135], v[20:23], v[176:183], v5
    ds_read_b64_tr_b16 a[40:41], v3 offset:38912
    v_exp_f32 v154, v154
    v_smfmac_f32_32x32x32_bf16 v[80:95], a[36:39], v[184:191], v5
    s_waitcnt lgkmcnt(1)
    v_exp_f32 v155, v155
    v_exp_f32 v156, v156
    v_exp_f32 v157, v157
    v_smfmac_f32_16x16x64_bf16 v[132:135], v[20:23], v[184:191], v5
    ds_read_b64_tr_b16 a[42:43], v3 offset:39168
    v_exp_f32 v158, v158
    v_exp_f32 v159, v159
    v_mfma_f32_32x32x16_bf16 v[176:191], a[8:11], v[32:35], 4.0
    v_exp_f32 v160, v160
    v_exp_f32 v161, v161
    v_exp_f32 v162, v162
    v_mfma_f32_32x32x16_bf16 v[176:191], a[12:15], v[36:39], v[176:191]
    v_exp_f32 v163, v163
    v_exp_f32 v164, v164
    v_exp_f32 v165, v165
    v_exp_f32 v166, v166
    v_smfmac_f32_32x32x32_bf16 v[96:111], a[32:35], v[144:151], v5
    v_exp_f32 v167, v167
    v_exp_f32 v168, v168
    v_exp_f32 v169, v169
    v_smfmac_f32_16x16x64_bf16 v[136:139], v[20:23], v[144:151], v5
    ds_read_b64_tr_b16 a[44:45], v3 offset:39936
    v_exp_f32 v170, v170
    v_smfmac_f32_32x32x32_bf16 v[96:111], a[36:39], v[152:159], v5
    v_exp_f32 v171, v171
    v_exp_f32 v172, v172
    v_exp_f32 v173, v173
    v_smfmac_f32_16x16x64_bf16 v[136:139], v[20:23], v[152:159], v5
    ds_read_b64_tr_b16 a[46:47], v3 offset:40192
    v_exp_f32 v174, v174
    v_exp_f32 v175, v175
    v_mfma_f32_32x32x16_bf16 v[144:159], a[8:11], v[40:43], 4.0
    v_exp_f32 v176, v176
    v_exp_f32 v177, v177
    v_exp_f32 v178, v178
    v_mfma_f32_32x32x16_bf16 v[144:159], a[12:15], v[44:47], v[144:159]
    v_exp_f32 v179, v179
    v_exp_f32 v180, v180
    v_exp_f32 v181, v181
    v_exp_f32 v182, v182
    v_smfmac_f32_32x32x32_bf16 v[112:127], a[32:35], v[160:167], v5
    v_exp_f32 v183, v183
    v_exp_f32 v184, v184
    v_exp_f32 v185, v185
    v_smfmac_f32_16x16x64_bf16 v[140:143], v[20:23], v[160:167], v5
    v_exp_f32 v186, v186
    v_smfmac_f32_32x32x32_bf16 v[112:127], a[36:39], v[168:175], v5
    v_exp_f32 v187, v187
    v_exp_f32 v188, v188
    v_exp_f32 v189, v189
    v_smfmac_f32_16x16x64_bf16 v[140:143], v[20:23], v[168:175], v5
    v_exp_f32 v190, v190
    v_exp_f32 v191, v191
    v_mfma_f32_32x32x16_bf16 v[160:175], a[8:11], v[48:51], 4.0
    v_exp_f32 v144, v144
    v_exp_f32 v145, v145
    v_exp_f32 v146, v146
    v_mfma_f32_32x32x16_bf16 v[160:175], a[12:15], v[52:55], v[160:175]
    s_waitcnt lgkmcnt(0)
    v_exp_f32 v147, v147
    v_exp_f32 v148, v148
    v_exp_f32 v149, v149
    v_exp_f32 v150, v150
    v_smfmac_f32_32x32x32_bf16 v[64:79], a[40:43], v[176:183], v5
    s_barrier
    v_exp_f32 v151, v151
    v_exp_f32 v152, v152
    v_exp_f32 v153, v153
    v_smfmac_f32_16x16x64_bf16 v[128:131], v[20:23], v[176:183], v5
    ds_read_b128 a[0:3], v7 offset:8192
    v_exp_f32 v154, v154
    v_smfmac_f32_32x32x32_bf16 v[64:79], a[44:47], v[184:191], v5
    v_exp_f32 v155, v155
    v_exp_f32 v156, v156
    v_exp_f32 v157, v157
    v_smfmac_f32_16x16x64_bf16 v[128:131], v[20:23], v[184:191], v5
    ds_read_b128 a[4:7], v8 offset:8192
    v_exp_f32 v158, v158
    v_exp_f32 v159, v159
    v_mfma_f32_32x32x16_bf16 v[176:191], a[8:11], v[56:59], 4.0
    v_exp_f32 v160, v160
    v_exp_f32 v161, v161
    v_exp_f32 v162, v162
    v_mfma_f32_32x32x16_bf16 v[176:191], a[12:15], v[60:63], v[176:191]
    v_exp_f32 v163, v163
    v_exp_f32 v164, v164
    v_exp_f32 v165, v165
    v_exp_f32 v166, v166
    v_smfmac_f32_32x32x32_bf16 v[80:95], a[40:43], v[144:151], v5
    v_exp_f32 v167, v167
    v_exp_f32 v168, v168
    v_exp_f32 v169, v169
    v_smfmac_f32_16x16x64_bf16 v[132:135], v[20:23], v[144:151], v5
    ds_read_b64_tr_b16 a[32:33], v3 offset:40960
    v_exp_f32 v170, v170
    v_smfmac_f32_32x32x32_bf16 v[80:95], a[44:47], v[152:159], v5
    s_waitcnt lgkmcnt(1)
    v_exp_f32 v171, v171
    v_exp_f32 v172, v172
    v_exp_f32 v173, v173
    v_smfmac_f32_16x16x64_bf16 v[132:135], v[20:23], v[152:159], v5
    ds_read_b64_tr_b16 a[34:35], v3 offset:41216
    v_exp_f32 v174, v174
    v_exp_f32 v175, v175
    v_mfma_f32_32x32x16_bf16 v[144:159], a[0:3], v[32:35], 4.0
    v_exp_f32 v176, v176
    v_exp_f32 v177, v177
    v_exp_f32 v178, v178
    v_mfma_f32_32x32x16_bf16 v[144:159], a[4:7], v[36:39], v[144:159]
    v_exp_f32 v179, v179
    v_exp_f32 v180, v180
    v_exp_f32 v181, v181
    v_exp_f32 v182, v182
    v_smfmac_f32_32x32x32_bf16 v[96:111], a[40:43], v[160:167], v5
    v_exp_f32 v183, v183
    v_exp_f32 v184, v184
    v_exp_f32 v185, v185
    v_smfmac_f32_16x16x64_bf16 v[136:139], v[20:23], v[160:167], v5
    ds_read_b64_tr_b16 a[36:37], v3 offset:41984
    v_exp_f32 v186, v186
    v_smfmac_f32_32x32x32_bf16 v[96:111], a[44:47], v[168:175], v5
    v_exp_f32 v187, v187
    v_exp_f32 v188, v188
    v_exp_f32 v189, v189
    v_smfmac_f32_16x16x64_bf16 v[136:139], v[20:23], v[168:175], v5
    ds_read_b64_tr_b16 a[38:39], v3 offset:42240
    v_exp_f32 v190, v190
    v_exp_f32 v191, v191
    v_mfma_f32_32x32x16_bf16 v[160:175], a[0:3], v[40:43], 4.0
    v_exp_f32 v144, v144
    v_exp_f32 v145, v145
    v_exp_f32 v146, v146
    v_mfma_f32_32x32x16_bf16 v[160:175], a[4:7], v[44:47], v[160:175]
    v_exp_f32 v147, v147
    v_exp_f32 v148, v148
    v_exp_f32 v149, v149
    v_exp_f32 v150, v150
    v_smfmac_f32_32x32x32_bf16 v[112:127], a[40:43], v[176:183], v5
    v_exp_f32 v151, v151
    v_exp_f32 v152, v152
    v_exp_f32 v153, v153
    v_smfmac_f32_16x16x64_bf16 v[140:143], v[20:23], v[176:183], v5
    v_exp_f32 v154, v154
    v_smfmac_f32_32x32x32_bf16 v[112:127], a[44:47], v[184:191], v5
    v_exp_f32 v155, v155
    v_exp_f32 v156, v156
    v_exp_f32 v157, v157
    v_smfmac_f32_16x16x64_bf16 v[140:143], v[20:23], v[184:191], v5
    v_exp_f32 v158, v158
    v_exp_f32 v159, v159
    v_mfma_f32_32x32x16_bf16 v[176:191], a[0:3], v[48:51], 4.0
    v_exp_f32 v160, v160
    v_exp_f32 v161, v161
    v_exp_f32 v162, v162
    v_mfma_f32_32x32x16_bf16 v[176:191], a[4:7], v[52:55], v[176:191]
    s_waitcnt lgkmcnt(0)
    v_exp_f32 v163, v163
    v_exp_f32 v164, v164
    v_exp_f32 v165, v165
    v_exp_f32 v166, v166
    v_smfmac_f32_32x32x32_bf16 v[64:79], a[32:35], v[144:151], v5
    v_exp_f32 v167, v167
    v_exp_f32 v168, v168
    v_exp_f32 v169, v169
    v_smfmac_f32_16x16x64_bf16 v[128:131], v[20:23], v[144:151], v5
    ds_read_b128 a[8:11], v7 offset:10240
    v_exp_f32 v170, v170
    v_smfmac_f32_32x32x32_bf16 v[64:79], a[36:39], v[152:159], v5
    v_exp_f32 v171, v171
    v_exp_f32 v172, v172
    v_exp_f32 v173, v173
    v_smfmac_f32_16x16x64_bf16 v[128:131], v[20:23], v[152:159], v5
    ds_read_b128 a[12:15], v8 offset:10240
    v_exp_f32 v174, v174
    v_exp_f32 v175, v175
    v_mfma_f32_32x32x16_bf16 v[144:159], a[0:3], v[56:59], 4.0
    v_exp_f32 v176, v176
    v_exp_f32 v177, v177
    v_exp_f32 v178, v178
    v_mfma_f32_32x32x16_bf16 v[144:159], a[4:7], v[60:63], v[144:159]
    v_exp_f32 v179, v179
    v_exp_f32 v180, v180
    v_exp_f32 v181, v181
    v_exp_f32 v182, v182
    v_smfmac_f32_32x32x32_bf16 v[80:95], a[32:35], v[160:167], v5
    v_exp_f32 v183, v183
    v_exp_f32 v184, v184
    v_exp_f32 v185, v185
    v_smfmac_f32_16x16x64_bf16 v[132:135], v[20:23], v[160:167], v5
    ds_read_b64_tr_b16 a[40:41], v3 offset:43008
    v_exp_f32 v186, v186
    v_smfmac_f32_32x32x32_bf16 v[80:95], a[36:39], v[168:175], v5
    s_waitcnt lgkmcnt(1)
    v_exp_f32 v187, v187
    v_exp_f32 v188, v188
    v_exp_f32 v189, v189
    v_smfmac_f32_16x16x64_bf16 v[132:135], v[20:23], v[168:175], v5
    ds_read_b64_tr_b16 a[42:43], v3 offset:43264
    v_exp_f32 v190, v190
    v_exp_f32 v191, v191
    v_mfma_f32_32x32x16_bf16 v[160:175], a[8:11], v[32:35], 4.0
    v_exp_f32 v144, v144
    v_exp_f32 v145, v145
    v_exp_f32 v146, v146
    v_mfma_f32_32x32x16_bf16 v[160:175], a[12:15], v[36:39], v[160:175]
    v_exp_f32 v147, v147
    v_exp_f32 v148, v148
    v_exp_f32 v149, v149
    v_exp_f32 v150, v150
    v_smfmac_f32_32x32x32_bf16 v[96:111], a[32:35], v[176:183], v5
    v_exp_f32 v151, v151
    v_exp_f32 v152, v152
    v_exp_f32 v153, v153
    v_smfmac_f32_16x16x64_bf16 v[136:139], v[20:23], v[176:183], v5
    ds_read_b64_tr_b16 a[44:45], v3 offset:44032
    v_exp_f32 v154, v154
    v_smfmac_f32_32x32x32_bf16 v[96:111], a[36:39], v[184:191], v5
    v_exp_f32 v155, v155
    v_exp_f32 v156, v156
    v_exp_f32 v157, v157
    v_smfmac_f32_16x16x64_bf16 v[136:139], v[20:23], v[184:191], v5
    ds_read_b64_tr_b16 a[46:47], v3 offset:44288
    v_exp_f32 v158, v158
    v_exp_f32 v159, v159
    v_mfma_f32_32x32x16_bf16 v[176:191], a[8:11], v[40:43], 4.0
    v_exp_f32 v160, v160
    v_exp_f32 v161, v161
    v_exp_f32 v162, v162
    v_mfma_f32_32x32x16_bf16 v[176:191], a[12:15], v[44:47], v[176:191]
    v_exp_f32 v163, v163
    v_exp_f32 v164, v164
    v_exp_f32 v165, v165
    v_exp_f32 v166, v166
    v_smfmac_f32_32x32x32_bf16 v[112:127], a[32:35], v[144:151], v5
    v_exp_f32 v167, v167
    v_exp_f32 v168, v168
    v_exp_f32 v169, v169
    v_smfmac_f32_16x16x64_bf16 v[140:143], v[20:23], v[144:151], v5
    v_exp_f32 v170, v170
    v_smfmac_f32_32x32x32_bf16 v[112:127], a[36:39], v[152:159], v5
    v_exp_f32 v171, v171
    v_exp_f32 v172, v172
    v_exp_f32 v173, v173
    v_smfmac_f32_16x16x64_bf16 v[140:143], v[20:23], v[152:159], v5
    v_exp_f32 v174, v174
    v_exp_f32 v175, v175
    v_mfma_f32_32x32x16_bf16 v[144:159], a[8:11], v[48:51], 4.0
    v_exp_f32 v176, v176
    v_exp_f32 v177, v177
    v_exp_f32 v178, v178
    v_mfma_f32_32x32x16_bf16 v[144:159], a[12:15], v[52:55], v[144:159]
    s_waitcnt lgkmcnt(0)
    v_exp_f32 v179, v179
    v_exp_f32 v180, v180
    v_exp_f32 v181, v181
    v_exp_f32 v182, v182
    v_smfmac_f32_32x32x32_bf16 v[64:79], a[40:43], v[160:167], v5
    v_exp_f32 v183, v183
    v_exp_f32 v184, v184
    v_exp_f32 v185, v185
    v_smfmac_f32_16x16x64_bf16 v[128:131], v[20:23], v[160:167], v5
    ds_read_b128 a[0:3], v7 offset:12288
    v_exp_f32 v186, v186
    v_smfmac_f32_32x32x32_bf16 v[64:79], a[44:47], v[168:175], v5
    v_exp_f32 v187, v187
    v_exp_f32 v188, v188
    v_exp_f32 v189, v189
    v_smfmac_f32_16x16x64_bf16 v[128:131], v[20:23], v[168:175], v5
    ds_read_b128 a[4:7], v8 offset:12288
    v_exp_f32 v190, v190
    v_exp_f32 v191, v191
    v_mfma_f32_32x32x16_bf16 v[160:175], a[8:11], v[56:59], 4.0
    v_exp_f32 v144, v144
    v_exp_f32 v145, v145
    v_exp_f32 v146, v146
    v_mfma_f32_32x32x16_bf16 v[160:175], a[12:15], v[60:63], v[160:175]
    v_exp_f32 v147, v147
    v_exp_f32 v148, v148
    v_exp_f32 v149, v149
    v_exp_f32 v150, v150
    v_smfmac_f32_32x32x32_bf16 v[80:95], a[40:43], v[176:183], v5
    v_exp_f32 v151, v151
    v_exp_f32 v152, v152
    v_exp_f32 v153, v153
    v_smfmac_f32_16x16x64_bf16 v[132:135], v[20:23], v[176:183], v5
    ds_read_b64_tr_b16 a[32:33], v3 offset:45056
    v_exp_f32 v154, v154
    v_smfmac_f32_32x32x32_bf16 v[80:95], a[44:47], v[184:191], v5
    s_waitcnt lgkmcnt(1)
    v_exp_f32 v155, v155
    v_exp_f32 v156, v156
    v_exp_f32 v157, v157
    v_smfmac_f32_16x16x64_bf16 v[132:135], v[20:23], v[184:191], v5
    ds_read_b64_tr_b16 a[34:35], v3 offset:45312
    v_exp_f32 v158, v158
    v_exp_f32 v159, v159
    v_mfma_f32_32x32x16_bf16 v[176:191], a[0:3], v[32:35], 4.0
    v_exp_f32 v160, v160
    v_exp_f32 v161, v161
    v_exp_f32 v162, v162
    v_mfma_f32_32x32x16_bf16 v[176:191], a[4:7], v[36:39], v[176:191]
    v_exp_f32 v163, v163
    v_exp_f32 v164, v164
    v_exp_f32 v165, v165
    v_exp_f32 v166, v166
    v_smfmac_f32_32x32x32_bf16 v[96:111], a[40:43], v[144:151], v5
    v_exp_f32 v167, v167
    v_exp_f32 v168, v168
    v_exp_f32 v169, v169
    v_smfmac_f32_16x16x64_bf16 v[136:139], v[20:23], v[144:151], v5
    ds_read_b64_tr_b16 a[36:37], v3 offset:46080
    v_exp_f32 v170, v170
    v_smfmac_f32_32x32x32_bf16 v[96:111], a[44:47], v[152:159], v5
    v_exp_f32 v171, v171
    v_exp_f32 v172, v172
    v_exp_f32 v173, v173
    v_smfmac_f32_16x16x64_bf16 v[136:139], v[20:23], v[152:159], v5
    ds_read_b64_tr_b16 a[38:39], v3 offset:46336
    v_exp_f32 v174, v174
    v_exp_f32 v175, v175
    v_mfma_f32_32x32x16_bf16 v[144:159], a[0:3], v[40:43], 4.0
    v_exp_f32 v176, v176
    v_exp_f32 v177, v177
    v_exp_f32 v178, v178
    v_mfma_f32_32x32x16_bf16 v[144:159], a[4:7], v[44:47], v[144:159]
    v_exp_f32 v179, v179
    v_exp_f32 v180, v180
    v_exp_f32 v181, v181
    v_exp_f32 v182, v182
    v_smfmac_f32_32x32x32_bf16 v[112:127], a[40:43], v[160:167], v5
    v_exp_f32 v183, v183
    v_exp_f32 v184, v184
    v_exp_f32 v185, v185
    v_smfmac_f32_16x16x64_bf16 v[140:143], v[20:23], v[160:167], v5
    v_exp_f32 v186, v186
    v_smfmac_f32_32x32x32_bf16 v[112:127], a[44:47], v[168:175], v5
    v_exp_f32 v187, v187
    v_exp_f32 v188, v188
    v_exp_f32 v189, v189
    v_smfmac_f32_16x16x64_bf16 v[140:143], v[20:23], v[168:175], v5
    v_exp_f32 v190, v190
    v_exp_f32 v191, v191
    v_mfma_f32_32x32x16_bf16 v[160:175], a[0:3], v[48:51], 4.0
    v_exp_f32 v144, v144
    v_exp_f32 v145, v145
    v_exp_f32 v146, v146
    v_mfma_f32_32x32x16_bf16 v[160:175], a[4:7], v[52:55], v[160:175]
    s_waitcnt lgkmcnt(0)
    v_exp_f32 v147, v147
    v_exp_f32 v148, v148
    v_exp_f32 v149, v149
    v_exp_f32 v150, v150
    v_smfmac_f32_32x32x32_bf16 v[64:79], a[32:35], v[176:183], v5
    v_exp_f32 v151, v151
    v_exp_f32 v152, v152
    v_exp_f32 v153, v153
    v_smfmac_f32_16x16x64_bf16 v[128:131], v[20:23], v[176:183], v5
    ds_read_b128 a[8:11], v7 offset:14336
    v_exp_f32 v154, v154
    v_smfmac_f32_32x32x32_bf16 v[64:79], a[36:39], v[184:191], v5
    v_exp_f32 v155, v155
    v_exp_f32 v156, v156
    v_exp_f32 v157, v157
    v_smfmac_f32_16x16x64_bf16 v[128:131], v[20:23], v[184:191], v5
    ds_read_b128 a[12:15], v8 offset:14336
    v_exp_f32 v158, v158
    v_exp_f32 v159, v159
    v_mfma_f32_32x32x16_bf16 v[176:191], a[0:3], v[56:59], 4.0
    v_exp_f32 v160, v160
    v_exp_f32 v161, v161
    v_exp_f32 v162, v162
    v_mfma_f32_32x32x16_bf16 v[176:191], a[4:7], v[60:63], v[176:191]
    v_exp_f32 v163, v163
    v_exp_f32 v164, v164
    v_exp_f32 v165, v165
    v_exp_f32 v166, v166
    v_smfmac_f32_32x32x32_bf16 v[80:95], a[32:35], v[144:151], v5
    v_exp_f32 v167, v167
    v_exp_f32 v168, v168
    v_exp_f32 v169, v169
    v_smfmac_f32_16x16x64_bf16 v[132:135], v[20:23], v[144:151], v5
    ds_read_b64_tr_b16 a[40:41], v3 offset:47104
    v_exp_f32 v170, v170
    v_smfmac_f32_32x32x32_bf16 v[80:95], a[36:39], v[152:159], v5
    s_waitcnt lgkmcnt(1)
    v_exp_f32 v171, v171
    v_exp_f32 v172, v172
    v_exp_f32 v173, v173
    v_smfmac_f32_16x16x64_bf16 v[132:135], v[20:23], v[152:159], v5
    ds_read_b64_tr_b16 a[42:43], v3 offset:47360
    v_exp_f32 v174, v174
    v_exp_f32 v175, v175
    v_mfma_f32_32x32x16_bf16 v[144:159], a[8:11], v[32:35], 4.0
    v_exp_f32 v176, v176
    v_exp_f32 v177, v177
    v_exp_f32 v178, v178
    v_mfma_f32_32x32x16_bf16 v[144:159], a[12:15], v[36:39], v[144:159]
    v_exp_f32 v179, v179
    v_exp_f32 v180, v180
    v_exp_f32 v181, v181
    v_exp_f32 v182, v182
    v_smfmac_f32_32x32x32_bf16 v[96:111], a[32:35], v[160:167], v5
    v_exp_f32 v183, v183
    v_exp_f32 v184, v184
    v_exp_f32 v185, v185
    v_smfmac_f32_16x16x64_bf16 v[136:139], v[20:23], v[160:167], v5
    ds_read_b64_tr_b16 a[44:45], v3 offset:48128
    v_exp_f32 v186, v186
    v_smfmac_f32_32x32x32_bf16 v[96:111], a[36:39], v[168:175], v5
    v_exp_f32 v187, v187
    v_exp_f32 v188, v188
    v_exp_f32 v189, v189
    v_smfmac_f32_16x16x64_bf16 v[136:139], v[20:23], v[168:175], v5
    ds_read_b64_tr_b16 a[46:47], v3 offset:48384
    v_exp_f32 v190, v190
    v_exp_f32 v191, v191
    v_mfma_f32_32x32x16_bf16 v[160:175], a[8:11], v[40:43], 4.0
    v_exp_f32 v144, v144
    v_exp_f32 v145, v145
    v_exp_f32 v146, v146
    v_mfma_f32_32x32x16_bf16 v[160:175], a[12:15], v[44:47], v[160:175]
    v_exp_f32 v147, v147
    v_exp_f32 v148, v148
    v_exp_f32 v149, v149
    v_exp_f32 v150, v150
    v_smfmac_f32_32x32x32_bf16 v[112:127], a[32:35], v[176:183], v5
    v_exp_f32 v151, v151
    v_exp_f32 v152, v152
    v_exp_f32 v153, v153
    v_smfmac_f32_16x16x64_bf16 v[140:143], v[20:23], v[176:183], v5
    v_exp_f32 v154, v154
    v_smfmac_f32_32x32x32_bf16 v[112:127], a[36:39], v[184:191], v5
    v_exp_f32 v155, v155
    v_exp_f32 v156, v156
    v_exp_f32 v157, v157
    v_smfmac_f32_16x16x64_bf16 v[140:143], v[20:23], v[184:191], v5
    v_exp_f32 v158, v158
    v_exp_f32 v159, v159
    v_mfma_f32_32x32x16_bf16 v[176:191], a[8:11], v[48:51], 4.0
    v_exp_f32 v160, v160
    v_exp_f32 v161, v161
    v_exp_f32 v162, v162
    v_mfma_f32_32x32x16_bf16 v[176:191], a[12:15], v[52:55], v[176:191]
    s_waitcnt lgkmcnt(0)
    v_exp_f32 v163, v163
    v_exp_f32 v164, v164
    v_exp_f32 v165, v165
    v_exp_f32 v166, v166
    v_smfmac_f32_32x32x32_bf16 v[64:79], a[40:43], v[144:151], v5
    s_barrier
    v_exp_f32 v167, v167
    v_exp_f32 v168, v168
    v_exp_f32 v169, v169
    v_smfmac_f32_16x16x64_bf16 v[128:131], v[20:23], v[144:151], v5
    ds_read_b128 a[0:3], v7 offset:16384
    v_exp_f32 v170, v170
    v_smfmac_f32_32x32x32_bf16 v[64:79], a[44:47], v[152:159], v5
    v_exp_f32 v171, v171
    v_exp_f32 v172, v172
    v_exp_f32 v173, v173
    v_smfmac_f32_16x16x64_bf16 v[128:131], v[20:23], v[152:159], v5
    ds_read_b128 a[4:7], v8 offset:16384
    v_exp_f32 v174, v174
    v_exp_f32 v175, v175
    v_mfma_f32_32x32x16_bf16 v[144:159], a[8:11], v[56:59], 4.0
    v_exp_f32 v176, v176
    v_exp_f32 v177, v177
    v_exp_f32 v178, v178
    v_mfma_f32_32x32x16_bf16 v[144:159], a[12:15], v[60:63], v[144:159]
    v_exp_f32 v179, v179
    v_exp_f32 v180, v180
    v_exp_f32 v181, v181
    v_exp_f32 v182, v182
    v_smfmac_f32_32x32x32_bf16 v[80:95], a[40:43], v[160:167], v5
    v_exp_f32 v183, v183
    v_exp_f32 v184, v184
    v_exp_f32 v185, v185
    v_smfmac_f32_16x16x64_bf16 v[132:135], v[20:23], v[160:167], v5
    ds_read_b64_tr_b16 a[32:33], v3 offset:49152
    v_exp_f32 v186, v186
    v_smfmac_f32_32x32x32_bf16 v[80:95], a[44:47], v[168:175], v5
    s_waitcnt lgkmcnt(1)
    v_exp_f32 v187, v187
    v_exp_f32 v188, v188
    v_exp_f32 v189, v189
    v_smfmac_f32_16x16x64_bf16 v[132:135], v[20:23], v[168:175], v5
    ds_read_b64_tr_b16 a[34:35], v3 offset:49408
    v_exp_f32 v190, v190
    v_exp_f32 v191, v191
    v_mfma_f32_32x32x16_bf16 v[160:175], a[0:3], v[32:35], 4.0
    v_exp_f32 v144, v144
    v_exp_f32 v145, v145
    v_exp_f32 v146, v146
    v_mfma_f32_32x32x16_bf16 v[160:175], a[4:7], v[36:39], v[160:175]
    v_exp_f32 v147, v147
    v_exp_f32 v148, v148
    v_exp_f32 v149, v149
    v_exp_f32 v150, v150
    v_smfmac_f32_32x32x32_bf16 v[96:111], a[40:43], v[176:183], v5
    v_exp_f32 v151, v151
    v_exp_f32 v152, v152
    v_exp_f32 v153, v153
    v_smfmac_f32_16x16x64_bf16 v[136:139], v[20:23], v[176:183], v5
    ds_read_b64_tr_b16 a[36:37], v3 offset:50176
    v_exp_f32 v154, v154
    v_smfmac_f32_32x32x32_bf16 v[96:111], a[44:47], v[184:191], v5
    v_exp_f32 v155, v155
    v_exp_f32 v156, v156
    v_exp_f32 v157, v157
    v_smfmac_f32_16x16x64_bf16 v[136:139], v[20:23], v[184:191], v5
    ds_read_b64_tr_b16 a[38:39], v3 offset:50432
    v_exp_f32 v158, v158
    v_exp_f32 v159, v159
    v_mfma_f32_32x32x16_bf16 v[176:191], a[0:3], v[40:43], 4.0
    v_exp_f32 v160, v160
    v_exp_f32 v161, v161
    v_exp_f32 v162, v162
    v_mfma_f32_32x32x16_bf16 v[176:191], a[4:7], v[44:47], v[176:191]
    v_exp_f32 v163, v163
    v_exp_f32 v164, v164
    v_exp_f32 v165, v165
    v_exp_f32 v166, v166
    v_smfmac_f32_32x32x32_bf16 v[112:127], a[40:43], v[144:151], v5
    v_exp_f32 v167, v167
    v_exp_f32 v168, v168
    v_exp_f32 v169, v169
    v_smfmac_f32_16x16x64_bf16 v[140:143], v[20:23], v[144:151], v5
    v_exp_f32 v170, v170
    v_smfmac_f32_32x32x32_bf16 v[112:127], a[44:47], v[152:159], v5
    v_exp_f32 v171, v171
    v_exp_f32 v172, v172
    v_exp_f32 v173, v173
    v_smfmac_f32_16x16x64_bf16 v[140:143], v[20:23], v[152:159], v5
    v_exp_f32 v174, v174
    v_exp_f32 v175, v175
    v_mfma_f32_32x32x16_bf16 v[144:159], a[0:3], v[48:51], 4.0
    v_exp_f32 v176, v176
    v_exp_f32 v177, v177
    v_exp_f32 v178, v178
    v_mfma_f32_32x32x16_bf16 v[144:159], a[4:7], v[52:55], v[144:159]
    s_waitcnt lgkmcnt(0)
    v_exp_f32 v179, v179
    v_exp_f32 v180, v180
    v_exp_f32 v181, v181
    v_exp_f32 v182, v182
    v_smfmac_f32_32x32x32_bf16 v[64:79], a[32:35], v[160:167], v5
    v_exp_f32 v183, v183
    v_exp_f32 v184, v184
    v_exp_f32 v185, v185
    v_smfmac_f32_16x16x64_bf16 v[128:131], v[20:23], v[160:167], v5
    ds_read_b128 a[8:11], v7 offset:18432
    v_exp_f32 v186, v186
    v_smfmac_f32_32x32x32_bf16 v[64:79], a[36:39], v[168:175], v5
    v_exp_f32 v187, v187
    v_exp_f32 v188, v188
    v_exp_f32 v189, v189
    v_smfmac_f32_16x16x64_bf16 v[128:131], v[20:23], v[168:175], v5
    ds_read_b128 a[12:15], v8 offset:18432
    v_exp_f32 v190, v190
    v_exp_f32 v191, v191
    v_mfma_f32_32x32x16_bf16 v[160:175], a[0:3], v[56:59], 4.0
    v_exp_f32 v144, v144
    v_exp_f32 v145, v145
    v_exp_f32 v146, v146
    v_mfma_f32_32x32x16_bf16 v[160:175], a[4:7], v[60:63], v[160:175]
    v_exp_f32 v147, v147
    v_exp_f32 v148, v148
    v_exp_f32 v149, v149
    v_exp_f32 v150, v150
    v_smfmac_f32_32x32x32_bf16 v[80:95], a[32:35], v[176:183], v5
    v_exp_f32 v151, v151
    v_exp_f32 v152, v152
    v_exp_f32 v153, v153
    v_smfmac_f32_16x16x64_bf16 v[132:135], v[20:23], v[176:183], v5
    ds_read_b64_tr_b16 a[40:41], v3 offset:51200
    v_exp_f32 v154, v154
    v_smfmac_f32_32x32x32_bf16 v[80:95], a[36:39], v[184:191], v5
    s_waitcnt lgkmcnt(1)
    v_exp_f32 v155, v155
    v_exp_f32 v156, v156
    v_exp_f32 v157, v157
    v_smfmac_f32_16x16x64_bf16 v[132:135], v[20:23], v[184:191], v5
    ds_read_b64_tr_b16 a[42:43], v3 offset:51456
    v_exp_f32 v158, v158
    v_exp_f32 v159, v159
    v_mfma_f32_32x32x16_bf16 v[176:191], a[8:11], v[32:35], 4.0
    v_exp_f32 v160, v160
    v_exp_f32 v161, v161
    v_exp_f32 v162, v162
    v_mfma_f32_32x32x16_bf16 v[176:191], a[12:15], v[36:39], v[176:191]
    v_exp_f32 v163, v163
    v_exp_f32 v164, v164
    v_exp_f32 v165, v165
    v_exp_f32 v166, v166
    v_smfmac_f32_32x32x32_bf16 v[96:111], a[32:35], v[144:151], v5
    v_exp_f32 v167, v167
    v_exp_f32 v168, v168
    v_exp_f32 v169, v169
    v_smfmac_f32_16x16x64_bf16 v[136:139], v[20:23], v[144:151], v5
    ds_read_b64_tr_b16 a[44:45], v3 offset:52224
    v_exp_f32 v170, v170
    v_smfmac_f32_32x32x32_bf16 v[96:111], a[36:39], v[152:159], v5
    v_exp_f32 v171, v171
    v_exp_f32 v172, v172
    v_exp_f32 v173, v173
    v_smfmac_f32_16x16x64_bf16 v[136:139], v[20:23], v[152:159], v5
    ds_read_b64_tr_b16 a[46:47], v3 offset:52480
    v_exp_f32 v174, v174
    v_exp_f32 v175, v175
    v_mfma_f32_32x32x16_bf16 v[144:159], a[8:11], v[40:43], 4.0
    v_exp_f32 v176, v176
    v_exp_f32 v177, v177
    v_exp_f32 v178, v178
    v_mfma_f32_32x32x16_bf16 v[144:159], a[12:15], v[44:47], v[144:159]
    v_exp_f32 v179, v179
    v_exp_f32 v180, v180
    v_exp_f32 v181, v181
    v_exp_f32 v182, v182
    v_smfmac_f32_32x32x32_bf16 v[112:127], a[32:35], v[160:167], v5
    v_exp_f32 v183, v183
    v_exp_f32 v184, v184
    v_exp_f32 v185, v185
    v_smfmac_f32_16x16x64_bf16 v[140:143], v[20:23], v[160:167], v5
    v_exp_f32 v186, v186
    v_smfmac_f32_32x32x32_bf16 v[112:127], a[36:39], v[168:175], v5
    v_exp_f32 v187, v187
    v_exp_f32 v188, v188
    v_exp_f32 v189, v189
    v_smfmac_f32_16x16x64_bf16 v[140:143], v[20:23], v[168:175], v5
    v_exp_f32 v190, v190
    v_exp_f32 v191, v191
    v_mfma_f32_32x32x16_bf16 v[160:175], a[8:11], v[48:51], 4.0
    v_exp_f32 v144, v144
    v_exp_f32 v145, v145
    v_exp_f32 v146, v146
    v_mfma_f32_32x32x16_bf16 v[160:175], a[12:15], v[52:55], v[160:175]
    s_waitcnt lgkmcnt(0)
    v_exp_f32 v147, v147
    v_exp_f32 v148, v148
    v_exp_f32 v149, v149
    v_exp_f32 v150, v150
    v_smfmac_f32_32x32x32_bf16 v[64:79], a[40:43], v[176:183], v5
L_pad6:
    s_cbranch_vccnz L_hopx
    v_exp_f32 v151, v151
    v_exp_f32 v152, v152
    v_exp_f32 v153, v153
    v_smfmac_f32_16x16x64_bf16 v[128:131], v[20:23], v[176:183], v5
    ds_read_b128 a[0:3], v7 offset:20480
    v_exp_f32 v154, v154
    v_smfmac_f32_32x32x32_bf16 v[64:79], a[44:47], v[184:191], v5
    v_exp_f32 v155, v155
    v_exp_f32 v156, v156
    v_exp_f32 v157, v157
    v_smfmac_f32_16x16x64_bf16 v[128:131], v[20:23], v[184:191], v5
    ds_read_b128 a[4:7], v8 offset:20480
    v_exp_f32 v158, v158
    v_exp_f32 v159, v159
    v_mfma_f32_32x32x16_bf16 v[176:191], a[8:11], v[56:59], 4.0
    v_exp_f32 v160, v160
    v_exp_f32 v161, v161
    v_exp_f32 v162, v162
    v_mfma_f32_32x32x16_bf16 v[176:191], a[12:15], v[60:63], v[176:191]
    v_exp_f32 v163, v163
    v_exp_f32 v164, v164
    v_exp_f32 v165, v165
    v_exp_f32 v166, v166
    v_smfmac_f32_32x32x32_bf16 v[80:95], a[40:43], v[144:151], v5
    v_exp_f32 v167, v167
    v_exp_f32 v168, v168
    v_exp_f32 v169, v169
    v_smfmac_f32_16x16x64_bf16 v[132:135], v[20:23], v[144:151], v5
    ds_read_b64_tr_b16 a[32:33], v3 offset:53248
    v_exp_f32 v170, v170
    v_smfmac_f32_32x32x32_bf16 v[80:95], a[44:47], v[152:159], v5
    s_waitcnt lgkmcnt(1)
    v_exp_f32 v171, v171
    v_exp_f32 v172, v172
    v_exp_f32 v173, v173
    v_smfmac_f32_16x16x64_bf16 v[132:135], v[20:23], v[152:159], v5
    ds_read_b64_tr_b16 a[34:35], v3 offset:53504
    v_exp_f32 v174, v174
    v_exp_f32 v175, v175
    v_mfma_f32_32x32x16_bf16 v[144:159], a[0:3], v[32:35], 4.0
    v_exp_f32 v176, v176
    v_exp_f32 v177, v177
    v_exp_f32 v178, v178
    v_mfma_f32_32x32x16_bf16 v[144:159], a[4:7], v[36:39], v[144:159]
    v_exp_f32 v179, v179
    v_exp_f32 v180, v180
    v_exp_f32 v181, v181
    v_exp_f32 v182, v182
    v_smfmac_f32_32x32x32_bf16 v[96:111], a[40:43], v[160:167], v5
    v_exp_f32 v183, v183
    v_exp_f32 v184, v184
    v_exp_f32 v185, v185
    v_smfmac_f32_16x16x64_bf16 v[136:139], v[20:23], v[160:167], v5
    ds_read_b64_tr_b16 a[36:37], v3 offset:54272
    v_exp_f32 v186, v186
    v_smfmac_f32_32x32x32_bf16 v[96:111], a[44:47], v[168:175], v5
    v_exp_f32 v187, v187
    v_exp_f32 v188, v188
    v_exp_f32 v189, v189
    v_smfmac_f32_16x16x64_bf16 v[136:139], v[20:23], v[168:175], v5
    ds_read_b64_tr_b16 a[38:39], v3 offset:54528
    v_exp_f32 v190, v190
    v_exp_f32 v191, v191
    v_mfma_f32_32x32x16_bf16 v[160:175], a[0:3], v[40:43], 4.0
    v_exp_f32 v144, v144
    v_exp_f32 v145, v145
    v_exp_f32 v146, v146
    v_mfma_f32_32x32x16_bf16 v[160:175], a[4:7], v[44:47], v[160:175]
    v_exp_f32 v147, v147
    v_exp_f32 v148, v148
    v_exp_f32 v149, v149
    v_exp_f32 v150, v150
    v_smfmac_f32_32x32x32_bf16 v[112:127], a[40:43], v[176:183], v5
    v_exp_f32 v151, v151
    v_exp_f32 v152, v152
    v_exp_f32 v153, v153
    v_smfmac_f32_16x16x64_bf16 v[140:143], v[20:23], v[176:183], v5
    v_exp_f32 v154, v154
    v_smfmac_f32_32x32x32_bf16 v[112:127], a[44:47], v[184:191], v5
    v_exp_f32 v155, v155
    v_exp_f32 v156, v156
    v_exp_f32 v157, v157
    v_smfmac_f32_16x16x64_bf16 v[140:143], v[20:23], v[184:191], v5
    v_exp_f32 v158, v158
    v_exp_f32 v159, v159
    v_mfma_f32_32x32x16_bf16 v[176:191], a[0:3], v[48:51], 4.0
    v_exp_f32 v160, v160
    v_exp_f32 v161, v161
    v_exp_f32 v162, v162
    v_mfma_f32_32x32x16_bf16 v[176:191], a[4:7], v[52:55], v[176:191]
    s_waitcnt lgkmcnt(0)
    v_exp_f32 v163, v163
    v_exp_f32 v164, v164
    v_exp_f32 v165, v165
    v_exp_f32 v166, v166
    v_smfmac_f32_32x32x32_bf16 v[64:79], a[32:35], v[144:151], v5
    v_exp_f32 v167, v167
    v_exp_f32 v168, v168
    v_exp_f32 v169, v169
    v_smfmac_f32_16x16x64_bf16 v[128:131], v[20:23], v[144:151], v5
    ds_read_b128 a[8:11], v7 offset:22528
    v_exp_f32 v170, v170
    v_smfmac_f32_32x32x32_bf16 v[64:79], a[36:39], v[152:159], v5
    v_exp_f32 v171, v171
    v_exp_f32 v172, v172
    v_exp_f32 v173, v173
    v_smfmac_f32_16x16x64_bf16 v[128:131], v[20:23], v[152:159], v5
    ds_read_b128 a[12:15], v8 offset:22528
    v_exp_f32 v174, v174
    v_exp_f32 v175, v175
    v_mfma_f32_32x32x16_bf16 v[144:159], a[0:3], v[56:59], 4.0
    v_exp_f32 v176, v176
    v_exp_f32 v177, v177
    v_exp_f32 v178, v178
    v_mfma_f32_32x32x16_bf16 v[144:159], a[4:7], v[60:63], v[144:159]
    v_exp_f32 v179, v179
    v_exp_f32 v180, v180
    v_exp_f32 v181, v181
    v_exp_f32 v182, v182
    v_smfmac_f32_32x32x32_bf16 v[80:95], a[32:35], v[160:167], v5
    v_exp_f32 v183, v183
    v_exp_f32 v184, v184
    v_exp_f32 v185, v185
    v_smfmac_f32_16x16x64_bf16 v[132:135], v[20:23], v[160:167], v5
    ds_read_b64_tr_b16 a[40:41], v3 offset:55296
    v_exp_f32 v186, v186
    v_smfmac_f32_32x32x32_bf16 v[80:95], a[36:39], v[168:175], v5
    s_waitcnt lgkmcnt(1)
    v_exp_f32 v187, v187
    v_exp_f32 v188, v188
    v_exp_f32 v189, v189
    v_smfmac_f32_16x16x64_bf16 v[132:135], v[20:23], v[168:175], v5
    ds_read_b64_tr_b16 a[42:43], v3 offset:55552
    v_exp_f32 v190, v190
    v_exp_f32 v191, v191
    v_mfma_f32_32x32x16_bf16 v[160:175], a[8:11], v[32:35], 4.0
    v_exp_f32 v144, v144
    v_exp_f32 v145, v145
    v_exp_f32 v146, v146
    v_mfma_f32_32x32x16_bf16 v[160:175], a[12:15], v[36:39], v[160:175]
    v_exp_f32 v147, v147
    v_exp_f32 v148, v148
    v_exp_f32 v149, v149
    v_exp_f32 v150, v150
    v_smfmac_f32_32x32x32_bf16 v[96:111], a[32:35], v[176:183], v5
    v_exp_f32 v151, v151
    v_exp_f32 v152, v152
    v_exp_f32 v153, v153
    v_smfmac_f32_16x16x64_bf16 v[136:139], v[20:23], v[176:183], v5
    ds_read_b64_tr_b16 a[44:45], v3 offset:56320
    v_exp_f32 v154, v154
    v_smfmac_f32_32x32x32_bf16 v[96:111], a[36:39], v[184:191], v5
    v_exp_f32 v155, v155
    v_exp_f32 v156, v156
    v_exp_f32 v157, v157
    v_smfmac_f32_16x16x64_bf16 v[136:139], v[20:23], v[184:191], v5
    ds_read_b64_tr_b16 a[46:47], v3 offset:56576
    v_exp_f32 v158, v158
    v_exp_f32 v159, v159
    v_mfma_f32_32x32x16_bf16 v[176:191], a[8:11], v[40:43], 4.0
    v_exp_f32 v160, v160
    v_exp_f32 v161, v161
    v_exp_f32 v162, v162
    v_mfma_f32_32x32x16_bf16 v[176:191], a[12:15], v[44:47], v[176:191]
    v_exp_f32 v163, v163
    v_exp_f32 v164, v164
    v_exp_f32 v165, v165
    v_exp_f32 v166, v166
    v_smfmac_f32_32x32x32_bf16 v[112:127], a[32:35], v[144:151], v5
    v_exp_f32 v167, v167
    v_exp_f32 v168, v168
    v_exp_f32 v169, v169
    v_smfmac_f32_16x16x64_bf16 v[140:143], v[20:23], v[144:151], v5
    v_exp_f32 v170, v170
    v_smfmac_f32_32x32x32_bf16 v[112:127], a[36:39], v[152:159], v5
    v_exp_f32 v171, v171
    v_exp_f32 v172, v172
    v_exp_f32 v173, v173
    v_smfmac_f32_16x16x64_bf16 v[140:143], v[20:23], v[152:159], v5
    v_exp_f32 v174, v174
    v_exp_f32 v175, v175
    v_mfma_f32_32x32x16_bf16 v[144:159], a[8:11], v[48:51], 4.0
    v_exp_f32 v176, v176
    v_exp_f32 v177, v177
    v_exp_f32 v178, v178
    v_mfma_f32_32x32x16_bf16 v[144:159], a[12:15], v[52:55], v[144:159]
    s_waitcnt lgkmcnt(0)
    v_exp_f32 v179, v179
    v_exp_f32 v180, v180
    v_exp_f32 v181, v181
    v_exp_f32 v182, v182
    v_smfmac_f32_32x32x32_bf16 v[64:79], a[40:43], v[160:167], v5
    s_barrier
    v_exp_f32 v183, v183
    v_exp_f32 v184, v184
    v_exp_f32 v185, v185
    v_smfmac_f32_16x16x64_bf16 v[128:131], v[20:23], v[160:167], v5
    ds_read_b128 a[0:3], v7 offset:24576
    v_exp_f32 v186, v186
    v_smfmac_f32_32x32x32_bf16 v[64:79], a[44:47], v[168:175], v5
    v_exp_f32 v187, v187
    v_exp_f32 v188, v188
    v_exp_f32 v189, v189
    v_smfmac_f32_16x16x64_bf16 v[128:131], v[20:23], v[168:175], v5
    ds_read_b128 a[4:7], v8 offset:24576
    v_exp_f32 v190, v190
    v_exp_f32 v191, v191
    v_mfma_f32_32x32x16_bf16 v[160:175], a[8:11], v[56:59], 4.0
    v_exp_f32 v144, v144
    v_exp_f32 v145, v145
    v_exp_f32 v146, v146
    v_mfma_f32_32x32x16_bf16 v[160:175], a[12:15], v[60:63], v[160:175]
    v_exp_f32 v147, v147
    v_exp_f32 v148, v148
    v_exp_f32 v149, v149
    v_exp_f32 v150, v150
    v_smfmac_f32_32x32x32_bf16 v[80:95], a[40:43], v[176:183], v5
    v_exp_f32 v151, v151
    v_exp_f32 v152, v152
    v_exp_f32 v153, v153
    v_smfmac_f32_16x16x64_bf16 v[132:135], v[20:23], v[176:183], v5
    ds_read_b64_tr_b16 a[32:33], v3 offset:57344
    v_exp_f32 v154, v154
    v_smfmac_f32_32x32x32_bf16 v[80:95], a[44:47], v[184:191], v5
    s_waitcnt lgkmcnt(1)
    v_exp_f32 v155, v155
    v_exp_f32 v156, v156
    v_exp_f32 v157, v157
    v_smfmac_f32_16x16x64_bf16 v[132:135], v[20:23], v[184:191], v5
    ds_read_b64_tr_b16 a[34:35], v3 offset:57600
    v_exp_f32 v158, v158
    v_exp_f32 v159, v159
    v_mfma_f32_32x32x16_bf16 v[176:191], a[0:3], v[32:35], 4.0
    v_exp_f32 v160, v160
    v_exp_f32 v161, v161
    v_exp_f32 v162, v162
    v_mfma_f32_32x32x16_bf16 v[176:191], a[4:7], v[36:39], v[176:191]
    v_exp_f32 v163, v163
    v_exp_f32 v164, v164
    v_exp_f32 v165, v165
    v_exp_f32 v166, v166
    v_smfmac_f32_32x32x32_bf16 v[96:111], a[40:43], v[144:151], v5
    v_exp_f32 v167, v167
    v_exp_f32 v168, v168
    v_exp_f32 v169, v169
    v_smfmac_f32_16x16x64_bf16 v[136:139], v[20:23], v[144:151], v5
    ds_read_b64_tr_b16 a[36:37], v3 offset:58368
    v_exp_f32 v170, v170
    v_smfmac_f32_32x32x32_bf16 v[96:111], a[44:47], v[152:159], v5
    v_exp_f32 v171, v171
    v_exp_f32 v172, v172
    v_exp_f32 v173, v173
    v_smfmac_f32_16x16x64_bf16 v[136:139], v[20:23], v[152:159], v5
    ds_read_b64_tr_b16 a[38:39], v3 offset:58624
    v_exp_f32 v174, v174
    v_exp_f32 v175, v175
    v_mfma_f32_32x32x16_bf16 v[144:159], a[0:3], v[40:43], 4.0
    v_exp_f32 v176, v176
    v_exp_f32 v177, v177
    v_exp_f32 v178, v178
    v_mfma_f32_32x32x16_bf16 v[144:159], a[4:7], v[44:47], v[144:159]
    v_exp_f32 v179, v179
    v_exp_f32 v180, v180
    v_exp_f32 v181, v181
    v_exp_f32 v182, v182
    v_smfmac_f32_32x32x32_bf16 v[112:127], a[40:43], v[160:167], v5
    v_exp_f32 v183, v183
    v_exp_f32 v184, v184
    v_exp_f32 v185, v185
    v_smfmac_f32_16x16x64_bf16 v[140:143], v[20:23], v[160:167], v5
    v_exp_f32 v186, v186
    v_smfmac_f32_32x32x32_bf16 v[112:127], a[44:47], v[168:175], v5
    v_exp_f32 v187, v187
    v_exp_f32 v188, v188
    v_exp_f32 v189, v189
    v_smfmac_f32_16x16x64_bf16 v[140:143], v[20:23], v[168:175], v5
    v_exp_f32 v190, v190
    v_exp_f32 v191, v191
    v_mfma_f32_32x32x16_bf16 v[160:175], a[0:3], v[48:51], 4.0
    v_exp_f32 v144, v144
    v_exp_f32 v145, v145
    v_exp_f32 v146, v146
    v_mfma_f32_32x32x16_bf16 v[160:175], a[4:7], v[52:55], v[160:175]
    s_waitcnt lgkmcnt(0)
    v_exp_f32 v147, v147
    v_exp_f32 v148, v148
    v_exp_f32 v149, v149
    v_exp_f32 v150, v150
    v_smfmac_f32_32x32x32_bf16 v[64:79], a[32:35], v[176:183], v5
    v_exp_f32 v151, v151
    v_exp_f32 v152, v152
    v_exp_f32 v153, v153
    v_smfmac_f32_16x16x64_bf16 v[128:131], v[20:23], v[176:183], v5
    ds_read_b128 a[8:11], v7 offset:26624
    v_exp_f32 v154, v154
    v_smfmac_f32_32x32x32_bf16 v[64:79], a[36:39], v[184:191], v5
    v_exp_f32 v155, v155
    v_exp_f32 v156, v156
    v_exp_f32 v157, v157
    v_smfmac_f32_16x16x64_bf16 v[128:131], v[20:23], v[184:191], v5
    ds_read_b128 a[12:15], v8 offset:26624
    v_exp_f32 v158, v158
    v_exp_f32 v159, v159
    v_mfma_f32_32x32x16_bf16 v[176:191], a[0:3], v[56:59], 4.0
    v_exp_f32 v160, v160
    v_exp_f32 v161, v161
    v_exp_f32 v162, v162
    v_mfma_f32_32x32x16_bf16 v[176:191], a[4:7], v[60:63], v[176:191]
    v_exp_f32 v163, v163
    v_exp_f32 v164, v164
    v_exp_f32 v165, v165
    v_exp_f32 v166, v166
    v_smfmac_f32_32x32x32_bf16 v[80:95], a[32:35], v[144:151], v5
    v_exp_f32 v167, v167
    v_exp_f32 v168, v168
    v_exp_f32 v169, v169
    v_smfmac_f32_16x16x64_bf16 v[132:135], v[20:23], v[144:151], v5
    ds_read_b64_tr_b16 a[40:41], v3 offset:59392
    v_exp_f32 v170, v170
    v_smfmac_f32_32x32x32_bf16 v[80:95], a[36:39], v[152:159], v5
    s_waitcnt lgkmcnt(1)
    v_exp_f32 v171, v171
    v_exp_f32 v172, v172
    v_exp_f32 v173, v173
    v_smfmac_f32_16x16x64_bf16 v[132:135], v[20:23], v[152:159], v5
    ds_read_b64_tr_b16 a[42:43], v3 offset:59648
    v_exp_f32 v174, v174
    v_exp_f32 v175, v175
    v_mfma_f32_32x32x16_bf16 v[144:159], a[8:11], v[32:35], 4.0
    v_exp_f32 v176, v176
    v_exp_f32 v177, v177
    v_exp_f32 v178, v178
    v_mfma_f32_32x32x16_bf16 v[144:159], a[12:15], v[36:39], v[144:159]
    v_exp_f32 v179, v179
    v_exp_f32 v180, v180
    v_exp_f32 v181, v181
    v_exp_f32 v182, v182
    v_smfmac_f32_32x32x32_bf16 v[96:111], a[32:35], v[160:167], v5
    v_exp_f32 v183, v183
    v_exp_f32 v184, v184
    v_exp_f32 v185, v185
    v_smfmac_f32_16x16x64_bf16 v[136:139], v[20:23], v[160:167], v5
    ds_read_b64_tr_b16 a[44:45], v3 offset:60416
    v_exp_f32 v186, v186
    v_smfmac_f32_32x32x32_bf16 v[96:111], a[36:39], v[168:175], v5
    v_exp_f32 v187, v187
    v_exp_f32 v188, v188
    v_exp_f32 v189, v189
    v_smfmac_f32_16x16x64_bf16 v[136:139], v[20:23], v[168:175], v5
    ds_read_b64_tr_b16 a[46:47], v3 offset:60672
    v_exp_f32 v190, v190
    v_exp_f32 v191, v191
    v_mfma_f32_32x32x16_bf16 v[160:175], a[8:11], v[40:43], 4.0
    v_exp_f32 v144, v144
    v_exp_f32 v145, v145
    v_exp_f32 v146, v146
    v_mfma_f32_32x32x16_bf16 v[160:175], a[12:15], v[44:47], v[160:175]
    v_exp_f32 v147, v147
    v_exp_f32 v148, v148
    v_exp_f32 v149, v149
    v_exp_f32 v150, v150
    v_smfmac_f32_32x32x32_bf16 v[112:127], a[32:35], v[176:183], v5
    v_exp_f32 v151, v151
    v_exp_f32 v152, v152
    v_exp_f32 v153, v153
    v_smfmac_f32_16x16x64_bf16 v[140:143], v[20:23], v[176:183], v5
    v_exp_f32 v154, v154
    v_smfmac_f32_32x32x32_bf16 v[112:127], a[36:39], v[184:191], v5
    v_exp_f32 v155, v155
    v_exp_f32 v156, v156
    v_exp_f32 v157, v157
    v_smfmac_f32_16x16x64_bf16 v[140:143], v[20:23], v[184:191], v5
    v_exp_f32 v158, v158
    v_exp_f32 v159, v159
    v_mfma_f32_32x32x16_bf16 v[176:191], a[8:11], v[48:51], 4.0
    v_exp_f32 v160, v160
    v_exp_f32 v161, v161
    v_exp_f32 v162, v162
    v_mfma_f32_32x32x16_bf16 v[176:191], a[12:15], v[52:55], v[176:191]
    s_waitcnt lgkmcnt(0)
    v_exp_f32 v163, v163
    v_exp_f32 v164, v164
    v_exp_f32 v165, v165
    v_exp_f32 v166, v166
    v_smfmac_f32_32x32x32_bf16 v[64:79], a[40:43], v[144:151], v5
    v_exp_f32 v167, v167
    v_exp_f32 v168, v168
    v_exp_f32 v169, v169
    v_smfmac_f32_16x16x64_bf16 v[128:131], v[20:23], v[144:151], v5
    ds_read_b128 a[0:3], v7 offset:28672
    v_exp_f32 v170, v170
    v_smfmac_f32_32x32x32_bf16 v[64:79], a[44:47], v[152:159], v5
    v_exp_f32 v171, v171
    v_exp_f32 v172, v172
    v_exp_f32 v173, v173
    v_smfmac_f32_16x16x64_bf16 v[128:131], v[20:23], v[152:159], v5
    ds_read_b128 a[4:7], v8 offset:28672
    v_exp_f32 v174, v174
    v_exp_f32 v175, v175
    v_mfma_f32_32x32x16_bf16 v[144:159], a[8:11], v[56:59], 4.0
    v_exp_f32 v176, v176
    v_exp_f32 v177, v177
    v_exp_f32 v178, v178
    v_mfma_f32_32x32x16_bf16 v[144:159], a[12:15], v[60:63], v[144:159]
    v_exp_f32 v179, v179
    v_exp_f32 v180, v180
    v_exp_f32 v181, v181
    v_exp_f32 v182, v182
    v_smfmac_f32_32x32x32_bf16 v[80:95], a[40:43], v[160:167], v5
    v_exp_f32 v183, v183
    v_exp_f32 v184, v184
    v_exp_f32 v185, v185
    v_smfmac_f32_16x16x64_bf16 v[132:135], v[20:23], v[160:167], v5
    ds_read_b64_tr_b16 a[32:33], v3 offset:61440
    v_exp_f32 v186, v186
    v_smfmac_f32_32x32x32_bf16 v[80:95], a[44:47], v[168:175], v5
    s_waitcnt lgkmcnt(1)
    v_exp_f32 v187, v187
    v_exp_f32 v188, v188
    v_exp_f32 v189, v189
    v_smfmac_f32_16x16x64_bf16 v[132:135], v[20:23], v[168:175], v5
    ds_read_b64_tr_b16 a[34:35], v3 offset:61696
    v_exp_f32 v190, v190
    v_exp_f32 v191, v191
    v_mfma_f32_32x32x16_bf16 v[160:175], a[0:3], v[32:35], 4.0
    v_exp_f32 v144, v144
    v_exp_f32 v145, v145
    v_exp_f32 v146, v146
    v_mfma_f32_32x32x16_bf16 v[160:175], a[4:7], v[36:39], v[160:175]
    v_exp_f32 v147, v147
    v_exp_f32 v148, v148
    v_exp_f32 v149, v149
    v_exp_f32 v150, v150
    v_smfmac_f32_32x32x32_bf16 v[96:111], a[40:43], v[176:183], v5
    v_exp_f32 v151, v151
    v_exp_f32 v152, v152
    v_exp_f32 v153, v153
    v_smfmac_f32_16x16x64_bf16 v[136:139], v[20:23], v[176:183], v5
    ds_read_b64_tr_b16 a[36:37], v3 offset:62464
    v_exp_f32 v154, v154
    v_smfmac_f32_32x32x32_bf16 v[96:111], a[44:47], v[184:191], v5
    v_exp_f32 v155, v155
    v_exp_f32 v156, v156
    v_exp_f32 v157, v157
    v_smfmac_f32_16x16x64_bf16 v[136:139], v[20:23], v[184:191], v5
    ds_read_b64_tr_b16 a[38:39], v3 offset:62720
    v_exp_f32 v158, v158
    v_exp_f32 v159, v159
    v_mfma_f32_32x32x16_bf16 v[176:191], a[0:3], v[40:43], 4.0
    v_exp_f32 v160, v160
    v_exp_f32 v161, v161
    v_exp_f32 v162, v162
    v_mfma_f32_32x32x16_bf16 v[176:191], a[4:7], v[44:47], v[176:191]
    v_exp_f32 v163, v163
    v_exp_f32 v164, v164
    v_exp_f32 v165, v165
    v_exp_f32 v166, v166
    v_smfmac_f32_32x32x32_bf16 v[112:127], a[40:43], v[144:151], v5
    v_exp_f32 v167, v167
    v_exp_f32 v168, v168
    v_exp_f32 v169, v169
    v_smfmac_f32_16x16x64_bf16 v[140:143], v[20:23], v[144:151], v5
    v_exp_f32 v170, v170
    v_smfmac_f32_32x32x32_bf16 v[112:127], a[44:47], v[152:159], v5
    v_exp_f32 v171, v171
    v_exp_f32 v172, v172
    v_exp_f32 v173, v173
    v_smfmac_f32_16x16x64_bf16 v[140:143], v[20:23], v[152:159], v5
    v_exp_f32 v174, v174
    v_exp_f32 v175, v175
    v_mfma_f32_32x32x16_bf16 v[144:159], a[0:3], v[48:51], 4.0
    v_exp_f32 v176, v176
    v_exp_f32 v177, v177
    v_exp_f32 v178, v178
    v_mfma_f32_32x32x16_bf16 v[144:159], a[4:7], v[52:55], v[144:159]
    s_waitcnt lgkmcnt(0)
    v_exp_f32 v179, v179
    v_exp_f32 v180, v180
    v_exp_f32 v181, v181
    v_exp_f32 v182, v182
    v_smfmac_f32_32x32x32_bf16 v[64:79], a[32:35], v[160:167], v5
    v_exp_f32 v183, v183
    v_exp_f32 v184, v184
    v_exp_f32 v185, v185
    v_smfmac_f32_16x16x64_bf16 v[128:131], v[20:23], v[160:167], v5
    ds_read_b128 a[8:11], v7 offset:30720
    v_exp_f32 v186, v186
    v_smfmac_f32_32x32x32_bf16 v[64:79], a[36:39], v[168:175], v5
    v_exp_f32 v187, v187
    v_exp_f32 v188, v188
    v_exp_f32 v189, v189
    v_smfmac_f32_16x16x64_bf16 v[128:131], v[20:23], v[168:175], v5
    ds_read_b128 a[12:15], v8 offset:30720
    v_exp_f32 v190, v190
    v_exp_f32 v191, v191
    v_mfma_f32_32x32x16_bf16 v[160:175], a[0:3], v[56:59], 4.0
    v_exp_f32 v144, v144
    v_exp_f32 v145, v145
    v_exp_f32 v146, v146
    v_mfma_f32_32x32x16_bf16 v[160:175], a[4:7], v[60:63], v[160:175]
    v_exp_f32 v147, v147
    v_exp_f32 v148, v148
    v_exp_f32 v149, v149
    v_exp_f32 v150, v150
    v_smfmac_f32_32x32x32_bf16 v[80:95], a[32:35], v[176:183], v5
    v_exp_f32 v151, v151
    v_exp_f32 v152, v152
    v_exp_f32 v153, v153
    v_smfmac_f32_16x16x64_bf16 v[132:135], v[20:23], v[176:183], v5
    ds_read_b64_tr_b16 a[40:41], v3 offset:63488
    v_exp_f32 v154, v154
    v_smfmac_f32_32x32x32_bf16 v[80:95], a[36:39], v[184:191], v5
    s_waitcnt lgkmcnt(1)
    v_exp_f32 v155, v155
    v_exp_f32 v156, v156
    v_exp_f32 v157, v157
    v_smfmac_f32_16x16x64_bf16 v[132:135], v[20:23], v[184:191], v5
    ds_read_b64_tr_b16 a[42:43], v3 offset:63744
    v_exp_f32 v158, v158
    v_exp_f32 v159, v159
    v_mfma_f32_32x32x16_bf16 v[176:191], a[8:11], v[32:35], 4.0
    v_exp_f32 v160, v160
    v_exp_f32 v161, v161
    v_exp_f32 v162, v162
    v_mfma_f32_32x32x16_bf16 v[176:191], a[12:15], v[36:39], v[176:191]
    v_exp_f32 v163, v163
    v_exp_f32 v164, v164
    v_exp_f32 v165, v165
    v_exp_f32 v166, v166
    v_smfmac_f32_32x32x32_bf16 v[96:111], a[32:35], v[144:151], v5
    v_exp_f32 v167, v167
    v_exp_f32 v168, v168
    v_exp_f32 v169, v169
    v_smfmac_f32_16x16x64_bf16 v[136:139], v[20:23], v[144:151], v5
    ds_read_b64_tr_b16 a[44:45], v3 offset:64512
    v_exp_f32 v170, v170
    v_smfmac_f32_32x32x32_bf16 v[96:111], a[36:39], v[152:159], v5
    v_exp_f32 v171, v171
    v_exp_f32 v172, v172
    v_exp_f32 v173, v173
    v_smfmac_f32_16x16x64_bf16 v[136:139], v[20:23], v[152:159], v5
    ds_read_b64_tr_b16 a[46:47], v3 offset:64768
    v_exp_f32 v174, v174
    v_exp_f32 v175, v175
    v_mfma_f32_32x32x16_bf16 v[144:159], a[8:11], v[40:43], 4.0
    v_exp_f32 v176, v176
    v_exp_f32 v177, v177
    v_exp_f32 v178, v178
    v_mfma_f32_32x32x16_bf16 v[144:159], a[12:15], v[44:47], v[144:159]
    v_exp_f32 v179, v179
    v_exp_f32 v180, v180
    v_exp_f32 v181, v181
    v_exp_f32 v182, v182
    v_smfmac_f32_32x32x32_bf16 v[112:127], a[32:35], v[160:167], v5
    v_exp_f32 v183, v183
    v_exp_f32 v184, v184
    v_exp_f32 v185, v185
    v_smfmac_f32_16x16x64_bf16 v[140:143], v[20:23], v[160:167], v5
    v_exp_f32 v186, v186
    v_smfmac_f32_32x32x32_bf16 v[112:127], a[36:39], v[168:175], v5
    v_exp_f32 v187, v187
    v_exp_f32 v188, v188
    v_exp_f32 v189, v189
    v_smfmac_f32_16x16x64_bf16 v[140:143], v[20:23], v[168:175], v5
    v_exp_f32 v190, v190
    v_exp_f32 v191, v191
    v_mfma_f32_32x32x16_bf16 v[160:175], a[8:11], v[48:51], 4.0
    v_exp_f32 v144, v144
    v_exp_f32 v145, v145
    v_exp_f32 v146, v146
    v_mfma_f32_32x32x16_bf16 v[160:175], a[12:15], v[52:55], v[160:175]
    s_waitcnt lgkmcnt(0)
    v_exp_f32 v147, v147
    v_exp_f32 v148, v148
    v_exp_f32 v149, v149
    v_exp_f32 v150, v150
    v_smfmac_f32_32x32x32_bf16 v[64:79], a[40:43], v[176:183], v5
    s_barrier
    v_exp_f32 v151, v151
    v_exp_f32 v152, v152
    v_exp_f32 v153, v153
    v_smfmac_f32_16x16x64_bf16 v[128:131], v[20:23], v[176:183], v5
    ds_read_b128 a[0:3], v7 offset:0
    v_exp_f32 v154, v154
    v_smfmac_f32_32x32x32_bf16 v[64:79], a[44:47], v[184:191], v5
    v_exp_f32 v155, v155
    v_exp_f32 v156, v156
    v_exp_f32 v157, v157
    v_smfmac_f32_16x16x64_bf16 v[128:131], v[20:23], v[184:191], v5
    ds_read_b128 a[4:7], v8 offset:0
    v_exp_f32 v158, v158
    v_exp_f32 v159, v159
    v_mfma_f32_32x32x16_bf16 v[176:191], a[8:11], v[56:59], 4.0
    v_exp_f32 v160, v160
    v_exp_f32 v161, v161
    v_exp_f32 v162, v162
    v_mfma_f32_32x32x16_bf16 v[176:191], a[12:15], v[60:63], v[176:191]
    v_exp_f32 v163, v163
    v_exp_f32 v164, v164
    v_exp_f32 v165, v165
    v_exp_f32 v166, v166
    v_smfmac_f32_32x32x32_bf16 v[80:95], a[40:43], v[144:151], v5
    v_exp_f32 v167, v167
    v_exp_f32 v168, v168
    v_exp_f32 v169, v169
    v_smfmac_f32_16x16x64_bf16 v[132:135], v[20:23], v[144:151], v5
    ds_read_b64_tr_b16 a[32:33], v3 offset:32768
    v_exp_f32 v170, v170
    v_smfmac_f32_32x32x32_bf16 v[80:95], a[44:47], v[152:159], v5
    s_waitcnt lgkmcnt(1)
    v_exp_f32 v171, v171
    v_exp_f32 v172, v172
    v_exp_f32 v173, v173
    v_smfmac_f32_16x16x64_bf16 v[132:135], v[20:23], v[152:159], v5
    ds_read_b64_tr_b16 a[34:35], v3 offset:33024
    v_exp_f32 v174, v174
    v_exp_f32 v175, v175
    v_mfma_f32_32x32x16_bf16 v[144:159], a[0:3], v[32:35], 4.0
    v_exp_f32 v176, v176
    v_exp_f32 v177, v177
    v_exp_f32 v178, v178
    v_mfma_f32_32x32x16_bf16 v[144:159], a[4:7], v[36:39], v[144:159]
    v_exp_f32 v179, v179
    v_exp_f32 v180, v180
    v_exp_f32 v181, v181
    v_exp_f32 v182, v182
    v_smfmac_f32_32x32x32_bf16 v[96:111], a[40:43], v[160:167], v5
    v_exp_f32 v183, v183
    v_exp_f32 v184, v184
    v_exp_f32 v185, v185
    v_smfmac_f32_16x16x64_bf16 v[136:139], v[20:23], v[160:167], v5
    ds_read_b64_tr_b16 a[36:37], v3 offset:33792
    v_exp_f32 v186, v186
    v_smfmac_f32_32x32x32_bf16 v[96:111], a[44:47], v[168:175], v5
    v_exp_f32 v187, v187
    v_exp_f32 v188, v188
    v_exp_f32 v189, v189
    v_smfmac_f32_16x16x64_bf16 v[136:139], v[20:23], v[168:175], v5
    ds_read_b64_tr_b16 a[38:39], v3 offset:34048
    v_exp_f32 v190, v190
    v_exp_f32 v191, v191
    v_mfma_f32_32x32x16_bf16 v[160:175], a[0:3], v[40:43], 4.0
    v_exp_f32 v144, v144
    v_exp_f32 v145, v145
    v_exp_f32 v146, v146
    v_mfma_f32_32x32x16_bf16 v[160:175], a[4:7], v[44:47], v[160:175]
    v_exp_f32 v147, v147
    v_exp_f32 v148, v148
    v_exp_f32 v149, v149
    v_exp_f32 v150, v150
    v_smfmac_f32_32x32x32_bf16 v[112:127], a[40:43], v[176:183], v5
    v_exp_f32 v151, v151
    v_exp_f32 v152, v152
    v_exp_f32 v153, v153
    v_smfmac_f32_16x16x64_bf16 v[140:143], v[20:23], v[176:183], v5
    v_exp_f32 v154, v154
    v_smfmac_f32_32x32x32_bf16 v[112:127], a[44:47], v[184:191], v5
    v_exp_f32 v155, v155
    v_exp_f32 v156, v156
    v_exp_f32 v157, v157
    v_smfmac_f32_16x16x64_bf16 v[140:143], v[20:23], v[184:191], v5
    v_exp_f32 v158, v158
    v_exp_f32 v159, v159
    v_mfma_f32_32x32x16_bf16 v[176:191], a[0:3], v[48:51], 4.0
    v_exp_f32 v160, v160
    v_exp_f32 v161, v161
    v_exp_f32 v162, v162
    v_mfma_f32_32x32x16_bf16 v[176:191], a[4:7], v[52:55], v[176:191]
    s_waitcnt lgkmcnt(0)
    v_exp_f32 v163, v163
    v_exp_f32 v164, v164
    v_exp_f32 v165, v165
    v_exp_f32 v166, v166
    v_smfmac_f32_32x32x32_bf16 v[64:79], a[32:35], v[144:151], v5
    v_exp_f32 v167, v167
    v_exp_f32 v168, v168
    v_exp_f32 v169, v169
    v_smfmac_f32_16x16x64_bf16 v[128:131], v[20:23], v[144:151], v5
    ds_read_b128 a[8:11], v7 offset:2048
    v_exp_f32 v170, v170
    v_smfmac_f32_32x32x32_bf16 v[64:79], a[36:39], v[152:159], v5
    v_exp_f32 v171, v171
    v_exp_f32 v172, v172
    v_exp_f32 v173, v173
    v_smfmac_f32_16x16x64_bf16 v[128:131], v[20:23], v[152:159], v5
    ds_read_b128 a[12:15], v8 offset:2048
    v_exp_f32 v174, v174
    v_exp_f32 v175, v175
    v_mfma_f32_32x32x16_bf16 v[144:159], a[0:3], v[56:59], 4.0
    v_exp_f32 v176, v176
    v_exp_f32 v177, v177
    v_exp_f32 v178, v178
    v_mfma_f32_32x32x16_bf16 v[144:159], a[4:7], v[60:63], v[144:159]
    v_exp_f32 v179, v179
    v_exp_f32 v180, v180
    v_exp_f32 v181, v181
    v_exp_f32 v182, v182
    v_smfmac_f32_32x32x32_bf16 v[80:95], a[32:35], v[160:167], v5
    v_exp_f32 v183, v183
    v_exp_f32 v184, v184
    v_exp_f32 v185, v185
    v_smfmac_f32_16x16x64_bf16 v[132:135], v[20:23], v[160:167], v5
    ds_read_b64_tr_b16 a[40:41], v3 offset:34816
    v_exp_f32 v186, v186
    v_smfmac_f32_32x32x32_bf16 v[80:95], a[36:39], v[168:175], v5
    s_waitcnt lgkmcnt(1)
    v_exp_f32 v187, v187
    v_exp_f32 v188, v188
    v_exp_f32 v189, v189
    v_smfmac_f32_16x16x64_bf16 v[132:135], v[20:23], v[168:175], v5
    ds_read_b64_tr_b16 a[42:43], v3 offset:35072
    v_exp_f32 v190, v190
    v_exp_f32 v191, v191
    v_mfma_f32_32x32x16_bf16 v[160:175], a[8:11], v[32:35], 4.0
    v_exp_f32 v144, v144
    v_exp_f32 v145, v145
    v_exp_f32 v146, v146
    v_mfma_f32_32x32x16_bf16 v[160:175], a[12:15], v[36:39], v[160:175]
    v_exp_f32 v147, v147
    v_exp_f32 v148, v148
    v_exp_f32 v149, v149
    v_exp_f32 v150, v150
    v_smfmac_f32_32x32x32_bf16 v[96:111], a[32:35], v[176:183], v5
    v_exp_f32 v151, v151
    v_exp_f32 v152, v152
    v_exp_f32 v153, v153
    v_smfmac_f32_16x16x64_bf16 v[136:139], v[20:23], v[176:183], v5
    ds_read_b64_tr_b16 a[44:45], v3 offset:35840
    v_exp_f32 v154, v154
    v_smfmac_f32_32x32x32_bf16 v[96:111], a[36:39], v[184:191], v5
    v_exp_f32 v155, v155
    v_exp_f32 v156, v156
    v_exp_f32 v157, v157
    v_smfmac_f32_16x16x64_bf16 v[136:139], v[20:23], v[184:191], v5
    ds_read_b64_tr_b16 a[46:47], v3 offset:36096
    v_exp_f32 v158, v158
    v_exp_f32 v159, v159
    v_mfma_f32_32x32x16_bf16 v[176:191], a[8:11], v[40:43], 4.0
    v_exp_f32 v160, v160
    v_exp_f32 v161, v161
    v_exp_f32 v162, v162
    v_mfma_f32_32x32x16_bf16 v[176:191], a[12:15], v[44:47], v[176:191]
    v_exp_f32 v163, v163
    v_exp_f32 v164, v164
    v_exp_f32 v165, v165
    v_exp_f32 v166, v166
    v_smfmac_f32_32x32x32_bf16 v[112:127], a[32:35], v[144:151], v5
    v_exp_f32 v167, v167
    v_exp_f32 v168, v168
    v_exp_f32 v169, v169
    v_smfmac_f32_16x16x64_bf16 v[140:143], v[20:23], v[144:151], v5
    v_exp_f32 v170, v170
    v_smfmac_f32_32x32x32_bf16 v[112:127], a[36:39], v[152:159], v5
    v_exp_f32 v171, v171
    v_exp_f32 v172, v172
    v_exp_f32 v173, v173
    v_smfmac_f32_16x16x64_bf16 v[140:143], v[20:23], v[152:159], v5
    v_exp_f32 v174, v174
    v_exp_f32 v175, v175
    v_mfma_f32_32x32x16_bf16 v[144:159], a[8:11], v[48:51], 4.0
    v_exp_f32 v176, v176
    v_exp_f32 v177, v177
    v_exp_f32 v178, v178
    v_mfma_f32_32x32x16_bf16 v[144:159], a[12:15], v[52:55], v[144:159]
    s_waitcnt lgkmcnt(0)
    v_exp_f32 v179, v179
    v_exp_f32 v180, v180
    v_exp_f32 v181, v181
    v_exp_f32 v182, v182
    v_smfmac_f32_32x32x32_bf16 v[64:79], a[40:43], v[160:167], v5
    v_exp_f32 v183, v183
    v_exp_f32 v184, v184
    v_exp_f32 v185, v185
    v_smfmac_f32_16x16x64_bf16 v[128:131], v[20:23], v[160:167], v5
    ds_read_b128 a[0:3], v7 offset:4096
    v_exp_f32 v186, v186
    v_smfmac_f32_32x32x32_bf16 v[64:79], a[44:47], v[168:175], v5
L_pad7:
    s_cbranch_vccnz L_hopx
    v_exp_f32 v187, v187
    v_exp_f32 v188, v188
    v_exp_f32 v189, v189
    v_smfmac_f32_16x16x64_bf16 v[128:131], v[20:23], v[168:175], v5
    ds_read_b128 a[4:7], v8 offset:4096
    v_exp_f32 v190, v190
    v_exp_f32 v191, v191
    v_mfma_f32_32x32x16_bf16 v[160:175], a[8:11], v[56:59], 4.0
    v_exp_f32 v144, v144
    v_exp_f32 v145, v145
    v_exp_f32 v146, v146
    v_mfma_f32_32x32x16_bf16 v[160:175], a[12:15], v[60:63], v[160:175]
    v_exp_f32 v147, v147
    v_exp_f32 v148, v148
    v_exp_f32 v149, v149
    v_exp_f32 v150, v150
    v_smfmac_f32_32x32x32_bf16 v[80:95], a[40:43], v[176:183], v5
    v_exp_f32 v151, v151
    v_exp_f32 v152, v152
    v_exp_f32 v153, v153
    v_smfmac_f32_16x16x64_bf16 v[132:135], v[20:23], v[176:183], v5
    ds_read_b64_tr_b16 a[32:33], v3 offset:36864
    v_exp_f32 v154, v154
    v_smfmac_f32_32x32x32_bf16 v[80:95], a[44:47], v[184:191], v5
    s_waitcnt lgkmcnt(1)
    v_exp_f32 v155, v155
    v_exp_f32 v156, v156
    v_exp_f32 v157, v157
    v_smfmac_f32_16x16x64_bf16 v[132:135], v[20:23], v[184:191], v5
    ds_read_b64_tr_b16 a[34:35], v3 offset:37120
    v_exp_f32 v158, v158
    v_exp_f32 v159, v159
    v_mfma_f32_32x32x16_bf16 v[176:191], a[0:3], v[32:35], 4.0
    v_exp_f32 v160, v160
    v_exp_f32 v161, v161
    v_exp_f32 v162, v162
    v_mfma_f32_32x32x16_bf16 v[176:191], a[4:7], v[36:39], v[176:191]
    v_exp_f32 v163, v163
    v_exp_f32 v164, v164
    v_exp_f32 v165, v165
    v_exp_f32 v166, v166
    v_smfmac_f32_32x32x32_bf16 v[96:111], a[40:43], v[144:151], v5
    v_exp_f32 v167, v167
    v_exp_f32 v168, v168
    v_exp_f32 v169, v169
    v_smfmac_f32_16x16x64_bf16 v[136:139], v[20:23], v[144:151], v5
    ds_read_b64_tr_b16 a[36:37], v3 offset:37888
    v_exp_f32 v170, v170
    v_smfmac_f32_32x32x32_bf16 v[96:111], a[44:47], v[152:159], v5
    v_exp_f32 v171, v171
    v_exp_f32 v172, v172
    v_exp_f32 v173, v173
    v_smfmac_f32_16x16x64_bf16 v[136:139], v[20:23], v[152:159], v5
    ds_read_b64_tr_b16 a[38:39], v3 offset:38144
    v_exp_f32 v174, v174
    v_exp_f32 v175, v175
    v_mfma_f32_32x32x16_bf16 v[144:159], a[0:3], v[40:43], 4.0
    v_exp_f32 v176, v176
    v_exp_f32 v177, v177
    v_exp_f32 v178, v178
    v_mfma_f32_32x32x16_bf16 v[144:159], a[4:7], v[44:47], v[144:159]
    v_exp_f32 v179, v179
    v_exp_f32 v180, v180
    v_exp_f32 v181, v181
    v_exp_f32 v182, v182
    v_smfmac_f32_32x32x32_bf16 v[112:127], a[40:43], v[160:167], v5
    v_exp_f32 v183, v183
    v_exp_f32 v184, v184
    v_exp_f32 v185, v185
    v_smfmac_f32_16x16x64_bf16 v[140:143], v[20:23], v[160:167], v5
    v_exp_f32 v186, v186
    v_smfmac_f32_32x32x32_bf16 v[112:127], a[44:47], v[168:175], v5
    v_exp_f32 v187, v187
    v_exp_f32 v188, v188
    v_exp_f32 v189, v189
    v_smfmac_f32_16x16x64_bf16 v[140:143], v[20:23], v[168:175], v5
    v_exp_f32 v190, v190
    v_exp_f32 v191, v191
    v_mfma_f32_32x32x16_bf16 v[160:175], a[0:3], v[48:51], 4.0
    v_exp_f32 v144, v144
    v_exp_f32 v145, v145
    v_exp_f32 v146, v146
    v_mfma_f32_32x32x16_bf16 v[160:175], a[4:7], v[52:55], v[160:175]
    s_waitcnt lgkmcnt(0)
    v_exp_f32 v147, v147
    v_exp_f32 v148, v148
    v_exp_f32 v149, v149
    v_exp_f32 v150, v150
    v_smfmac_f32_32x32x32_bf16 v[64:79], a[32:35], v[176:183], v5
    v_exp_f32 v151, v151
    v_exp_f32 v152, v152
    v_exp_f32 v153, v153
    v_smfmac_f32_16x16x64_bf16 v[128:131], v[20:23], v[176:183], v5
    ds_read_b128 a[8:11], v7 offset:6144
    v_exp_f32 v154, v154
    v_smfmac_f32_32x32x32_bf16 v[64:79], a[36:39], v[184:191], v5
    v_exp_f32 v155, v155
    v_exp_f32 v156, v156
    v_exp_f32 v157, v157
    v_smfmac_f32_16x16x64_bf16 v[128:131], v[20:23], v[184:191], v5
    ds_read_b128 a[12:15], v8 offset:6144
    v_exp_f32 v158, v158
    v_exp_f32 v159, v159
    v_mfma_f32_32x32x16_bf16 v[176:191], a[0:3], v[56:59], 4.0
    v_exp_f32 v160, v160
    v_exp_f32 v161, v161
    v_exp_f32 v162, v162
    v_mfma_f32_32x32x16_bf16 v[176:191], a[4:7], v[60:63], v[176:191]
    v_exp_f32 v163, v163
    v_exp_f32 v164, v164
    v_exp_f32 v165, v165
    v_exp_f32 v166, v166
    v_smfmac_f32_32x32x32_bf16 v[80:95], a[32:35], v[144:151], v5
    v_exp_f32 v167, v167
    v_exp_f32 v168, v168
    v_exp_f32 v169, v169
    v_smfmac_f32_16x16x64_bf16 v[132:135], v[20:23], v[144:151], v5
    ds_read_b64_tr_b16 a[40:41], v3 offset:38912
    v_exp_f32 v170, v170
    v_smfmac_f32_32x32x32_bf16 v[80:95], a[36:39], v[152:159], v5
    s_waitcnt lgkmcnt(1)
    v_exp_f32 v171, v171
    v_exp_f32 v172, v172
    v_exp_f32 v173, v173
    v_smfmac_f32_16x16x64_bf16 v[132:135], v[20:23], v[152:159], v5
    ds_read_b64_tr_b16 a[42:43], v3 offset:39168
    v_exp_f32 v174, v174
    v_exp_f32 v175, v175
    v_mfma_f32_32x32x16_bf16 v[144:159], a[8:11], v[32:35], 4.0
    v_exp_f32 v176, v176
    v_exp_f32 v177, v177
    v_exp_f32 v178, v178
    v_mfma_f32_32x32x16_bf16 v[144:159], a[12:15], v[36:39], v[144:159]
    v_exp_f32 v179, v179
    v_exp_f32 v180, v180
    v_exp_f32 v181, v181
    v_exp_f32 v182, v182
    v_smfmac_f32_32x32x32_bf16 v[96:111], a[32:35], v[160:167], v5
    v_exp_f32 v183, v183
    v_exp_f32 v184, v184
    v_exp_f32 v185, v185
    v_smfmac_f32_16x16x64_bf16 v[136:139], v[20:23], v[160:167], v5
    ds_read_b64_tr_b16 a[44:45], v3 offset:39936
    v_exp_f32 v186, v186
    v_smfmac_f32_32x32x32_bf16 v[96:111], a[36:39], v[168:175], v5
    v_exp_f32 v187, v187
    v_exp_f32 v188, v188
    v_exp_f32 v189, v189
    v_smfmac_f32_16x16x64_bf16 v[136:139], v[20:23], v[168:175], v5
    ds_read_b64_tr_b16 a[46:47], v3 offset:40192
    v_exp_f32 v190, v190
    v_exp_f32 v191, v191
    v_mfma_f32_32x32x16_bf16 v[160:175], a[8:11], v[40:43], 4.0
    v_exp_f32 v144, v144
    v_exp_f32 v145, v145
    v_exp_f32 v146, v146
    v_mfma_f32_32x32x16_bf16 v[160:175], a[12:15], v[44:47], v[160:175]
    v_exp_f32 v147, v147
    v_exp_f32 v148, v148
    v_exp_f32 v149, v149
    v_exp_f32 v150, v150
    v_smfmac_f32_32x32x32_bf16 v[112:127], a[32:35], v[176:183], v5
    v_exp_f32 v151, v151
    v_exp_f32 v152, v152
    v_exp_f32 v153, v153
    v_smfmac_f32_16x16x64_bf16 v[140:143], v[20:23], v[176:183], v5
    v_exp_f32 v154, v154
    v_smfmac_f32_32x32x32_bf16 v[112:127], a[36:39], v[184:191], v5
    v_exp_f32 v155, v155
    v_exp_f32 v156, v156
    v_exp_f32 v157, v157
    v_smfmac_f32_16x16x64_bf16 v[140:143], v[20:23], v[184:191], v5
    v_exp_f32 v158, v158
    v_exp_f32 v159, v159
    v_mfma_f32_32x32x16_bf16 v[176:191], a[8:11], v[48:51], 4.0
    v_exp_f32 v160, v160
    v_exp_f32 v161, v161
    v_exp_f32 v162, v162
    v_mfma_f32_32x32x16_bf16 v[176:191], a[12:15], v[52:55], v[176:191]
    s_waitcnt lgkmcnt(0)
    v_exp_f32 v163, v163
    v_exp_f32 v164, v164
    v_exp_f32 v165, v165
    v_exp_f32 v166, v166
    v_smfmac_f32_32x32x32_bf16 v[64:79], a[40:43], v[144:151], v5
    s_barrier
    v_exp_f32 v167, v167
    v_exp_f32 v168, v168
    v_exp_f32 v169, v169
    v_smfmac_f32_16x16x64_bf16 v[128:131], v[20:23], v[144:151], v5
    ds_read_b128 a[0:3], v7 offset:8192
    v_exp_f32 v170, v170
    v_smfmac_f32_32x32x32_bf16 v[64:79], a[44:47], v[152:159], v5
    v_exp_f32 v171, v171
    v_exp_f32 v172, v172
    v_exp_f32 v173, v173
    v_smfmac_f32_16x16x64_bf16 v[128:131], v[20:23], v[152:159], v5
    ds_read_b128 a[4:7], v8 offset:8192
    v_exp_f32 v174, v174
    v_exp_f32 v175, v175
    v_mfma_f32_32x32x16_bf16 v[144:159], a[8:11], v[56:59], 4.0
    v_exp_f32 v176, v176
    v_exp_f32 v177, v177
    v_exp_f32 v178, v178
    v_mfma_f32_32x32x16_bf16 v[144:159], a[12:15], v[60:63], v[144:159]
    v_exp_f32 v179, v179
    v_exp_f32 v180, v180
    v_exp_f32 v181, v181
    v_exp_f32 v182, v182
    v_smfmac_f32_32x32x32_bf16 v[80:95], a[40:43], v[160:167], v5
    v_exp_f32 v183, v183
    v_exp_f32 v184, v184
    v_exp_f32 v185, v185
    v_smfmac_f32_16x16x64_bf16 v[132:135], v[20:23], v[160:167], v5
    ds_read_b64_tr_b16 a[32:33], v3 offset:40960
    v_exp_f32 v186, v186
    v_smfmac_f32_32x32x32_bf16 v[80:95], a[44:47], v[168:175], v5
    s_waitcnt lgkmcnt(1)
    v_exp_f32 v187, v187
    v_exp_f32 v188, v188
    v_exp_f32 v189, v189
    v_smfmac_f32_16x16x64_bf16 v[132:135], v[20:23], v[168:175], v5
    ds_read_b64_tr_b16 a[34:35], v3 offset:41216
    v_exp_f32 v190, v190
    v_exp_f32 v191, v191
    v_mfma_f32_32x32x16_bf16 v[160:175], a[0:3], v[32:35], 4.0
    v_exp_f32 v144, v144
    v_exp_f32 v145, v145
    v_exp_f32 v146, v146
    v_mfma_f32_32x32x16_bf16 v[160:175], a[4:7], v[36:39], v[160:175]
    v_exp_f32 v147, v147
    v_exp_f32 v148, v148
    v_exp_f32 v149, v149
    v_exp_f32 v150, v150
    v_smfmac_f32_32x32x32_bf16 v[96:111], a[40:43], v[176:183], v5
    v_exp_f32 v151, v151
    v_exp_f32 v152, v152
    v_exp_f32 v153, v153
    v_smfmac_f32_16x16x64_bf16 v[136:139], v[20:23], v[176:183], v5
    ds_read_b64_tr_b16 a[36:37], v3 offset:41984
    v_exp_f32 v154, v154
    v_smfmac_f32_32x32x32_bf16 v[96:111], a[44:47], v[184:191], v5
    v_exp_f32 v155, v155
    v_exp_f32 v156, v156
    v_exp_f32 v157, v157
    v_smfmac_f32_16x16x64_bf16 v[136:139], v[20:23], v[184:191], v5
    ds_read_b64_tr_b16 a[38:39], v3 offset:42240
    v_exp_f32 v158, v158
    v_exp_f32 v159, v159
    v_mfma_f32_32x32x16_bf16 v[176:191], a[0:3], v[40:43], 4.0
    v_exp_f32 v160, v160
    v_exp_f32 v161, v161
    v_exp_f32 v162, v162
    v_mfma_f32_32x32x16_bf16 v[176:191], a[4:7], v[44:47], v[176:191]
    v_exp_f32 v163, v163
    v_exp_f32 v164, v164
    v_exp_f32 v165, v165
    v_exp_f32 v166, v166
    v_smfmac_f32_32x32x32_bf16 v[112:127], a[40:43], v[144:151], v5
    v_exp_f32 v167, v167
    v_exp_f32 v168, v168
    v_exp_f32 v169, v169
    v_smfmac_f32_16x16x64_bf16 v[140:143], v[20:23], v[144:151], v5
    v_exp_f32 v170, v170
    v_smfmac_f32_32x32x32_bf16 v[112:127], a[44:47], v[152:159], v5
    v_exp_f32 v171, v171
    v_exp_f32 v172, v172
    v_exp_f32 v173, v173
    v_smfmac_f32_16x16x64_bf16 v[140:143], v[20:23], v[152:159], v5
    v_exp_f32 v174, v174
    v_exp_f32 v175, v175
    v_mfma_f32_32x32x16_bf16 v[144:159], a[0:3], v[48:51], 4.0
    v_exp_f32 v176, v176
    v_exp_f32 v177, v177
    v_exp_f32 v178, v178
    v_mfma_f32_32x32x16_bf16 v[144:159], a[4:7], v[52:55], v[144:159]
    s_waitcnt lgkmcnt(0)
    v_exp_f32 v179, v179
    v_exp_f32 v180, v180
    v_exp_f32 v181, v181
    v_exp_f32 v182, v182
    v_smfmac_f32_32x32x32_bf16 v[64:79], a[32:35], v[160:167], v5
    v_exp_f32 v183, v183
    v_exp_f32 v184, v184
    v_exp_f32 v185, v185
    v_smfmac_f32_16x16x64_bf16 v[128:131], v[20:23], v[160:167], v5
    ds_read_b128 a[8:11], v7 offset:10240
    v_exp_f32 v186, v186
    v_smfmac_f32_32x32x32_bf16 v[64:79], a[36:39], v[168:175], v5
    v_exp_f32 v187, v187
    v_exp_f32 v188, v188
    v_exp_f32 v189, v189
    v_smfmac_f32_16x16x64_bf16 v[128:131], v[20:23], v[168:175], v5
    ds_read_b128 a[12:15], v8 offset:10240
    v_exp_f32 v190, v190
    v_exp_f32 v191, v191
    v_mfma_f32_32x32x16_bf16 v[160:175], a[0:3], v[56:59], 4.0
    v_exp_f32 v144, v144
    v_exp_f32 v145, v145
    v_exp_f32 v146, v146
    v_mfma_f32_32x32x16_bf16 v[160:175], a[4:7], v[60:63], v[160:175]
    v_exp_f32 v147, v147
    v_exp_f32 v148, v148
    v_exp_f32 v149, v149
    v_exp_f32 v150, v150
    v_smfmac_f32_32x32x32_bf16 v[80:95], a[32:35], v[176:183], v5
    v_exp_f32 v151, v151
    v_exp_f32 v152, v152
    v_exp_f32 v153, v153
    v_smfmac_f32_16x16x64_bf16 v[132:135], v[20:23], v[176:183], v5
    ds_read_b64_tr_b16 a[40:41], v3 offset:43008
    v_exp_f32 v154, v154
    v_smfmac_f32_32x32x32_bf16 v[80:95], a[36:39], v[184:191], v5
    s_waitcnt lgkmcnt(1)
    v_exp_f32 v155, v155
    v_exp_f32 v156, v156
    v_exp_f32 v157, v157
    v_smfmac_f32_16x16x64_bf16 v[132:135], v[20:23], v[184:191], v5
    ds_read_b64_tr_b16 a[42:43], v3 offset:43264
    v_exp_f32 v158, v158
    v_exp_f32 v159, v159
    v_mfma_f32_32x32x16_bf16 v[176:191], a[8:11], v[32:35], 4.0
    v_exp_f32 v160, v160
    v_exp_f32 v161, v161
    v_exp_f32 v162, v162
    v_mfma_f32_32x32x16_bf16 v[176:191], a[12:15], v[36:39], v[176:191]
    v_exp_f32 v163, v163
    v_exp_f32 v164, v164
    v_exp_f32 v165, v165
    v_exp_f32 v166, v166
    v_smfmac_f32_32x32x32_bf16 v[96:111], a[32:35], v[144:151], v5
    v_exp_f32 v167, v167
    v_exp_f32 v168, v168
    v_exp_f32 v169, v169
    v_smfmac_f32_16x16x64_bf16 v[136:139], v[20:23], v[144:151], v5
    ds_read_b64_tr_b16 a[44:45], v3 offset:44032
    v_exp_f32 v170, v170
    v_smfmac_f32_32x32x32_bf16 v[96:111], a[36:39], v[152:159], v5
    v_exp_f32 v171, v171
    v_exp_f32 v172, v172
    v_exp_f32 v173, v173
    v_smfmac_f32_16x16x64_bf16 v[136:139], v[20:23], v[152:159], v5
    ds_read_b64_tr_b16 a[46:47], v3 offset:44288
    v_exp_f32 v174, v174
    v_exp_f32 v175, v175
    v_mfma_f32_32x32x16_bf16 v[144:159], a[8:11], v[40:43], 4.0
    v_exp_f32 v176, v176
    v_exp_f32 v177, v177
    v_exp_f32 v178, v178
    v_mfma_f32_32x32x16_bf16 v[144:159], a[12:15], v[44:47], v[144:159]
    v_exp_f32 v179, v179
    v_exp_f32 v180, v180
    v_exp_f32 v181, v181
    v_exp_f32 v182, v182
    v_smfmac_f32_32x32x32_bf16 v[112:127], a[32:35], v[160:167], v5
    v_exp_f32 v183, v183
    v_exp_f32 v184, v184
    v_exp_f32 v185, v185
    v_smfmac_f32_16x16x64_bf16 v[140:143], v[20:23], v[160:167], v5
    v_exp_f32 v186, v186
    v_smfmac_f32_32x32x32_bf16 v[112:127], a[36:39], v[168:175], v5
    v_exp_f32 v187, v187
    v_exp_f32 v188, v188
    v_exp_f32 v189, v189
    v_smfmac_f32_16x16x64_bf16 v[140:143], v[20:23], v[168:175], v5
    v_exp_f32 v190, v190
    v_exp_f32 v191, v191
    v_mfma_f32_32x32x16_bf16 v[160:175], a[8:11], v[48:51], 4.0
    v_exp_f32 v144, v144
    v_exp_f32 v145, v145
    v_exp_f32 v146, v146
    v_mfma_f32_32x32x16_bf16 v[160:175], a[12:15], v[52:55], v[160:175]
    s_waitcnt lgkmcnt(0)
    v_exp_f32 v147, v147
    v_exp_f32 v148, v148
    v_exp_f32 v149, v149
    v_exp_f32 v150, v150
    v_smfmac_f32_32x32x32_bf16 v[64:79], a[40:43], v[176:183], v5
    v_exp_f32 v151, v151
    v_exp_f32 v152, v152
    v_exp_f32 v153, v153
    v_smfmac_f32_16x16x64_bf16 v[128:131], v[20:23], v[176:183], v5
    ds_read_b128 a[0:3], v7 offset:12288
    v_exp_f32 v154, v154
    v_smfmac_f32_32x32x32_bf16 v[64:79], a[44:47], v[184:191], v5
    v_exp_f32 v155, v155
    v_exp_f32 v156, v156
    v_exp_f32 v157, v157
    v_smfmac_f32_16x16x64_bf16 v[128:131], v[20:23], v[184:191], v5
    ds_read_b128 a[4:7], v8 offset:12288
    v_exp_f32 v158, v158
    v_exp_f32 v159, v159
    v_mfma_f32_32x32x16_bf16 v[176:191], a[8:11], v[56:59], 4.0
    v_exp_f32 v160, v160
    v_exp_f32 v161, v161
    v_exp_f32 v162, v162
    v_mfma_f32_32x32x16_bf16 v[176:191], a[12:15], v[60:63], v[176:191]
    v_exp_f32 v163, v163
    v_exp_f32 v164, v164
    v_exp_f32 v165, v165
    v_exp_f32 v166, v166
    v_smfmac_f32_32x32x32_bf16 v[80:95], a[40:43], v[144:151], v5
    v_exp_f32 v167, v167
    v_exp_f32 v168, v168
    v_exp_f32 v169, v169
    v_smfmac_f32_16x16x64_bf16 v[132:135], v[20:23], v[144:151], v5
    ds_read_b64_tr_b16 a[32:33], v3 offset:45056
    v_exp_f32 v170, v170
    v_smfmac_f32_32x32x32_bf16 v[80:95], a[44:47], v[152:159], v5
    s_waitcnt lgkmcnt(1)
    v_exp_f32 v171, v171
    v_exp_f32 v172, v172
    v_exp_f32 v173, v173
    v_smfmac_f32_16x16x64_bf16 v[132:135], v[20:23], v[152:159], v5
    ds_read_b64_tr_b16 a[34:35], v3 offset:45312
    v_exp_f32 v174, v174
    v_exp_f32 v175, v175
    v_mfma_f32_32x32x16_bf16 v[144:159], a[0:3], v[32:35], 4.0
    v_exp_f32 v176, v176
    v_exp_f32 v177, v177
    v_exp_f32 v178, v178
    v_mfma_f32_32x32x16_bf16 v[144:159], a[4:7], v[36:39], v[144:159]
    v_exp_f32 v179, v179
    v_exp_f32 v180, v180
    v_exp_f32 v181, v181
    v_exp_f32 v182, v182
    v_smfmac_f32_32x32x32_bf16 v[96:111], a[40:43], v[160:167], v5
    v_exp_f32 v183, v183
    v_exp_f32 v184, v184
    v_exp_f32 v185, v185
    v_smfmac_f32_16x16x64_bf16 v[136:139], v[20:23], v[160:167], v5
    ds_read_b64_tr_b16 a[36:37], v3 offset:46080
    v_exp_f32 v186, v186
    v_smfmac_f32_32x32x32_bf16 v[96:111], a[44:47], v[168:175], v5
    v_exp_f32 v187, v187
    v_exp_f32 v188, v188
    v_exp_f32 v189, v189
    v_smfmac_f32_16x16x64_bf16 v[136:139], v[20:23], v[168:175], v5
    ds_read_b64_tr_b16 a[38:39], v3 offset:46336
    v_exp_f32 v190, v190
    v_exp_f32 v191, v191
    v_mfma_f32_32x32x16_bf16 v[160:175], a[0:3], v[40:43], 4.0
    v_exp_f32 v144, v144
    v_exp_f32 v145, v145
    v_exp_f32 v146, v146
    v_mfma_f32_32x32x16_bf16 v[160:175], a[4:7], v[44:47], v[160:175]
    v_exp_f32 v147, v147
    v_exp_f32 v148, v148
    v_exp_f32 v149, v149
    v_exp_f32 v150, v150
    v_smfmac_f32_32x32x32_bf16 v[112:127], a[40:43], v[176:183], v5
    v_exp_f32 v151, v151
    v_exp_f32 v152, v152
    v_exp_f32 v153, v153
    v_smfmac_f32_16x16x64_bf16 v[140:143], v[20:23], v[176:183], v5
    v_exp_f32 v154, v154
    v_smfmac_f32_32x32x32_bf16 v[112:127], a[44:47], v[184:191], v5
    v_exp_f32 v155, v155
    v_exp_f32 v156, v156
    v_exp_f32 v157, v157
    v_smfmac_f32_16x16x64_bf16 v[140:143], v[20:23], v[184:191], v5
    v_exp_f32 v158, v158
    v_exp_f32 v159, v159
    v_mfma_f32_32x32x16_bf16 v[176:191], a[0:3], v[48:51], 4.0
    v_exp_f32 v160, v160
    v_exp_f32 v161, v161
    v_exp_f32 v162, v162
    v_mfma_f32_32x32x16_bf16 v[176:191], a[4:7], v[52:55], v[176:191]
    s_waitcnt lgkmcnt(0)
    v_exp_f32 v163, v163
    v_exp_f32 v164, v164
    v_exp_f32 v165, v165
    v_exp_f32 v166, v166
    v_smfmac_f32_32x32x32_bf16 v[64:79], a[32:35], v[144:151], v5
    v_exp_f32 v167, v167
    v_exp_f32 v168, v168
    v_exp_f32 v169, v169
    v_smfmac_f32_16x16x64_bf16 v[128:131], v[20:23], v[144:151], v5
    ds_read_b128 a[8:11], v7 offset:14336
    v_exp_f32 v170, v170
    v_smfmac_f32_32x32x32_bf16 v[64:79], a[36:39], v[152:159], v5
    v_exp_f32 v171, v171
    v_exp_f32 v172, v172
    v_exp_f32 v173, v173
    v_smfmac_f32_16x16x64_bf16 v[128:131], v[20:23], v[152:159], v5
    ds_read_b128 a[12:15], v8 offset:14336
    v_exp_f32 v174, v174
    v_exp_f32 v175, v175
    v_mfma_f32_32x32x16_bf16 v[144:159], a[0:3], v[56:59], 4.0
    v_exp_f32 v176, v176
    v_exp_f32 v177, v177
    v_exp_f32 v178, v178
    v_mfma_f32_32x32x16_bf16 v[144:159], a[4:7], v[60:63], v[144:159]
    v_exp_f32 v179, v179
    v_exp_f32 v180, v180
    v_exp_f32 v181, v181
    v_exp_f32 v182, v182
    v_smfmac_f32_32x32x32_bf16 v[80:95], a[32:35], v[160:167], v5
    v_exp_f32 v183, v183
    v_exp_f32 v184, v184
    v_exp_f32 v185, v185
    v_smfmac_f32_16x16x64_bf16 v[132:135], v[20:23], v[160:167], v5
    ds_read_b64_tr_b16 a[40:41], v3 offset:47104
    v_exp_f32 v186, v186
    v_smfmac_f32_32x32x32_bf16 v[80:95], a[36:39], v[168:175], v5
    s_waitcnt lgkmcnt(1)
    v_exp_f32 v187, v187
    v_exp_f32 v188, v188
    v_exp_f32 v189, v189
    v_smfmac_f32_16x16x64_bf16 v[132:135], v[20:23], v[168:175], v5
    ds_read_b64_tr_b16 a[42:43], v3 offset:47360
    v_exp_f32 v190, v190
    v_exp_f32 v191, v191
    v_mfma_f32_32x32x16_bf16 v[160:175], a[8:11], v[32:35], 4.0
    v_exp_f32 v144, v144
    v_exp_f32 v145, v145
    v_exp_f32 v146, v146
    v_mfma_f32_32x32x16_bf16 v[160:175], a[12:15], v[36:39], v[160:175]
    v_exp_f32 v147, v147
    v_exp_f32 v148, v148
    v_exp_f32 v149, v149
    v_exp_f32 v150, v150
    v_smfmac_f32_32x32x32_bf16 v[96:111], a[32:35], v[176:183], v5
    v_exp_f32 v151, v151
    v_exp_f32 v152, v152
    v_exp_f32 v153, v153
    v_smfmac_f32_16x16x64_bf16 v[136:139], v[20:23], v[176:183], v5
    ds_read_b64_tr_b16 a[44:45], v3 offset:48128
    v_exp_f32 v154, v154
    v_smfmac_f32_32x32x32_bf16 v[96:111], a[36:39], v[184:191], v5
    v_exp_f32 v155, v155
    v_exp_f32 v156, v156
    v_exp_f32 v157, v157
    v_smfmac_f32_16x16x64_bf16 v[136:139], v[20:23], v[184:191], v5
    ds_read_b64_tr_b16 a[46:47], v3 offset:48384
    v_exp_f32 v158, v158
    v_exp_f32 v159, v159
    v_mfma_f32_32x32x16_bf16 v[176:191], a[8:11], v[40:43], 4.0
    v_exp_f32 v160, v160
    v_exp_f32 v161, v161
    v_exp_f32 v162, v162
    v_mfma_f32_32x32x16_bf16 v[176:191], a[12:15], v[44:47], v[176:191]
    v_exp_f32 v163, v163
    v_exp_f32 v164, v164
    v_exp_f32 v165, v165
    v_exp_f32 v166, v166
    v_smfmac_f32_32x32x32_bf16 v[112:127], a[32:35], v[144:151], v5
    v_exp_f32 v167, v167
    v_exp_f32 v168, v168
    v_exp_f32 v169, v169
    v_smfmac_f32_16x16x64_bf16 v[140:143], v[20:23], v[144:151], v5
    v_exp_f32 v170, v170
    v_smfmac_f32_32x32x32_bf16 v[112:127], a[36:39], v[152:159], v5
    v_exp_f32 v171, v171
    v_exp_f32 v172, v172
    v_exp_f32 v173, v173
    v_smfmac_f32_16x16x64_bf16 v[140:143], v[20:23], v[152:159], v5
    v_exp_f32 v174, v174
    v_exp_f32 v175, v175
    v_mfma_f32_32x32x16_bf16 v[144:159], a[8:11], v[48:51], 4.0
    v_exp_f32 v176, v176
    v_exp_f32 v177, v177
    v_exp_f32 v178, v178
    v_mfma_f32_32x32x16_bf16 v[144:159], a[12:15], v[52:55], v[144:159]
    s_waitcnt lgkmcnt(0)
    v_exp_f32 v179, v179
    v_exp_f32 v180, v180
    v_exp_f32 v181, v181
    v_exp_f32 v182, v182
    v_smfmac_f32_32x32x32_bf16 v[64:79], a[40:43], v[160:167], v5
    s_barrier
    v_exp_f32 v183, v183
    v_exp_f32 v184, v184
    v_exp_f32 v185, v185
    v_smfmac_f32_16x16x64_bf16 v[128:131], v[20:23], v[160:167], v5
    ds_read_b128 a[0:3], v7 offset:16384
    v_exp_f32 v186, v186
    v_smfmac_f32_32x32x32_bf16 v[64:79], a[44:47], v[168:175], v5
    v_exp_f32 v187, v187
    v_exp_f32 v188, v188
    v_exp_f32 v189, v189
    v_smfmac_f32_16x16x64_bf16 v[128:131], v[20:23], v[168:175], v5
    ds_read_b128 a[4:7], v8 offset:16384
    v_exp_f32 v190, v190
    v_exp_f32 v191, v191
    v_mfma_f32_32x32x16_bf16 v[160:175], a[8:11], v[56:59], 4.0
    v_exp_f32 v144, v144
    v_exp_f32 v145, v145
    v_exp_f32 v146, v146
    v_mfma_f32_32x32x16_bf16 v[160:175], a[12:15], v[60:63], v[160:175]
    v_exp_f32 v147, v147
    v_exp_f32 v148, v148
    v_exp_f32 v149, v149
    v_exp_f32 v150, v150
    v_smfmac_f32_32x32x32_bf16 v[80:95], a[40:43], v[176:183], v5
    v_exp_f32 v151, v151
    v_exp_f32 v152, v152
    v_exp_f32 v153, v153
    v_smfmac_f32_16x16x64_bf16 v[132:135], v[20:23], v[176:183], v5
    ds_read_b64_tr_b16 a[32:33], v3 offset:49152
    v_exp_f32 v154, v154
    v_smfmac_f32_32x32x32_bf16 v[80:95], a[44:47], v[184:191], v5
    s_waitcnt lgkmcnt(1)
    v_exp_f32 v155, v155
    v_exp_f32 v156, v156
    v_exp_f32 v157, v157
    v_smfmac_f32_16x16x64_bf16 v[132:135], v[20:23], v[184:191], v5
    ds_read_b64_tr_b16 a[34:35], v3 offset:49408
    v_exp_f32 v158, v158
    v_exp_f32 v159, v159
    v_mfma_f32_32x32x16_bf16 v[176:191], a[0:3], v[32:35], 4.0
    v_exp_f32 v160, v160
    v_exp_f32 v161, v161
    v_exp_f32 v162, v162
    v_mfma_f32_32x32x16_bf16 v[176:191], a[4:7], v[36:39], v[176:191]
    v_exp_f32 v163, v163
    v_exp_f32 v164, v164
    v_exp_f32 v165, v165
    v_exp_f32 v166, v166
    v_smfmac_f32_32x32x32_bf16 v[96:111], a[40:43], v[144:151], v5
    v_exp_f32 v167, v167
    v_exp_f32 v168, v168
    v_exp_f32 v169, v169
    v_smfmac_f32_16x16x64_bf16 v[136:139], v[20:23], v[144:151], v5
    ds_read_b64_tr_b16 a[36:37], v3 offset:50176
    v_exp_f32 v170, v170
    v_smfmac_f32_32x32x32_bf16 v[96:111], a[44:47], v[152:159], v5
    v_exp_f32 v171, v171
    v_exp_f32 v172, v172
    v_exp_f32 v173, v173
    v_smfmac_f32_16x16x64_bf16 v[136:139], v[20:23], v[152:159], v5
    ds_read_b64_tr_b16 a[38:39], v3 offset:50432
    v_exp_f32 v174, v174
    v_exp_f32 v175, v175
    v_mfma_f32_32x32x16_bf16 v[144:159], a[0:3], v[40:43], 4.0
    v_exp_f32 v176, v176
    v_exp_f32 v177, v177
    v_exp_f32 v178, v178
    v_mfma_f32_32x32x16_bf16 v[144:159], a[4:7], v[44:47], v[144:159]
    v_exp_f32 v179, v179
    v_exp_f32 v180, v180
    v_exp_f32 v181, v181
    v_exp_f32 v182, v182
    v_smfmac_f32_32x32x32_bf16 v[112:127], a[40:43], v[160:167], v5
    v_exp_f32 v183, v183
    v_exp_f32 v184, v184
    v_exp_f32 v185, v185
    v_smfmac_f32_16x16x64_bf16 v[140:143], v[20:23], v[160:167], v5
    v_exp_f32 v186, v186
    v_smfmac_f32_32x32x32_bf16 v[112:127], a[44:47], v[168:175], v5
    v_exp_f32 v187, v187
    v_exp_f32 v188, v188
    v_exp_f32 v189, v189
    v_smfmac_f32_16x16x64_bf16 v[140:143], v[20:23], v[168:175], v5
    v_exp_f32 v190, v190
    v_exp_f32 v191, v191
    v_mfma_f32_32x32x16_bf16 v[160:175], a[0:3], v[48:51], 4.0
    v_exp_f32 v144, v144
    v_exp_f32 v145, v145
    v_exp_f32 v146, v146
    v_mfma_f32_32x32x16_bf16 v[160:175], a[4:7], v[52:55], v[160:175]
    s_waitcnt lgkmcnt(0)
    v_exp_f32 v147, v147
    v_exp_f32 v148, v148
    v_exp_f32 v149, v149
    v_exp_f32 v150, v150
    v_smfmac_f32_32x32x32_bf16 v[64:79], a[32:35], v[176:183], v5
    v_exp_f32 v151, v151
    v_exp_f32 v152, v152
    v_exp_f32 v153, v153
    v_smfmac_f32_16x16x64_bf16 v[128:131], v[20:23], v[176:183], v5
    ds_read_b128 a[8:11], v7 offset:18432
    v_exp_f32 v154, v154
    v_smfmac_f32_32x32x32_bf16 v[64:79], a[36:39], v[184:191], v5
    v_exp_f32 v155, v155
    v_exp_f32 v156, v156
    v_exp_f32 v157, v157
    v_smfmac_f32_16x16x64_bf16 v[128:131], v[20:23], v[184:191], v5
    ds_read_b128 a[12:15], v8 offset:18432
    v_exp_f32 v158, v158
    v_exp_f32 v159, v159
    v_mfma_f32_32x32x16_bf16 v[176:191], a[0:3], v[56:59], 4.0
    v_exp_f32 v160, v160
    v_exp_f32 v161, v161
    v_exp_f32 v162, v162
    v_mfma_f32_32x32x16_bf16 v[176:191], a[4:7], v[60:63], v[176:191]
    v_exp_f32 v163, v163
    v_exp_f32 v164, v164
    v_exp_f32 v165, v165
    v_exp_f32 v166, v166
    v_smfmac_f32_32x32x32_bf16 v[80:95], a[32:35], v[144:151], v5
    v_exp_f32 v167, v167
    v_exp_f32 v168, v168
    v_exp_f32 v169, v169
    v_smfmac_f32_16x16x64_bf16 v[132:135], v[20:23], v[144:151], v5
    ds_read_b64_tr_b16 a[40:41], v3 offset:51200
    v_exp_f32 v170, v170
    v_smfmac_f32_32x32x32_bf16 v[80:95], a[36:39], v[152:159], v5
    s_waitcnt lgkmcnt(1)
    v_exp_f32 v171, v171
    v_exp_f32 v172, v172
    v_exp_f32 v173, v173
    v_smfmac_f32_16x16x64_bf16 v[132:135], v[20:23], v[152:159], v5
    ds_read_b64_tr_b16 a[42:43], v3 offset:51456
    v_exp_f32 v174, v174
    v_exp_f32 v175, v175
    v_mfma_f32_32x32x16_bf16 v[144:159], a[8:11], v[32:35], 4.0
    v_exp_f32 v176, v176
    v_exp_f32 v177, v177
    v_exp_f32 v178, v178
    v_mfma_f32_32x32x16_bf16 v[144:159], a[12:15], v[36:39], v[144:159]
    v_exp_f32 v179, v179
    v_exp_f32 v180, v180
    v_exp_f32 v181, v181
    v_exp_f32 v182, v182
    v_smfmac_f32_32x32x32_bf16 v[96:111], a[32:35], v[160:167], v5
    s_barrier
    v_exp_f32 v183, v183
    v_exp_f32 v184, v184
    v_exp_f32 v185, v185
    v_smfmac_f32_16x16x64_bf16 v[136:139], v[20:23], v[160:167], v5
    ds_read_b64_tr_b16 a[44:45], v3 offset:52224
    v_exp_f32 v186, v186
    v_smfmac_f32_32x32x32_bf16 v[96:111], a[36:39], v[168:175], v5
    v_exp_f32 v187, v187
    v_exp_f32 v188, v188
    v_exp_f32 v189, v189
    v_smfmac_f32_16x16x64_bf16 v[136:139], v[20:23], v[168:175], v5
    ds_read_b64_tr_b16 a[46:47], v3 offset:52480
    v_exp_f32 v190, v190
    v_exp_f32 v191, v191
    v_mfma_f32_32x32x16_bf16 v[160:175], a[8:11], v[40:43], 4.0
    v_exp_f32 v144, v144
    v_exp_f32 v145, v145
    v_exp_f32 v146, v146
    v_mfma_f32_32x32x16_bf16 v[160:175], a[12:15], v[44:47], v[160:175]
    v_exp_f32 v147, v147
    v_exp_f32 v148, v148
    v_exp_f32 v149, v149
    v_exp_f32 v150, v150
    v_smfmac_f32_32x32x32_bf16 v[112:127], a[32:35], v[176:183], v5
    v_exp_f32 v151, v151
    v_exp_f32 v152, v152
    v_exp_f32 v153, v153
    v_smfmac_f32_16x16x64_bf16 v[140:143], v[20:23], v[176:183], v5
    ds_read_b128 a[16:19], v7 offset:26624
    v_exp_f32 v154, v154
    v_smfmac_f32_32x32x32_bf16 v[112:127], a[36:39], v[184:191], v5
    v_exp_f32 v155, v155
    v_exp_f32 v156, v156
    v_exp_f32 v157, v157
    v_smfmac_f32_16x16x64_bf16 v[140:143], v[20:23], v[184:191], v5
    ds_read_b128 a[20:23], v8 offset:26624
    v_exp_f32 v158, v158
    v_exp_f32 v159, v159
    v_mfma_f32_32x32x16_bf16 v[176:191], a[8:11], v[48:51], 4.0
    v_exp_f32 v160, v160
    v_exp_f32 v161, v161
    v_exp_f32 v162, v162
    v_mfma_f32_32x32x16_bf16 v[176:191], a[12:15], v[52:55], v[176:191]
    s_waitcnt lgkmcnt(2)
    v_exp_f32 v163, v163
    v_exp_f32 v164, v164
    v_exp_f32 v165, v165
    v_exp_f32 v166, v166
    v_smfmac_f32_32x32x32_bf16 v[64:79], a[40:43], v[144:151], v5
    v_exp_f32 v167, v167
    v_exp_f32 v168, v168
    v_exp_f32 v169, v169
    v_smfmac_f32_16x16x64_bf16 v[128:131], v[20:23], v[144:151], v5
    ds_read_b128 a[0:3], v7 offset:20480
    v_exp_f32 v170, v170
    v_smfmac_f32_32x32x32_bf16 v[64:79], a[44:47], v[152:159], v5
    v_exp_f32 v171, v171
    v_exp_f32 v172, v172
    v_exp_f32 v173, v173
    v_smfmac_f32_16x16x64_bf16 v[128:131], v[20:23], v[152:159], v5
    ds_read_b128 a[4:7], v8 offset:20480
    v_exp_f32 v174, v174
    v_exp_f32 v175, v175
    v_mfma_f32_32x32x16_bf16 v[144:159], a[8:11], v[56:59], 4.0
L_pad8:
    s_cbranch_vccnz L_hopx
    v_exp_f32 v176, v176
    v_exp_f32 v177, v177
    v_exp_f32 v178, v178
    v_mfma_f32_32x32x16_bf16 v[144:159], a[12:15], v[60:63], v[144:159]
    v_exp_f32 v179, v179
    v_exp_f32 v180, v180
    v_exp_f32 v181, v181
    v_exp_f32 v182, v182
    v_smfmac_f32_32x32x32_bf16 v[80:95], a[40:43], v[160:167], v5
    v_exp_f32 v183, v183
    v_exp_f32 v184, v184
    v_exp_f32 v185, v185
    v_smfmac_f32_16x16x64_bf16 v[132:135], v[20:23], v[160:167], v5
    ds_read_b64_tr_b16 a[32:33], v3 offset:53248
    v_exp_f32 v186, v186
    v_smfmac_f32_32x32x32_bf16 v[80:95], a[44:47], v[168:175], v5
    s_waitcnt lgkmcnt(1)
    v_exp_f32 v187, v187
    v_exp_f32 v188, v188
    v_exp_f32 v189, v189
    v_smfmac_f32_16x16x64_bf16 v[132:135], v[20:23], v[168:175], v5
    ds_read_b64_tr_b16 a[34:35], v3 offset:53504
    v_exp_f32 v190, v190
    v_exp_f32 v191, v191
    v_mfma_f32_32x32x16_bf16 v[160:175], a[0:3], v[32:35], 4.0
    v_exp_f32 v144, v144
    v_exp_f32 v145, v145
    v_exp_f32 v146, v146
    v_mfma_f32_32x32x16_bf16 v[160:175], a[4:7], v[36:39], v[160:175]
    v_exp_f32 v147, v147
    v_exp_f32 v148, v148
    v_exp_f32 v149, v149
    v_exp_f32 v150, v150
    v_smfmac_f32_32x32x32_bf16 v[96:111], a[40:43], v[176:183], v5
    v_exp_f32 v151, v151
    v_exp_f32 v152, v152
    v_exp_f32 v153, v153
    v_smfmac_f32_16x16x64_bf16 v[136:139], v[20:23], v[176:183], v5
    ds_read_b64_tr_b16 a[36:37], v3 offset:54272
    v_exp_f32 v154, v154
    v_smfmac_f32_32x32x32_bf16 v[96:111], a[44:47], v[184:191], v5
    v_exp_f32 v155, v155
    v_exp_f32 v156, v156
    v_exp_f32 v157, v157
    v_smfmac_f32_16x16x64_bf16 v[136:139], v[20:23], v[184:191], v5
    ds_read_b64_tr_b16 a[38:39], v3 offset:54528
    v_exp_f32 v158, v158
    v_exp_f32 v159, v159
    v_mfma_f32_32x32x16_bf16 v[176:191], a[0:3], v[40:43], 4.0
    v_exp_f32 v160, v160
    v_exp_f32 v161, v161
    v_exp_f32 v162, v162
    v_mfma_f32_32x32x16_bf16 v[176:191], a[4:7], v[44:47], v[176:191]
    v_exp_f32 v163, v163
    v_exp_f32 v164, v164
    v_exp_f32 v165, v165
    v_exp_f32 v166, v166
    v_smfmac_f32_32x32x32_bf16 v[112:127], a[40:43], v[144:151], v5
    v_exp_f32 v167, v167
    v_exp_f32 v168, v168
    v_exp_f32 v169, v169
    v_smfmac_f32_16x16x64_bf16 v[140:143], v[20:23], v[144:151], v5
    ds_read_b128 a[24:27], v7 offset:28672
    v_exp_f32 v170, v170
    v_smfmac_f32_32x32x32_bf16 v[112:127], a[44:47], v[152:159], v5
    v_exp_f32 v171, v171
    v_exp_f32 v172, v172
    v_exp_f32 v173, v173
    v_smfmac_f32_16x16x64_bf16 v[140:143], v[20:23], v[152:159], v5
    ds_read_b128 a[28:31], v8 offset:28672
    v_exp_f32 v174, v174
    v_exp_f32 v175, v175
    v_mfma_f32_32x32x16_bf16 v[144:159], a[0:3], v[48:51], 4.0
    v_exp_f32 v176, v176
    v_exp_f32 v177, v177
    v_exp_f32 v178, v178
    v_mfma_f32_32x32x16_bf16 v[144:159], a[4:7], v[52:55], v[144:159]
    s_waitcnt lgkmcnt(2)
    v_exp_f32 v179, v179
    v_exp_f32 v180, v180
    v_exp_f32 v181, v181
    v_exp_f32 v182, v182
    v_smfmac_f32_32x32x32_bf16 v[64:79], a[32:35], v[160:167], v5
    v_exp_f32 v183, v183
    v_exp_f32 v184, v184
    v_exp_f32 v185, v185
    v_smfmac_f32_16x16x64_bf16 v[128:131], v[20:23], v[160:167], v5
    ds_read_b128 a[8:11], v7 offset:22528
    v_exp_f32 v186, v186
    v_smfmac_f32_32x32x32_bf16 v[64:79], a[36:39], v[168:175], v5
    v_exp_f32 v187, v187
    v_exp_f32 v188, v188
    v_exp_f32 v189, v189
    v_smfmac_f32_16x16x64_bf16 v[128:131], v[20:23], v[168:175], v5
    ds_read_b128 a[12:15], v8 offset:22528
    v_exp_f32 v190, v190
    v_exp_f32 v191, v191
    v_mfma_f32_32x32x16_bf16 v[160:175], a[0:3], v[56:59], 4.0
    v_exp_f32 v144, v144
    v_exp_f32 v145, v145
    v_exp_f32 v146, v146
    v_mfma_f32_32x32x16_bf16 v[160:175], a[4:7], v[60:63], v[160:175]
    v_exp_f32 v147, v147
    v_exp_f32 v148, v148
    v_exp_f32 v149, v149
    v_exp_f32 v150, v150
    v_smfmac_f32_32x32x32_bf16 v[80:95], a[32:35], v[176:183], v5
    v_exp_f32 v151, v151
    v_exp_f32 v152, v152
    v_exp_f32 v153, v153
    v_smfmac_f32_16x16x64_bf16 v[132:135], v[20:23], v[176:183], v5
    ds_read_b64_tr_b16 a[40:41], v3 offset:55296
    v_exp_f32 v154, v154
    v_smfmac_f32_32x32x32_bf16 v[80:95], a[36:39], v[184:191], v5
    s_waitcnt lgkmcnt(1)
    v_exp_f32 v155, v155
    v_exp_f32 v156, v156
    v_exp_f32 v157, v157
    v_smfmac_f32_16x16x64_bf16 v[132:135], v[20:23], v[184:191], v5
    ds_read_b64_tr_b16 a[42:43], v3 offset:55552
    v_exp_f32 v158, v158
    v_exp_f32 v159, v159
    v_mfma_f32_32x32x16_bf16 v[176:191], a[8:11], v[32:35], 4.0
    v_exp_f32 v160, v160
    v_exp_f32 v161, v161
    v_exp_f32 v162, v162
    v_mfma_f32_32x32x16_bf16 v[176:191], a[12:15], v[36:39], v[176:191]
    v_exp_f32 v163, v163
    v_exp_f32 v164, v164
    v_exp_f32 v165, v165
    v_exp_f32 v166, v166
    v_smfmac_f32_32x32x32_bf16 v[96:111], a[32:35], v[144:151], v5
    v_exp_f32 v167, v167
    v_exp_f32 v168, v168
    v_exp_f32 v169, v169
    v_smfmac_f32_16x16x64_bf16 v[136:139], v[20:23], v[144:151], v5
    ds_read_b64_tr_b16 a[44:45], v3 offset:56320
    v_exp_f32 v170, v170
    v_smfmac_f32_32x32x32_bf16 v[96:111], a[36:39], v[152:159], v5
    v_exp_f32 v171, v171
    v_exp_f32 v172, v172
    v_exp_f32 v173, v173
    v_smfmac_f32_16x16x64_bf16 v[136:139], v[20:23], v[152:159], v5
    ds_read_b64_tr_b16 a[46:47], v3 offset:56576
    v_exp_f32 v174, v174
    v_exp_f32 v175, v175
    v_mfma_f32_32x32x16_bf16 v[144:159], a[8:11], v[40:43], 4.0
    v_exp_f32 v176, v176
    v_exp_f32 v177, v177
    v_exp_f32 v178, v178
    v_mfma_f32_32x32x16_bf16 v[144:159], a[12:15], v[44:47], v[144:159]
    v_exp_f32 v179, v179
    v_exp_f32 v180, v180
    v_exp_f32 v181, v181
    v_exp_f32 v182, v182
    v_smfmac_f32_32x32x32_bf16 v[112:127], a[32:35], v[160:167], v5
    v_exp_f32 v183, v183
    v_exp_f32 v184, v184
    v_exp_f32 v185, v185
    v_smfmac_f32_16x16x64_bf16 v[140:143], v[20:23], v[160:167], v5
    ds_read_b64_tr_b16 a[48:49], v3 offset:59392
    v_exp_f32 v186, v186
    v_smfmac_f32_32x32x32_bf16 v[112:127], a[36:39], v[168:175], v5
    v_exp_f32 v187, v187
    v_exp_f32 v188, v188
    v_exp_f32 v189, v189
    v_smfmac_f32_16x16x64_bf16 v[140:143], v[20:23], v[168:175], v5
    ds_read_b64_tr_b16 a[50:51], v3 offset:59648
    v_exp_f32 v190, v190
    v_exp_f32 v191, v191
    v_mfma_f32_32x32x16_bf16 v[160:175], a[8:11], v[48:51], 4.0
    v_exp_f32 v144, v144
    v_exp_f32 v145, v145
    v_exp_f32 v146, v146
    v_mfma_f32_32x32x16_bf16 v[160:175], a[12:15], v[52:55], v[160:175]
    s_waitcnt lgkmcnt(2)
    v_exp_f32 v147, v147
    v_exp_f32 v148, v148
    v_exp_f32 v149, v149
    v_exp_f32 v150, v150
    v_smfmac_f32_32x32x32_bf16 v[64:79], a[40:43], v[176:183], v5
    v_exp_f32 v151, v151
    v_exp_f32 v152, v152
    v_exp_f32 v153, v153
    v_smfmac_f32_16x16x64_bf16 v[128:131], v[20:23], v[176:183], v5
    ds_read_b128 a[0:3], v7 offset:24576
    v_exp_f32 v154, v154
    v_smfmac_f32_32x32x32_bf16 v[64:79], a[44:47], v[184:191], v5
    v_exp_f32 v155, v155
    v_exp_f32 v156, v156
    v_exp_f32 v157, v157
    v_smfmac_f32_16x16x64_bf16 v[128:131], v[20:23], v[184:191], v5
    ds_read_b128 a[4:7], v8 offset:24576
    v_exp_f32 v158, v158
    v_exp_f32 v159, v159
    v_mfma_f32_32x32x16_bf16 v[176:191], a[8:11], v[56:59], 4.0
    v_exp_f32 v160, v160
    v_exp_f32 v161, v161
    v_exp_f32 v162, v162
    v_mfma_f32_32x32x16_bf16 v[176:191], a[12:15], v[60:63], v[176:191]
    v_exp_f32 v163, v163
    v_exp_f32 v164, v164
    v_exp_f32 v165, v165
    v_exp_f32 v166, v166
    v_smfmac_f32_32x32x32_bf16 v[80:95], a[40:43], v[144:151], v5
    v_exp_f32 v167, v167
    v_exp_f32 v168, v168
    v_exp_f32 v169, v169
    v_smfmac_f32_16x16x64_bf16 v[132:135], v[20:23], v[144:151], v5
    ds_read_b64_tr_b16 a[32:33], v3 offset:57344
    v_exp_f32 v170, v170
    v_smfmac_f32_32x32x32_bf16 v[80:95], a[44:47], v[152:159], v5
    s_waitcnt lgkmcnt(1)
    v_exp_f32 v171, v171
    v_exp_f32 v172, v172
    v_exp_f32 v173, v173
    v_smfmac_f32_16x16x64_bf16 v[132:135], v[20:23], v[152:159], v5
    ds_read_b64_tr_b16 a[34:35], v3 offset:57600
    v_exp_f32 v174, v174
    v_exp_f32 v175, v175
    v_mfma_f32_32x32x16_bf16 v[144:159], a[0:3], v[32:35], 4.0
    v_exp_f32 v176, v176
    v_exp_f32 v177, v177
    v_exp_f32 v178, v178
    v_mfma_f32_32x32x16_bf16 v[144:159], a[4:7], v[36:39], v[144:159]
    v_exp_f32 v179, v179
    v_exp_f32 v180, v180
    v_exp_f32 v181, v181
    v_exp_f32 v182, v182
    v_smfmac_f32_32x32x32_bf16 v[96:111], a[40:43], v[160:167], v5
    v_exp_f32 v183, v183
    v_exp_f32 v184, v184
    v_exp_f32 v185, v185
    v_smfmac_f32_16x16x64_bf16 v[136:139], v[20:23], v[160:167], v5
    ds_read_b64_tr_b16 a[36:37], v3 offset:58368
    v_exp_f32 v186, v186
    v_smfmac_f32_32x32x32_bf16 v[96:111], a[44:47], v[168:175], v5
    v_exp_f32 v187, v187
    v_exp_f32 v188, v188
    v_exp_f32 v189, v189
    v_smfmac_f32_16x16x64_bf16 v[136:139], v[20:23], v[168:175], v5
    ds_read_b64_tr_b16 a[38:39], v3 offset:58624
    v_exp_f32 v190, v190
    v_exp_f32 v191, v191
    v_mfma_f32_32x32x16_bf16 v[160:175], a[16:19], v[32:35], 4.0
    v_exp_f32 v144, v144
    v_exp_f32 v145, v145
    v_exp_f32 v146, v146
    v_mfma_f32_32x32x16_bf16 v[160:175], a[20:23], v[36:39], v[160:175]
    v_exp_f32 v147, v147
    v_exp_f32 v148, v148
    v_exp_f32 v149, v149
    v_exp_f32 v150, v150
    v_smfmac_f32_32x32x32_bf16 v[112:127], a[40:43], v[176:183], v5
    ds_read_b64_tr_b16 a[52:53], v3 offset:60416
    v_exp_f32 v151, v151
    v_exp_f32 v152, v152
    v_exp_f32 v153, v153
    v_smfmac_f32_16x16x64_bf16 v[140:143], v[20:23], v[176:183], v5
    ds_read_b128 a[8:11], v7 offset:30720
    v_exp_f32 v154, v154
    v_smfmac_f32_32x32x32_bf16 v[112:127], a[44:47], v[184:191], v5
    ds_read_b64_tr_b16 a[54:55], v3 offset:60672
    v_exp_f32 v155, v155
    v_exp_f32 v156, v156
    v_exp_f32 v157, v157
    v_smfmac_f32_16x16x64_bf16 v[140:143], v[20:23], v[184:191], v5
    ds_read_b128 a[12:15], v8 offset:30720
    v_exp_f32 v158, v158
    v_exp_f32 v159, v159
    v_mfma_f32_32x32x16_bf16 v[176:191], a[24:27], v[32:35], 4.0
    v_exp_f32 v160, v160
    v_exp_f32 v161, v161
    v_exp_f32 v162, v162
    v_mfma_f32_32x32x16_bf16 v[176:191], a[28:31], v[36:39], v[176:191]
    s_waitcnt lgkmcnt(4)
    v_exp_f32 v163, v163
    v_exp_f32 v164, v164
    v_exp_f32 v165, v165
    v_exp_f32 v166, v166
    v_smfmac_f32_32x32x32_bf16 v[64:79], a[32:35], v[144:151], v5
    s_waitcnt lgkmcnt(0)
    v_exp_f32 v167, v167
    v_exp_f32 v168, v168
    v_exp_f32 v169, v169
    v_smfmac_f32_16x16x64_bf16 v[128:131], v[20:23], v[144:151], v5
    ds_read_b64_tr_b16 a[56:57], v3 offset:61440
    v_exp_f32 v170, v170
    v_smfmac_f32_32x32x32_bf16 v[64:79], a[36:39], v[152:159], v5
    ds_read_b64_tr_b16 a[40:41], v3 offset:63488
    v_exp_f32 v171, v171
    v_exp_f32 v172, v172
    v_exp_f32 v173, v173
    v_smfmac_f32_16x16x64_bf16 v[128:131], v[20:23], v[152:159], v5
    ds_read_b64_tr_b16 a[58:59], v3 offset:61696
    v_exp_f32 v174, v174
    v_exp_f32 v175, v175
    v_mfma_f32_32x32x16_bf16 v[144:159], a[8:11], v[32:35], 4.0
    v_exp_f32 v176, v176
    v_exp_f32 v177, v177
    v_exp_f32 v178, v178
    v_mfma_f32_32x32x16_bf16 v[144:159], a[12:15], v[36:39], v[144:159]
    v_exp_f32 v179, v179
    v_exp_f32 v180, v180
    v_exp_f32 v181, v181
    v_exp_f32 v182, v182
    v_smfmac_f32_32x32x32_bf16 v[64:79], a[48:51], v[160:167], v5
    ds_read_b64_tr_b16 a[42:43], v3 offset:63744
    v_exp_f32 v183, v183
    v_exp_f32 v184, v184
    v_exp_f32 v185, v185
    v_smfmac_f32_16x16x64_bf16 v[128:131], v[20:23], v[160:167], v5
    ds_read_b64_tr_b16 a[60:61], v3 offset:62464
    v_exp_f32 v186, v186
    v_smfmac_f32_32x32x32_bf16 v[64:79], a[52:55], v[168:175], v5
    v_exp_f32 v187, v187
    v_exp_f32 v188, v188
    v_exp_f32 v189, v189
    v_smfmac_f32_16x16x64_bf16 v[128:131], v[20:23], v[168:175], v5
    ds_read_b64_tr_b16 a[62:63], v3 offset:62720
    v_exp_f32 v190, v190
    v_exp_f32 v191, v191
    v_mfma_f32_32x32x16_bf16 v[160:175], a[0:3], v[40:43], 4.0
    v_exp_f32 v144, v144
    v_exp_f32 v145, v145
    v_exp_f32 v146, v146
    v_mfma_f32_32x32x16_bf16 v[160:175], a[4:7], v[44:47], v[160:175]
    s_waitcnt lgkmcnt(3)
    v_exp_f32 v147, v147
    v_exp_f32 v148, v148
    v_exp_f32 v149, v149
    v_exp_f32 v150, v150
    v_smfmac_f32_32x32x32_bf16 v[64:79], a[56:59], v[176:183], v5
    s_waitcnt lgkmcnt(0)
    v_exp_f32 v151, v151
    v_exp_f32 v152, v152
    v_exp_f32 v153, v153
    v_smfmac_f32_16x16x64_bf16 v[128:131], v[20:23], v[176:183], v5
    ds_read_b64_tr_b16 a[44:45], v3 offset:64512
    v_exp_f32 v154, v154
    v_smfmac_f32_32x32x32_bf16 v[64:79], a[60:63], v[184:191], v5
    v_exp_f32 v155, v155
    v_exp_f32 v156, v156
    v_exp_f32 v157, v157
    v_smfmac_f32_16x16x64_bf16 v[128:131], v[20:23], v[184:191], v5
    ds_read_b64_tr_b16 a[46:47], v3 offset:64768
    v_exp_f32 v158, v158
    v_exp_f32 v159, v159
    v_mfma_f32_32x32x16_bf16 v[176:191], a[16:19], v[40:43], 4.0
    v_exp_f32 v160, v160
    v_exp_f32 v161, v161
    v_exp_f32 v162, v162
    v_mfma_f32_32x32x16_bf16 v[176:191], a[20:23], v[44:47], v[176:191]
    v_exp_f32 v163, v163
    v_exp_f32 v164, v164
    v_exp_f32 v165, v165
    v_exp_f32 v166, v166
    v_smfmac_f32_32x32x32_bf16 v[64:79], a[40:43], v[144:151], v5
    s_waitcnt lgkmcnt(0)
    v_exp_f32 v167, v167
    v_exp_f32 v168, v168
    v_exp_f32 v169, v169
    v_smfmac_f32_16x16x64_bf16 v[128:131], v[20:23], v[144:151], v5
    v_exp_f32 v170, v170
    v_smfmac_f32_32x32x32_bf16 v[64:79], a[44:47], v[152:159], v5
    v_exp_f32 v171, v171
    v_exp_f32 v172, v172
    v_exp_f32 v173, v173
    v_smfmac_f32_16x16x64_bf16 v[128:131], v[20:23], v[152:159], v5
    v_exp_f32 v174, v174
    v_exp_f32 v175, v175
    v_mfma_f32_32x32x16_bf16 v[144:159], a[24:27], v[40:43], 4.0
    v_exp_f32 v176, v176
    v_exp_f32 v177, v177
    v_exp_f32 v178, v178
    v_mfma_f32_32x32x16_bf16 v[144:159], a[28:31], v[44:47], v[144:159]
    v_exp_f32 v179, v179
    v_exp_f32 v180, v180
    v_exp_f32 v181, v181
    v_rcp_f32 v12, v128
    v_exp_f32 v182, v182
    v_pk_mul_f32 v[64:65], v[64:65], v[12:13] op_sel_hi:[1,0]
    v_pk_mul_f32 v[66:67], v[66:67], v[12:13] op_sel_hi:[1,0]
    v_pk_mul_f32 v[68:69], v[68:69], v[12:13] op_sel_hi:[1,0]
    v_pk_mul_f32 v[70:71], v[70:71], v[12:13] op_sel_hi:[1,0]
    v_pk_mul_f32 v[72:73], v[72:73], v[12:13] op_sel_hi:[1,0]
    v_pk_mul_f32 v[74:75], v[74:75], v[12:13] op_sel_hi:[1,0]
    v_pk_mul_f32 v[76:77], v[76:77], v[12:13] op_sel_hi:[1,0]
    v_pk_mul_f32 v[78:79], v[78:79], v[12:13] op_sel_hi:[1,0]
    v_cvt_pk_bf16_f32 v64, v64, v65
    v_cvt_pk_bf16_f32 v65, v66, v67
    v_cvt_pk_bf16_f32 v66, v68, v69
    v_cvt_pk_bf16_f32 v67, v70, v71
    v_cvt_pk_bf16_f32 v68, v72, v73
    v_cvt_pk_bf16_f32 v69, v74, v75
    v_cvt_pk_bf16_f32 v70, v76, v77
    v_cvt_pk_bf16_f32 v71, v78, v79
    v_permlane16_swap_b32 v64, v68
    v_permlane16_swap_b32 v65, v69
    v_permlane16_swap_b32 v66, v70
    v_permlane16_swap_b32 v67, v71
    v_smfmac_f32_32x32x32_bf16 v[80:95], a[32:35], v[160:167], v5
    v_exp_f32 v183, v183
    v_exp_f32 v184, v184
    v_exp_f32 v185, v185
    v_smfmac_f32_16x16x64_bf16 v[132:135], v[20:23], v[160:167], v5
    buffer_store_dwordx4 v[64:67], v9, s[16:19], s33 offen sc1 nt
    v_exp_f32 v186, v186
    v_smfmac_f32_32x32x32_bf16 v[80:95], a[36:39], v[168:175], v5
    v_exp_f32 v187, v187
    v_exp_f32 v188, v188
    v_exp_f32 v189, v189
    v_smfmac_f32_16x16x64_bf16 v[132:135], v[20:23], v[168:175], v5
    buffer_store_dwordx4 v[68:71], v9, s[16:19], s33 offen offset:1024 sc1 nt
    v_exp_f32 v190, v190
    v_exp_f32 v191, v191
    v_mfma_f32_32x32x16_bf16 v[160:175], a[8:11], v[40:43], 4.0
    v_exp_f32 v144, v144
    v_exp_f32 v145, v145
    v_exp_f32 v146, v146
    v_mfma_f32_32x32x16_bf16 v[160:175], a[12:15], v[44:47], v[160:175]
    v_exp_f32 v147, v147
    v_exp_f32 v148, v148
    v_exp_f32 v149, v149
    v_exp_f32 v150, v150
    v_smfmac_f32_32x32x32_bf16 v[80:95], a[48:51], v[176:183], v5
    v_exp_f32 v151, v151
    v_exp_f32 v152, v152
    v_exp_f32 v153, v153
    v_smfmac_f32_16x16x64_bf16 v[132:135], v[20:23], v[176:183], v5
    v_exp_f32 v154, v154
    v_smfmac_f32_32x32x32_bf16 v[80:95], a[52:55], v[184:191], v5
    v_exp_f32 v155, v155
    v_exp_f32 v156, v156
    v_exp_f32 v157, v157
    v_smfmac_f32_16x16x64_bf16 v[132:135], v[20:23], v[184:191], v5
    v_exp_f32 v158, v158
    v_exp_f32 v159, v159
    v_mfma_f32_32x32x16_bf16 v[176:191], a[0:3], v[48:51], 4.0
    v_exp_f32 v160, v160
    v_exp_f32 v161, v161
    v_exp_f32 v162, v162
    v_mfma_f32_32x32x16_bf16 v[176:191], a[4:7], v[52:55], v[176:191]
    v_exp_f32 v163, v163
    v_exp_f32 v164, v164
    v_exp_f32 v165, v165
    v_exp_f32 v166, v166
    v_smfmac_f32_32x32x32_bf16 v[80:95], a[56:59], v[144:151], v5
    v_exp_f32 v167, v167
    v_exp_f32 v168, v168
    v_exp_f32 v169, v169
    v_smfmac_f32_16x16x64_bf16 v[132:135], v[20:23], v[144:151], v5
    v_exp_f32 v170, v170
    v_smfmac_f32_32x32x32_bf16 v[80:95], a[60:63], v[152:159], v5
    v_exp_f32 v171, v171
    v_exp_f32 v172, v172
    v_exp_f32 v173, v173
    v_smfmac_f32_16x16x64_bf16 v[132:135], v[20:23], v[152:159], v5
    v_exp_f32 v174, v174
    v_exp_f32 v175, v175
    v_mfma_f32_32x32x16_bf16 v[144:159], a[16:19], v[48:51], 4.0
    v_exp_f32 v176, v176
    v_exp_f32 v177, v177
    v_exp_f32 v178, v178
    v_mfma_f32_32x32x16_bf16 v[144:159], a[20:23], v[52:55], v[144:159]
    v_exp_f32 v179, v179
    v_exp_f32 v180, v180
    v_exp_f32 v181, v181
    v_exp_f32 v182, v182
    v_smfmac_f32_32x32x32_bf16 v[80:95], a[40:43], v[160:167], v5
    v_exp_f32 v183, v183
    v_exp_f32 v184, v184
    v_exp_f32 v185, v185
    v_smfmac_f32_16x16x64_bf16 v[132:135], v[20:23], v[160:167], v5
    v_exp_f32 v186, v186
    v_smfmac_f32_32x32x32_bf16 v[80:95], a[44:47], v[168:175], v5
    v_exp_f32 v187, v187
    v_exp_f32 v188, v188
    v_exp_f32 v189, v189
    v_smfmac_f32_16x16x64_bf16 v[132:135], v[20:23], v[168:175], v5
    v_exp_f32 v190, v190
    v_exp_f32 v191, v191
    v_mfma_f32_32x32x16_bf16 v[160:175], a[24:27], v[48:51], 4.0
    v_exp_f32 v144, v144
    v_exp_f32 v145, v145
    v_exp_f32 v146, v146
    v_mfma_f32_32x32x16_bf16 v[160:175], a[28:31], v[52:55], v[160:175]
    v_exp_f32 v147, v147
    v_exp_f32 v148, v148
    v_exp_f32 v149, v149
    v_rcp_f32 v14, v132
    v_exp_f32 v150, v150
    v_pk_mul_f32 v[80:81], v[80:81], v[14:15] op_sel_hi:[1,0]
    v_pk_mul_f32 v[82:83], v[82:83], v[14:15] op_sel_hi:[1,0]
    v_pk_mul_f32 v[84:85], v[84:85], v[14:15] op_sel_hi:[1,0]
    v_pk_mul_f32 v[86:87], v[86:87], v[14:15] op_sel_hi:[1,0]
    v_pk_mul_f32 v[88:89], v[88:89], v[14:15] op_sel_hi:[1,0]
    v_pk_mul_f32 v[90:91], v[90:91], v[14:15] op_sel_hi:[1,0]
    v_pk_mul_f32 v[92:93], v[92:93], v[14:15] op_sel_hi:[1,0]
    v_pk_mul_f32 v[94:95], v[94:95], v[14:15] op_sel_hi:[1,0]
    v_cvt_pk_bf16_f32 v80, v80, v81
    v_cvt_pk_bf16_f32 v81, v82, v83
    v_cvt_pk_bf16_f32 v82, v84, v85
    v_cvt_pk_bf16_f32 v83, v86, v87
    v_cvt_pk_bf16_f32 v84, v88, v89
    v_cvt_pk_bf16_f32 v85, v90, v91
    v_cvt_pk_bf16_f32 v86, v92, v93
    v_cvt_pk_bf16_f32 v87, v94, v95
    v_permlane16_swap_b32 v80, v84
    v_permlane16_swap_b32 v81, v85
    v_permlane16_swap_b32 v82, v86
    v_permlane16_swap_b32 v83, v87
    v_smfmac_f32_32x32x32_bf16 v[96:111], a[32:35], v[176:183], v5
    v_exp_f32 v151, v151
    v_exp_f32 v152, v152
    v_exp_f32 v153, v153
    v_smfmac_f32_16x16x64_bf16 v[136:139], v[20:23], v[176:183], v5
    buffer_store_dwordx4 v[80:83], v9, s[16:19], s35 offen sc1 nt
    v_exp_f32 v154, v154
    v_smfmac_f32_32x32x32_bf16 v[96:111], a[36:39], v[184:191], v5
    v_exp_f32 v155, v155
    v_exp_f32 v156, v156
    v_exp_f32 v157, v157
    v_smfmac_f32_16x16x64_bf16 v[136:139], v[20:23], v[184:191], v5
    buffer_store_dwordx4 v[84:87], v9, s[16:19], s35 offen offset:1024 sc1 nt
    v_exp_f32 v158, v158
    v_exp_f32 v159, v159
    v_mfma_f32_32x32x16_bf16 v[176:191], a[8:11], v[48:51], 4.0
    v_exp_f32 v160, v160
    v_exp_f32 v161, v161
    v_exp_f32 v162, v162
    v_mfma_f32_32x32x16_bf16 v[176:191], a[12:15], v[52:55], v[176:191]
    v_exp_f32 v163, v163
    v_exp_f32 v164, v164
    v_exp_f32 v165, v165
    v_exp_f32 v166, v166
    v_smfmac_f32_32x32x32_bf16 v[96:111], a[48:51], v[144:151], v5
    v_exp_f32 v167, v167
    v_exp_f32 v168, v168
    v_exp_f32 v169, v169
    v_smfmac_f32_16x16x64_bf16 v[136:139], v[20:23], v[144:151], v5
    v_exp_f32 v170, v170
    v_smfmac_f32_32x32x32_bf16 v[96:111], a[52:55], v[152:159], v5
    v_exp_f32 v171, v171
    v_exp_f32 v172, v172
    v_exp_f32 v173, v173
    v_smfmac_f32_16x16x64_bf16 v[136:139], v[20:23], v[152:159], v5
    v_exp_f32 v174, v174
    v_exp_f32 v175, v175
    v_mfma_f32_32x32x16_bf16 v[144:159], a[0:3], v[56:59], 4.0
    v_exp_f32 v176, v176
    v_exp_f32 v177, v177
    v_exp_f32 v178, v178
    v_mfma_f32_32x32x16_bf16 v[144:159], a[4:7], v[60:63], v[144:159]
    v_exp_f32 v179, v179
    v_exp_f32 v180, v180
    v_exp_f32 v181, v181
    v_exp_f32 v182, v182
    v_smfmac_f32_32x32x32_bf16 v[96:111], a[56:59], v[160:167], v5
    v_exp_f32 v183, v183
    v_exp_f32 v184, v184
    v_exp_f32 v185, v185
    v_smfmac_f32_16x16x64_bf16 v[136:139], v[20:23], v[160:167], v5
    v_exp_f32 v186, v186
    v_smfmac_f32_32x32x32_bf16 v[96:111], a[60:63], v[168:175], v5
    v_exp_f32 v187, v187
    v_exp_f32 v188, v188
    v_exp_f32 v189, v189
    v_smfmac_f32_16x16x64_bf16 v[136:139], v[20:23], v[168:175], v5
    v_exp_f32 v190, v190
    v_exp_f32 v191, v191
    v_mfma_f32_32x32x16_bf16 v[160:175], a[16:19], v[56:59], 4.0
    v_exp_f32 v144, v144
    v_exp_f32 v145, v145
    v_exp_f32 v146, v146
    v_mfma_f32_32x32x16_bf16 v[160:175], a[20:23], v[60:63], v[160:175]
    v_exp_f32 v147, v147
    v_exp_f32 v148, v148
    v_exp_f32 v149, v149
    v_exp_f32 v150, v150
    v_smfmac_f32_32x32x32_bf16 v[96:111], a[40:43], v[176:183], v5
    v_exp_f32 v151, v151
    v_exp_f32 v152, v152
    v_exp_f32 v153, v153
    v_smfmac_f32_16x16x64_bf16 v[136:139], v[20:23], v[176:183], v5
    v_exp_f32 v154, v154
    v_smfmac_f32_32x32x32_bf16 v[96:111], a[44:47], v[184:191], v5
    v_exp_f32 v155, v155
    v_exp_f32 v156, v156
    v_exp_f32 v157, v157
    v_smfmac_f32_16x16x64_bf16 v[136:139], v[20:23], v[184:191], v5
    v_exp_f32 v158, v158
    v_exp_f32 v159, v159
    v_mfma_f32_32x32x16_bf16 v[176:191], a[24:27], v[56:59], 4.0
    v_exp_f32 v160, v160
    v_exp_f32 v161, v161
    v_exp_f32 v162, v162
    v_mfma_f32_32x32x16_bf16 v[176:191], a[28:31], v[60:63], v[176:191]
    v_exp_f32 v163, v163
    v_exp_f32 v164, v164
    v_exp_f32 v165, v165
    v_rcp_f32 v16, v136
    v_exp_f32 v166, v166
    v_pk_mul_f32 v[96:97], v[96:97], v[16:17] op_sel_hi:[1,0]
    v_pk_mul_f32 v[98:99], v[98:99], v[16:17] op_sel_hi:[1,0]
    v_pk_mul_f32 v[100:101], v[100:101], v[16:17] op_sel_hi:[1,0]
    v_pk_mul_f32 v[102:103], v[102:103], v[16:17] op_sel_hi:[1,0]
    v_pk_mul_f32 v[104:105], v[104:105], v[16:17] op_sel_hi:[1,0]
    v_pk_mul_f32 v[106:107], v[106:107], v[16:17] op_sel_hi:[1,0]
    v_pk_mul_f32 v[108:109], v[108:109], v[16:17] op_sel_hi:[1,0]
    v_pk_mul_f32 v[110:111], v[110:111], v[16:17] op_sel_hi:[1,0]
    v_cvt_pk_bf16_f32 v96, v96, v97
    v_cvt_pk_bf16_f32 v97, v98, v99
    v_cvt_pk_bf16_f32 v98, v100, v101
    v_cvt_pk_bf16_f32 v99, v102, v103
    v_cvt_pk_bf16_f32 v100, v104, v105
    v_cvt_pk_bf16_f32 v101, v106, v107
    v_cvt_pk_bf16_f32 v102, v108, v109
    v_cvt_pk_bf16_f32 v103, v110, v111
    v_permlane16_swap_b32 v96, v100
    v_permlane16_swap_b32 v97, v101
    v_permlane16_swap_b32 v98, v102
    v_permlane16_swap_b32 v99, v103
    v_smfmac_f32_32x32x32_bf16 v[112:127], a[32:35], v[144:151], v5
    v_exp_f32 v167, v167
    v_exp_f32 v168, v168
    v_exp_f32 v169, v169
    v_smfmac_f32_16x16x64_bf16 v[140:143], v[20:23], v[144:151], v5
    buffer_store_dwordx4 v[96:99], v9, s[16:19], s54 offen sc1 nt
    v_exp_f32 v170, v170
    v_smfmac_f32_32x32x32_bf16 v[112:127], a[36:39], v[152:159], v5
    v_exp_f32 v171, v171
    v_exp_f32 v172, v172
    v_exp_f32 v173, v173
    v_smfmac_f32_16x16x64_bf16 v[140:143], v[20:23], v[152:159], v5
    buffer_store_dwordx4 v[100:103], v9, s[16:19], s54 offen offset:1024 sc1 nt
    v_exp_f32 v174, v174
    v_exp_f32 v175, v175
    v_mfma_f32_32x32x16_bf16 v[144:159], a[8:11], v[56:59], 4.0
    v_exp_f32 v176, v176
    v_exp_f32 v177, v177
    v_exp_f32 v178, v178
    v_mfma_f32_32x32x16_bf16 v[144:159], a[12:15], v[60:63], v[144:159]
    v_exp_f32 v179, v179
    v_exp_f32 v180, v180
    v_exp_f32 v181, v181
    v_exp_f32 v182, v182
    v_smfmac_f32_32x32x32_bf16 v[112:127], a[48:51], v[160:167], v5
    v_exp_f32 v183, v183
    v_exp_f32 v184, v184
    v_exp_f32 v185, v185
    v_smfmac_f32_16x16x64_bf16 v[140:143], v[20:23], v[160:167], v5
    v_exp_f32 v186, v186
    v_smfmac_f32_32x32x32_bf16 v[112:127], a[52:55], v[168:175], v5
    v_exp_f32 v187, v187
    v_exp_f32 v188, v188
    v_exp_f32 v189, v189
    v_smfmac_f32_16x16x64_bf16 v[140:143], v[20:23], v[168:175], v5
    v_exp_f32 v190, v190
    v_exp_f32 v191, v191
    v_smfmac_f32_32x32x32_bf16 v[112:127], a[56:59], v[176:183], v5
    v_exp_f32 v144, v144
    v_exp_f32 v145, v145
    v_exp_f32 v146, v146
    v_smfmac_f32_16x16x64_bf16 v[140:143], v[20:23], v[176:183], v5
    v_exp_f32 v147, v147
    v_smfmac_f32_32x32x32_bf16 v[112:127], a[60:63], v[184:191], v5
    v_exp_f32 v148, v148
    v_exp_f32 v149, v149
    v_exp_f32 v150, v150
    v_smfmac_f32_16x16x64_bf16 v[140:143], v[20:23], v[184:191], v5
    v_exp_f32 v151, v151
    v_exp_f32 v152, v152
    v_exp_f32 v153, v153
    v_smfmac_f32_32x32x32_bf16 v[112:127], a[40:43], v[144:151], v5
    v_exp_f32 v154, v154
    v_exp_f32 v155, v155
    v_exp_f32 v156, v156
    v_smfmac_f32_16x16x64_bf16 v[140:143], v[20:23], v[144:151], v5
    v_exp_f32 v157, v157
    v_exp_f32 v158, v158
    v_exp_f32 v159, v159
    s_nop 1
    v_smfmac_f32_16x16x64_bf16 v[140:143], v[20:23], v[152:159], v5
    v_smfmac_f32_32x32x32_bf16 v[112:127], a[44:47], v[152:159], v5
    s_nop 6
    v_rcp_f32 v18, v140
    s_nop 3
    v_pk_mul_f32 v[112:113], v[112:113], v[18:19] op_sel_hi:[1,0]
    v_pk_mul_f32 v[114:115], v[114:115], v[18:19] op_sel_hi:[1,0]
    v_pk_mul_f32 v[116:117], v[116:117], v[18:19] op_sel_hi:[1,0]
    v_pk_mul_f32 v[118:119], v[118:119], v[18:19] op_sel_hi:[1,0]
    v_pk_mul_f32 v[120:121], v[120:121], v[18:19] op_sel_hi:[1,0]
    v_pk_mul_f32 v[122:123], v[122:123], v[18:19] op_sel_hi:[1,0]
    v_pk_mul_f32 v[124:125], v[124:125], v[18:19] op_sel_hi:[1,0]
    v_pk_mul_f32 v[126:127], v[126:127], v[18:19] op_sel_hi:[1,0]
    v_cvt_pk_bf16_f32 v112, v112, v113
    v_cvt_pk_bf16_f32 v113, v114, v115
    v_cvt_pk_bf16_f32 v114, v116, v117
    v_cvt_pk_bf16_f32 v115, v118, v119
    v_cvt_pk_bf16_f32 v116, v120, v121
    v_cvt_pk_bf16_f32 v117, v122, v123
    v_cvt_pk_bf16_f32 v118, v124, v125
    v_cvt_pk_bf16_f32 v119, v126, v127
    v_permlane16_swap_b32 v112, v116
    v_permlane16_swap_b32 v113, v117
    v_permlane16_swap_b32 v114, v118
    v_permlane16_swap_b32 v115, v119
    buffer_store_dwordx4 v[112:115], v9, s[16:19], s59 offen sc1 nt
    buffer_store_dwordx4 v[116:119], v9, s[16:19], s59 offen offset:1024 sc1 nt
L_end:
    s_endpgm
L_code_end:
.p2align 12
L_loader2:
    s_waitcnt vmcnt(8)
    buffer_load_dword v8, v7, s[16:19], 0 offen sc1
    s_barrier
    s_cmp_eq_u32 s32, 9
    s_cbranch_scc1 L_ready3
    s_mov_b32 s32, 3
    s_mov_b32 s60, 256
L_spin3:
    s_waitcnt vmcnt(0)
    v_readfirstlane_b32 s54, v8
    s_sub_u32 s60, s60, 1
    s_nop 2
    s_and_b32 s54, s54, 0x2020202
    s_cmp_eq_u32 s54, 0x2020202
    s_cbranch_scc1 L_ready3
    buffer_load_dword v8, v7, s[16:19], 0 offen sc1
    s_cmp_lg_u32 s60, 0
    s_cbranch_scc1 L_spin3
    s_branch L_help
L_ready3:
    buffer_store_byte v10, v1, s[16:19], 0 offen sc1
    s_add_u32 s34, s34, 8192
    s_and_b32 s34, s34, 0x1ffff
    s_cmp_eq_u32 s34, s58
    s_cselect_b32 s34, s3, s34
    s_mov_b32 m0, 16384
    s_nop 0
    buffer_load_dwordx4 v2, s[20:23], s34 offen offset:0 sc1 lds
    buffer_load_dwordx4 v2, s[20:23], s34 offen offset:1024 sc1 lds
    buffer_load_dwordx4 v2, s[20:23], s34 offen offset:2048 sc1 lds
    buffer_load_dwordx4 v2, s[20:23], s34 offen offset:3072 sc1 lds
    s_mov_b32 m0, 20480
    s_add_u32 s50, s34, 4096
    buffer_load_dwordx4 v2, s[20:23], s50 offen offset:0 sc1 lds
    buffer_load_dwordx4 v2, s[20:23], s50 offen offset:1024 sc1 lds
    buffer_load_dwordx4 v2, s[20:23], s50 offen offset:2048 sc1 lds
    buffer_load_dwordx4 v2, s[20:23], s50 offen offset:3072 sc1 lds
    s_add_u32 s33, s33, 8192
    s_and_b32 s33, s33, 0x1ffff
    s_cmp_eq_u32 s33, s58
    s_cselect_b32 s33, s3, s33
    s_mov_b32 m0, 57344
    s_nop 0
    buffer_load_dwordx4 v2, s[12:15], s33 offen offset:0  lds
    buffer_load_dwordx4 v2, s[12:15], s33 offen offset:1024  lds
    buffer_load_dwordx4 v2, s[12:15], s33 offen offset:2048  lds
    buffer_load_dwordx4 v2, s[12:15], s33 offen offset:3072  lds
    s_mov_b32 m0, 61440
    s_add_u32 s50, s33, 4096
    buffer_load_dwordx4 v2, s[12:15], s50 offen offset:0  lds
    buffer_load_dwordx4 v2, s[12:15], s50 offen offset:1024  lds
    buffer_load_dwordx4 v2, s[12:15], s50 offen offset:2048  lds
    buffer_load_dwordx4 v2, s[12:15], s50 offen offset:3072  lds
    s_branch L_pad4
L_hop4:
    s_waitcnt vmcnt(8)
    buffer_load_dword v8, v7, s[16:19], 0 offen sc1
    s_barrier
    s_cmp_eq_u32 s32, 9
    s_cbranch_scc1 L_ready4
    s_mov_b32 s32, 4
    s_mov_b32 s60, 256
L_spin4:
    s_waitcnt vmcnt(0)
    v_readfirstlane_b32 s54, v8
    s_sub_u32 s60, s60, 1
    s_nop 2
    s_and_b32 s54, s54, 0x4040404
    s_cmp_eq_u32 s54, 0x4040404
    s_cbranch_scc1 L_ready4
    buffer_load_dword v8, v7, s[16:19], 0 offen sc1
    s_cmp_lg_u32 s60, 0
    s_cbranch_scc1 L_spin4
    s_branch L_help
L_ready4:
    s_add_u32 s34, s34, 8192
    s_and_b32 s34, s34, 0x1ffff
    s_cmp_eq_u32 s34, s58
    s_cselect_b32 s34, s3, s34
    s_mov_b32 m0, 24576
    s_nop 0
    buffer_load_dwordx4 v2, s[20:23], s34 offen offset:0 sc1 lds
    buffer_load_dwordx4 v2, s[20:23], s34 offen offset:1024 sc1 lds
    buffer_load_dwordx4 v2, s[20:23], s34 offen offset:2048 sc1 lds
    buffer_load_dwordx4 v2, s[20:23], s34 offen offset:3072 sc1 lds
    s_mov_b32 m0, 28672
    s_add_u32 s50, s34, 4096
    buffer_load_dwordx4 v2, s[20:23], s50 offen offset:0 sc1 lds
    buffer_load_dwordx4 v2, s[20:23], s50 offen offset:1024 sc1 lds
    buffer_load_dwordx4 v2, s[20:23], s50 offen offset:2048 sc1 lds
    buffer_load_dwordx4 v2, s[20:23], s50 offen offset:3072 sc1 lds
    s_add_u32 s33, s33, 8192
    s_and_b32 s33, s33, 0x1ffff
    s_cmp_eq_u32 s33, s58
    s_cselect_b32 s33, s3, s33
    s_mov_b32 m0, 32768
    s_nop 0
    buffer_load_dwordx4 v2, s[12:15], s33 offen offset:0  lds
    buffer_load_dwordx4 v2, s[12:15], s33 offen offset:1024  lds
    buffer_load_dwordx4 v2, s[12:15], s33 offen offset:2048  lds
    buffer_load_dwordx4 v2, s[12:15], s33 offen offset:3072  lds
    s_mov_b32 m0, 36864
    s_add_u32 s50, s33, 4096
    buffer_load_dwordx4 v2, s[12:15], s50 offen offset:0  lds
    buffer_load_dwordx4 v2, s[12:15], s50 offen offset:1024  lds
    buffer_load_dwordx4 v2, s[12:15], s50 offen offset:2048  lds
    buffer_load_dwordx4 v2, s[12:15], s50 offen offset:3072  lds
    s_add_u32 s34, s34, 8192
    s_and_b32 s34, s34, 0x1ffff
    s_cmp_eq_u32 s34, s58
    s_cselect_b32 s34, s3, s34
    s_mov_b32 m0, 0
    s_nop 0
    buffer_load_dwordx4 v2, s[20:23], s34 offen offset:0 sc1 lds
    buffer_load_dwordx4 v2, s[20:23], s34 offen offset:1024 sc1 lds
    buffer_load_dwordx4 v2, s[20:23], s34 offen offset:2048 sc1 lds
    buffer_load_dwordx4 v2, s[20:23], s34 offen offset:3072 sc1 lds
    s_mov_b32 m0, 4096
    s_add_u32 s50, s34, 4096
    buffer_load_dwordx4 v2, s[20:23], s50 offen offset:0 sc1 lds
    buffer_load_dwordx4 v2, s[20:23], s50 offen offset:1024 sc1 lds
    buffer_load_dwordx4 v2, s[20:23], s50 offen offset:2048 sc1 lds
    buffer_load_dwordx4 v2, s[20:23], s50 offen offset:3072 sc1 lds
    s_waitcnt vmcnt(16)
    s_barrier
    s_mov_b32 s35, 7
    s_mov_b32 s59, 0
L_lloop:
    s_add_u32 s59, s59, 8192
    s_and_b32 s59, s59, 0x7fff
    s_add_u32 s33, s33, 8192
    s_and_b32 s33, s33, 0x1ffff
    s_cmp_eq_u32 s33, s58
    s_cselect_b32 s33, s3, s33
    s_add_u32 m0, s59, 32768
    s_nop 0
    buffer_load_dwordx4 v2, s[12:15], s33 offen offset:0  lds
    buffer_load_dwordx4 v2, s[12:15], s33 offen offset:1024  lds
    buffer_load_dwordx4 v2, s[12:15], s33 offen offset:2048  lds
    buffer_load_dwordx4 v2, s[12:15], s33 offen offset:3072  lds
    s_add_u32 m0, s59, 36864
    s_add_u32 s50, s33, 4096
    buffer_load_dwordx4 v2, s[12:15], s50 offen offset:0  lds
    buffer_load_dwordx4 v2, s[12:15], s50 offen offset:1024  lds
    buffer_load_dwordx4 v2, s[12:15], s50 offen offset:2048  lds
    buffer_load_dwordx4 v2, s[12:15], s50 offen offset:3072  lds
    s_add_u32 m0, s59, 0
    s_nop 0
    buffer_load_dwordx4 v2, s[20:23], s33 offen offset:0 sc1 lds
    buffer_load_dwordx4 v2, s[20:23], s33 offen offset:1024 sc1 lds
    buffer_load_dwordx4 v2, s[20:23], s33 offen offset:2048 sc1 lds
    buffer_load_dwordx4 v2, s[20:23], s33 offen offset:3072 sc1 lds
    s_add_u32 m0, s59, 4096
    s_add_u32 s50, s33, 4096
    buffer_load_dwordx4 v2, s[20:23], s50 offen offset:0 sc1 lds
    buffer_load_dwordx4 v2, s[20:23], s50 offen offset:1024 sc1 lds
    buffer_load_dwordx4 v2, s[20:23], s50 offen offset:2048 sc1 lds
    buffer_load_dwordx4 v2, s[20:23], s50 offen offset:3072 sc1 lds
    s_cmp_eq_u32 s35, 7
    s_cbranch_scc1 L_pad5
    s_cmp_eq_u32 s35, 5
    s_cbranch_scc1 L_pad6
    s_cmp_eq_u32 s35, 3
    s_cbranch_scc1 L_pad7
    s_cmp_eq_u32 s35, 1
    s_cbranch_scc1 L_pad8
L_hopx:
    s_waitcnt vmcnt(16)
    s_barrier
    s_sub_u32 s35, s35, 1
    s_cmp_lg_u32 s35, 0
    s_cbranch_scc1 L_lloop
    s_waitcnt vmcnt(0)
    s_barrier
    s_endpgm
L_loader_slow:
    buffer_store_dword v20, v3, s[16:19], 0 offen sc1
    s_waitcnt vmcnt(0)
    buffer_store_dword v5, v3, s[24:27], 0 offen sc1
    s_barrier
    s_endpgm
L_help:
    s_mov_b32 s60, 64
    s_mov_b32 s53, 0
L_help_loop:
    s_add_u32 s53, s53, 2048
    s_and_b32 s53, s53, 0x1ffff
    buffer_load_dwordx4 v[24:27], v6, s[8:11], s53 offen
    buffer_load_dwordx4 v[28:31], v6, s[8:11], s53 offen offset:16
    s_waitcnt vmcnt(0)
    v_dot2_f32_bf16 v12, v24, v24, 0
    v_dot2_f32_bf16 v12, v25, v25, v12
    v_dot2_f32_bf16 v12, v26, v26, v12
    v_dot2_f32_bf16 v12, v27, v27, v12
    v_dot2_f32_bf16 v12, v28, v28, v12
    v_dot2_f32_bf16 v12, v29, v29, v12
    v_dot2_f32_bf16 v12, v30, v30, v12
    v_dot2_f32_bf16 v12, v31, v31, v12
    v_lshlrev_b32 v14, 16, v24
    v_and_b32 v15, 0xffff0000, v24
    v_lshlrev_b32 v16, 16, v25
    v_add_f32_dpp v12, v12, v12 quad_perm:[1,0,3,2] row_mask:0xf bank_mask:0xf
    v_sqrt_f32 v12, v12
    v_and_b32 v17, 0xffff0000, v25
    v_add_f32 v12, s61, v12
    v_rcp_f32 v12, v12
    v_lshlrev_b32 v18, 16, v26
    v_pk_mul_f32 v[14:15], v[14:15], v[12:13] op_sel_hi:[1,0]
    v_cvt_pk_bf16_f32 v24, v14, v15
    v_pk_mul_f32 v[16:17], v[16:17], v[12:13] op_sel_hi:[1,0]
    v_cvt_pk_bf16_f32 v25, v16, v17
    v_and_b32 v19, 0xffff0000, v26
    v_pk_mul_f32 v[18:19], v[18:19], v[12:13] op_sel_hi:[1,0]
    v_cvt_pk_bf16_f32 v26, v18, v19
    v_lshlrev_b32 v14, 16, v27
    v_and_b32 v15, 0xffff0000, v27
    v_pk_mul_f32 v[14:15], v[14:15], v[12:13] op_sel_hi:[1,0]
    v_cvt_pk_bf16_f32 v27, v14, v15
    v_lshlrev_b32 v16, 16, v28
    v_and_b32 v17, 0xffff0000, v28
    v_pk_mul_f32 v[16:17], v[16:17], v[12:13] op_sel_hi:[1,0]
    v_cvt_pk_bf16_f32 v28, v16, v17
    v_lshlrev_b32 v18, 16, v29
    v_and_b32 v19, 0xffff0000, v29
    v_pk_mul_f32 v[18:19], v[18:19], v[12:13] op_sel_hi:[1,0]
    v_cvt_pk_bf16_f32 v29, v18, v19
    v_lshlrev_b32 v14, 16, v30
    v_and_b32 v15, 0xffff0000, v30
    v_pk_mul_f32 v[14:15], v[14:15], v[12:13] op_sel_hi:[1,0]
    v_cvt_pk_bf16_f32 v30, v14, v15
    v_lshlrev_b32 v16, 16, v31
    v_and_b32 v17, 0xffff0000, v31
    v_pk_mul_f32 v[16:17], v[16:17], v[12:13] op_sel_hi:[1,0]
    v_cvt_pk_bf16_f32 v31, v16, v17
    buffer_store_dwordx4 v[24:27], v2, s[20:23], s53 offen sc1
    buffer_store_dwordx4 v[28:31], v2, s[20:23], s53 offen offset:1024 sc1
    s_waitcnt vmcnt(0)
    s_sub_u32 s60, s60, 1
    s_cmp_lg_u32 s60, 0
    s_cbranch_scc1 L_help_loop
    s_mov_b32 s60, s32
    s_mov_b32 s32, 9
    s_cmp_eq_u32 s60, 1
    s_cbranch_scc1 L_ready1
    s_cmp_eq_u32 s60, 2
    s_cbranch_scc1 L_ready2
    s_cmp_eq_u32 s60, 3
    s_cbranch_scc1 L_ready3
    s_branch L_ready4
L_slow:
    s_waitcnt vmcnt(0)
    buffer_load_dwordx4 v[32:35], v1, s[4:7], s33 offen
    buffer_load_dwordx4 v[36:39], v1, s[4:7], s33 offen offset:32
    buffer_load_dwordx4 v[40:43], v1, s[4:7], s35 offen
    buffer_load_dwordx4 v[44:47], v1, s[4:7], s35 offen offset:32
    buffer_load_dwordx4 v[48:51], v1, s[4:7], s54 offen
    buffer_load_dwordx4 v[52:55], v1, s[4:7], s54 offen offset:32
    buffer_load_dwordx4 v[56:59], v1, s[4:7], s59 offen
    buffer_load_dwordx4 v[60:63], v1, s[4:7], s59 offen offset:32
    s_waitcnt vmcnt(0) lgkmcnt(0)
    s_barrier
    v_dot2_f32_bf16 v12, v32, v32, 0
    v_dot2_f32_bf16 v12, v33, v33, v12
    v_dot2_f32_bf16 v12, v34, v34, v12
    v_dot2_f32_bf16 v12, v35, v35, v12
    v_dot2_f32_bf16 v12, v36, v36, v12
    v_dot2_f32_bf16 v12, v37, v37, v12
    v_dot2_f32_bf16 v12, v38, v38, v12
    v_dot2_f32_bf16 v12, v39, v39, v12
    v_lshlrev_b32 v14, 16, v32
    v_and_b32 v15, 0xffff0000, v32
    v_lshlrev_b32 v16, 16, v33
    v_mov_b32 v13, v12
    v_and_b32 v17, 0xffff0000, v33
    v_lshlrev_b32 v18, 16, v34
    v_permlane32_swap_b32 v12, v13
    v_and_b32 v19, 0xffff0000, v34
    v_add_f32 v12, v12, v13
    v_sqrt_f32 v12, v12
    s_nop 0
    v_add_f32 v12, s61, v12
    v_rcp_f32 v12, v12
    s_nop 0
    v_mul_f32 v12, v10, v12
    v_pk_mul_f32 v[14:15], v[14:15], v[12:13] op_sel_hi:[1,0]
    v_cvt_pk_bf16_f32 v32, v14, v15
    v_pk_mul_f32 v[16:17], v[16:17], v[12:13] op_sel_hi:[1,0]
    v_cvt_pk_bf16_f32 v33, v16, v17
    v_pk_mul_f32 v[18:19], v[18:19], v[12:13] op_sel_hi:[1,0]
    v_cvt_pk_bf16_f32 v34, v18, v19
    v_lshlrev_b32 v14, 16, v35
    v_and_b32 v15, 0xffff0000, v35
    v_pk_mul_f32 v[14:15], v[14:15], v[12:13] op_sel_hi:[1,0]
    v_cvt_pk_bf16_f32 v35, v14, v15
    v_lshlrev_b32 v16, 16, v36
    v_and_b32 v17, 0xffff0000, v36
    v_pk_mul_f32 v[16:17], v[16:17], v[12:13] op_sel_hi:[1,0]
    v_cvt_pk_bf16_f32 v36, v16, v17
    v_lshlrev_b32 v18, 16, v37
    v_and_b32 v19, 0xffff0000, v37
    v_pk_mul_f32 v[18:19], v[18:19], v[12:13] op_sel_hi:[1,0]
    v_cvt_pk_bf16_f32 v37, v18, v19
    v_lshlrev_b32 v14, 16, v38
    v_and_b32 v15, 0xffff0000, v38
    v_pk_mul_f32 v[14:15], v[14:15], v[12:13] op_sel_hi:[1,0]
    v_cvt_pk_bf16_f32 v38, v14, v15
    v_lshlrev_b32 v16, 16, v39
    v_and_b32 v17, 0xffff0000, v39
    v_pk_mul_f32 v[16:17], v[16:17], v[12:13] op_sel_hi:[1,0]
    v_cvt_pk_bf16_f32 v39, v16, v17
    v_dot2_f32_bf16 v12, v40, v40, 0
    v_dot2_f32_bf16 v12, v41, v41, v12
    v_dot2_f32_bf16 v12, v42, v42, v12
    v_dot2_f32_bf16 v12, v43, v43, v12
    v_dot2_f32_bf16 v12, v44, v44, v12
    v_dot2_f32_bf16 v12, v45, v45, v12
    v_dot2_f32_bf16 v12, v46, v46, v12
    v_dot2_f32_bf16 v12, v47, v47, v12
    v_lshlrev_b32 v14, 16, v40
    v_and_b32 v15, 0xffff0000, v40
    v_lshlrev_b32 v16, 16, v41
    v_mov_b32 v13, v12
    v_and_b32 v17, 0xffff0000, v41
    v_lshlrev_b32 v18, 16, v42
    v_permlane32_swap_b32 v12, v13
    v_and_b32 v19, 0xffff0000, v42
    v_add_f32 v12, v12, v13
    v_sqrt_f32 v12, v12
    s_nop 0
    v_add_f32 v12, s61, v12
    v_rcp_f32 v12, v12
    s_nop 0
    v_mul_f32 v12, v10, v12
    v_pk_mul_f32 v[14:15], v[14:15], v[12:13] op_sel_hi:[1,0]
    v_cvt_pk_bf16_f32 v40, v14, v15
    v_pk_mul_f32 v[16:17], v[16:17], v[12:13] op_sel_hi:[1,0]
    v_cvt_pk_bf16_f32 v41, v16, v17
    v_pk_mul_f32 v[18:19], v[18:19], v[12:13] op_sel_hi:[1,0]
    v_cvt_pk_bf16_f32 v42, v18, v19
    v_lshlrev_b32 v14, 16, v43
    v_and_b32 v15, 0xffff0000, v43
    v_pk_mul_f32 v[14:15], v[14:15], v[12:13] op_sel_hi:[1,0]
    v_cvt_pk_bf16_f32 v43, v14, v15
    v_lshlrev_b32 v16, 16, v44
    v_and_b32 v17, 0xffff0000, v44
    v_pk_mul_f32 v[16:17], v[16:17], v[12:13] op_sel_hi:[1,0]
    v_cvt_pk_bf16_f32 v44, v16, v17
    v_lshlrev_b32 v18, 16, v45
    v_and_b32 v19, 0xffff0000, v45
    v_pk_mul_f32 v[18:19], v[18:19], v[12:13] op_sel_hi:[1,0]
    v_cvt_pk_bf16_f32 v45, v18, v19
    v_lshlrev_b32 v14, 16, v46
    v_and_b32 v15, 0xffff0000, v46
    v_pk_mul_f32 v[14:15], v[14:15], v[12:13] op_sel_hi:[1,0]
    v_cvt_pk_bf16_f32 v46, v14, v15
    v_lshlrev_b32 v16, 16, v47
    v_and_b32 v17, 0xffff0000, v47
    v_pk_mul_f32 v[16:17], v[16:17], v[12:13] op_sel_hi:[1,0]
    v_cvt_pk_bf16_f32 v47, v16, v17
    v_dot2_f32_bf16 v12, v48, v48, 0
    v_dot2_f32_bf16 v12, v49, v49, v12
    v_dot2_f32_bf16 v12, v50, v50, v12
    v_dot2_f32_bf16 v12, v51, v51, v12
    v_dot2_f32_bf16 v12, v52, v52, v12
    v_dot2_f32_bf16 v12, v53, v53, v12
    v_dot2_f32_bf16 v12, v54, v54, v12
    v_dot2_f32_bf16 v12, v55, v55, v12
    v_lshlrev_b32 v14, 16, v48
    v_and_b32 v15, 0xffff0000, v48
    v_lshlrev_b32 v16, 16, v49
    v_mov_b32 v13, v12
    v_and_b32 v17, 0xffff0000, v49
    v_lshlrev_b32 v18, 16, v50
    v_permlane32_swap_b32 v12, v13
    v_and_b32 v19, 0xffff0000, v50
    v_add_f32 v12, v12, v13
    v_sqrt_f32 v12, v12
    s_nop 0
    v_add_f32 v12, s61, v12
    v_rcp_f32 v12, v12
    s_nop 0
    v_mul_f32 v12, v10, v12
    v_pk_mul_f32 v[14:15], v[14:15], v[12:13] op_sel_hi:[1,0]
    v_cvt_pk_bf16_f32 v48, v14, v15
    v_pk_mul_f32 v[16:17], v[16:17], v[12:13] op_sel_hi:[1,0]
    v_cvt_pk_bf16_f32 v49, v16, v17
    v_pk_mul_f32 v[18:19], v[18:19], v[12:13] op_sel_hi:[1,0]
    v_cvt_pk_bf16_f32 v50, v18, v19
    v_lshlrev_b32 v14, 16, v51
    v_and_b32 v15, 0xffff0000, v51
    v_pk_mul_f32 v[14:15], v[14:15], v[12:13] op_sel_hi:[1,0]
    v_cvt_pk_bf16_f32 v51, v14, v15
    v_lshlrev_b32 v16, 16, v52
    v_and_b32 v17, 0xffff0000, v52
    v_pk_mul_f32 v[16:17], v[16:17], v[12:13] op_sel_hi:[1,0]
    v_cvt_pk_bf16_f32 v52, v16, v17
    v_lshlrev_b32 v18, 16, v53
    v_and_b32 v19, 0xffff0000, v53
    v_pk_mul_f32 v[18:19], v[18:19], v[12:13] op_sel_hi:[1,0]
    v_cvt_pk_bf16_f32 v53, v18, v19
    v_lshlrev_b32 v14, 16, v54
    v_and_b32 v15, 0xffff0000, v54
    v_pk_mul_f32 v[14:15], v[14:15], v[12:13] op_sel_hi:[1,0]
    v_cvt_pk_bf16_f32 v54, v14, v15
    v_lshlrev_b32 v16, 16, v55
    v_and_b32 v17, 0xffff0000, v55
    v_pk_mul_f32 v[16:17], v[16:17], v[12:13] op_sel_hi:[1,0]
    v_cvt_pk_bf16_f32 v55, v16, v17
    v_dot2_f32_bf16 v12, v56, v56, 0
    v_dot2_f32_bf16 v12, v57, v57, v12
    v_dot2_f32_bf16 v12, v58, v58, v12
    v_dot2_f32_bf16 v12, v59, v59, v12
    v_dot2_f32_bf16 v12, v60, v60, v12
    v_dot2_f32_bf16 v12, v61, v61, v12
    v_dot2_f32_bf16 v12, v62, v62, v12
    v_dot2_f32_bf16 v12, v63, v63, v12
    v_lshlrev_b32 v14, 16, v56
    v_and_b32 v15, 0xffff0000, v56
    v_lshlrev_b32 v16, 16, v57
    v_mov_b32 v13, v12
    v_and_b32 v17, 0xffff0000, v57
    v_lshlrev_b32 v18, 16, v58
    v_permlane32_swap_b32 v12, v13
    v_and_b32 v19, 0xffff0000, v58
    v_add_f32 v12, v12, v13
    v_sqrt_f32 v12, v12
    s_nop 0
    v_add_f32 v12, s61, v12
    v_rcp_f32 v12, v12
    s_nop 0
    v_mul_f32 v12, v10, v12
    v_pk_mul_f32 v[14:15], v[14:15], v[12:13] op_sel_hi:[1,0]
    v_cvt_pk_bf16_f32 v56, v14, v15
    v_pk_mul_f32 v[16:17], v[16:17], v[12:13] op_sel_hi:[1,0]
    v_cvt_pk_bf16_f32 v57, v16, v17
    v_pk_mul_f32 v[18:19], v[18:19], v[12:13] op_sel_hi:[1,0]
    v_cvt_pk_bf16_f32 v58, v18, v19
    v_lshlrev_b32 v14, 16, v59
    v_and_b32 v15, 0xffff0000, v59
    v_pk_mul_f32 v[14:15], v[14:15], v[12:13] op_sel_hi:[1,0]
    v_cvt_pk_bf16_f32 v59, v14, v15
    v_lshlrev_b32 v16, 16, v60
    v_and_b32 v17, 0xffff0000, v60
    v_pk_mul_f32 v[16:17], v[16:17], v[12:13] op_sel_hi:[1,0]
    v_cvt_pk_bf16_f32 v60, v16, v17
    v_lshlrev_b32 v18, 16, v61
    v_and_b32 v19, 0xffff0000, v61
    v_pk_mul_f32 v[18:19], v[18:19], v[12:13] op_sel_hi:[1,0]
    v_cvt_pk_bf16_f32 v61, v18, v19
    v_lshlrev_b32 v14, 16, v62
    v_and_b32 v15, 0xffff0000, v62
    v_pk_mul_f32 v[14:15], v[14:15], v[12:13] op_sel_hi:[1,0]
    v_cvt_pk_bf16_f32 v62, v14, v15
    v_lshlrev_b32 v16, 16, v63
    v_and_b32 v17, 0xffff0000, v63
    v_pk_mul_f32 v[16:17], v[16:17], v[12:13] op_sel_hi:[1,0]
    v_cvt_pk_bf16_f32 v63, v16, v17
    v_mov_b32 v160, 0xff800000
    v_mov_b32 v161, 0xff800000
    v_mov_b32 v162, 0xff800000
    v_mov_b32 v163, 0xff800000
    v_add_u32 v3, s55, v3
    s_add_u32 m0, s55, 32768
    s_mov_b32 s34, 0
L_slow_kv:
    buffer_load_dwordx4 v[24:27], v1, s[8:11], s34 offen
    buffer_load_dwordx4 v[28:31], v1, s[8:11], s34 offen offset:32
    buffer_load_dwordx4 v2, s[12:15], s34 offen lds
    buffer_load_dwordx4 v2, s[12:15], s34 offen offset:1024 lds
    s_waitcnt vmcnt(0)
    ds_read_b64_tr_b16 a[32:33], v3 offset:32768
    ds_read_b64_tr_b16 a[34:35], v3 offset:33024
    ds_read_b64_tr_b16 a[36:37], v3 offset:33792
    ds_read_b64_tr_b16 a[38:39], v3 offset:34048
    v_dot2_f32_bf16 v12, v24, v24, 0
    v_dot2_f32_bf16 v12, v25, v25, v12
    v_dot2_f32_bf16 v12, v26, v26, v12
    v_dot2_f32_bf16 v12, v27, v27, v12
    v_dot2_f32_bf16 v12, v28, v28, v12
    v_dot2_f32_bf16 v12, v29, v29, v12
    v_dot2_f32_bf16 v12, v30, v30, v12
    v_dot2_f32_bf16 v12, v31, v31, v12
    v_lshlrev_b32 v14, 16, v24
    v_and_b32 v15, 0xffff0000, v24
    v_lshlrev_b32 v16, 16, v25
    v_mov_b32 v13, v12
    v_and_b32 v17, 0xffff0000, v25
    v_lshlrev_b32 v18, 16, v26
    v_permlane32_swap_b32 v12, v13
    v_and_b32 v19, 0xffff0000, v26
    v_add_f32 v12, v12, v13
    v_sqrt_f32 v12, v12
    s_nop 0
    v_add_f32 v12, s61, v12
    v_rcp_f32 v12, v12
    s_nop 0
    v_pk_mul_f32 v[14:15], v[14:15], v[12:13] op_sel_hi:[1,0]
    v_cvt_pk_bf16_f32 v24, v14, v15
    v_pk_mul_f32 v[16:17], v[16:17], v[12:13] op_sel_hi:[1,0]
    v_cvt_pk_bf16_f32 v25, v16, v17
    v_pk_mul_f32 v[18:19], v[18:19], v[12:13] op_sel_hi:[1,0]
    v_cvt_pk_bf16_f32 v26, v18, v19
    v_lshlrev_b32 v14, 16, v27
    v_and_b32 v15, 0xffff0000, v27
    v_pk_mul_f32 v[14:15], v[14:15], v[12:13] op_sel_hi:[1,0]
    v_cvt_pk_bf16_f32 v27, v14, v15
    v_lshlrev_b32 v16, 16, v28
    v_and_b32 v17, 0xffff0000, v28
    v_pk_mul_f32 v[16:17], v[16:17], v[12:13] op_sel_hi:[1,0]
    v_cvt_pk_bf16_f32 v28, v16, v17
    v_lshlrev_b32 v18, 16, v29
    v_and_b32 v19, 0xffff0000, v29
    v_pk_mul_f32 v[18:19], v[18:19], v[12:13] op_sel_hi:[1,0]
    v_cvt_pk_bf16_f32 v29, v18, v19
    v_lshlrev_b32 v14, 16, v30
    v_and_b32 v15, 0xffff0000, v30
    v_pk_mul_f32 v[14:15], v[14:15], v[12:13] op_sel_hi:[1,0]
    v_cvt_pk_bf16_f32 v30, v14, v15
    v_lshlrev_b32 v16, 16, v31
    v_and_b32 v17, 0xffff0000, v31
    v_pk_mul_f32 v[16:17], v[16:17], v[12:13] op_sel_hi:[1,0]
    v_cvt_pk_bf16_f32 v31, v16, v17
    s_waitcnt lgkmcnt(0)
    s_nop 1
    v_mfma_f32_32x32x16_bf16 v[144:159], v[24:27], v[32:35], 0
    v_mfma_f32_32x32x16_bf16 v[144:159], v[28:31], v[36:39], v[144:159]
    s_nop 15
    v_max3_f32 v12, v144, v145, v160
    v_max3_f32 v12, v146, v147, v12
    v_max3_f32 v12, v148, v149, v12
    v_max3_f32 v12, v150, v151, v12
    v_max3_f32 v12, v152, v153, v12
    v_max3_f32 v12, v154, v155, v12
    v_max3_f32 v12, v156, v157, v12
    v_max3_f32 v12, v158, v159, v12
    v_mov_b32 v13, v12
    s_nop 1
    v_permlane32_swap_b32 v12, v13
    s_nop 0
    v_max_f32 v12, v12, v13
    v_sub_f32 v14, v160, v12
    v_exp_f32 v14, v14
    v_mov_b32 v160, v12
    v_sub_f32 v144, v144, v12
    v_sub_f32 v145, v145, v12
    v_sub_f32 v146, v146, v12
    v_sub_f32 v147, v147, v12
    v_sub_f32 v148, v148, v12
    v_sub_f32 v149, v149, v12
    v_sub_f32 v150, v150, v12
    v_sub_f32 v151, v151, v12
    v_sub_f32 v152, v152, v12
    v_sub_f32 v153, v153, v12
    v_sub_f32 v154, v154, v12
    v_sub_f32 v155, v155, v12
    v_sub_f32 v156, v156, v12
    v_sub_f32 v157, v157, v12
    v_sub_f32 v158, v158, v12
    v_sub_f32 v159, v159, v12
    v_exp_f32 v144, v144
    v_exp_f32 v145, v145
    v_exp_f32 v146, v146
    v_exp_f32 v147, v147
    v_exp_f32 v148, v148
    v_exp_f32 v149, v149
    v_exp_f32 v150, v150
    v_exp_f32 v151, v151
    v_exp_f32 v152, v152
    v_exp_f32 v153, v153
    v_exp_f32 v154, v154
    v_exp_f32 v155, v155
    v_exp_f32 v156, v156
    v_exp_f32 v157, v157
    v_exp_f32 v158, v158
    v_exp_f32 v159, v159
    v_mul_f32 v64, v64, v14
    v_mul_f32 v65, v65, v14
    v_mul_f32 v66, v66, v14
    v_mul_f32 v67, v67, v14
    v_mul_f32 v68, v68, v14
    v_mul_f32 v69, v69, v14
    v_mul_f32 v70, v70, v14
    v_mul_f32 v71, v71, v14
    v_mul_f32 v72, v72, v14
    v_mul_f32 v73, v73, v14
    v_mul_f32 v74, v74, v14
    v_mul_f32 v75, v75, v14
    v_mul_f32 v76, v76, v14
    v_mul_f32 v77, v77, v14
    v_mul_f32 v78, v78, v14
    v_mul_f32 v79, v79, v14
    v_mul_f32 v128, v128, v14
    s_nop 1
    v_smfmac_f32_32x32x32_bf16 v[64:79], a[32:35], v[144:151], v5
    v_smfmac_f32_16x16x64_bf16 v[128:131], v[20:23], v[144:151], v5
    v_smfmac_f32_32x32x32_bf16 v[64:79], a[36:39], v[152:159], v5
    v_smfmac_f32_16x16x64_bf16 v[128:131], v[20:23], v[152:159], v5
    v_mfma_f32_32x32x16_bf16 v[144:159], v[24:27], v[40:43], 0
    v_mfma_f32_32x32x16_bf16 v[144:159], v[28:31], v[44:47], v[144:159]
    s_nop 15
    v_max3_f32 v12, v144, v145, v161
    v_max3_f32 v12, v146, v147, v12
    v_max3_f32 v12, v148, v149, v12
    v_max3_f32 v12, v150, v151, v12
    v_max3_f32 v12, v152, v153, v12
    v_max3_f32 v12, v154, v155, v12
    v_max3_f32 v12, v156, v157, v12
    v_max3_f32 v12, v158, v159, v12
    v_mov_b32 v13, v12
    s_nop 1
    v_permlane32_swap_b32 v12, v13
    s_nop 0
    v_max_f32 v12, v12, v13
    v_sub_f32 v14, v161, v12
    v_exp_f32 v14, v14
    v_mov_b32 v161, v12
    v_sub_f32 v144, v144, v12
    v_sub_f32 v145, v145, v12
    v_sub_f32 v146, v146, v12
    v_sub_f32 v147, v147, v12
    v_sub_f32 v148, v148, v12
    v_sub_f32 v149, v149, v12
    v_sub_f32 v150, v150, v12
    v_sub_f32 v151, v151, v12
    v_sub_f32 v152, v152, v12
    v_sub_f32 v153, v153, v12
    v_sub_f32 v154, v154, v12
    v_sub_f32 v155, v155, v12
    v_sub_f32 v156, v156, v12
    v_sub_f32 v157, v157, v12
    v_sub_f32 v158, v158, v12
    v_sub_f32 v159, v159, v12
    v_exp_f32 v144, v144
    v_exp_f32 v145, v145
    v_exp_f32 v146, v146
    v_exp_f32 v147, v147
    v_exp_f32 v148, v148
    v_exp_f32 v149, v149
    v_exp_f32 v150, v150
    v_exp_f32 v151, v151
    v_exp_f32 v152, v152
    v_exp_f32 v153, v153
    v_exp_f32 v154, v154
    v_exp_f32 v155, v155
    v_exp_f32 v156, v156
    v_exp_f32 v157, v157
    v_exp_f32 v158, v158
    v_exp_f32 v159, v159
    v_mul_f32 v80, v80, v14
    v_mul_f32 v81, v81, v14
    v_mul_f32 v82, v82, v14
    v_mul_f32 v83, v83, v14
    v_mul_f32 v84, v84, v14
    v_mul_f32 v85, v85, v14
    v_mul_f32 v86, v86, v14
    v_mul_f32 v87, v87, v14
    v_mul_f32 v88, v88, v14
    v_mul_f32 v89, v89, v14
    v_mul_f32 v90, v90, v14
    v_mul_f32 v91, v91, v14
    v_mul_f32 v92, v92, v14
    v_mul_f32 v93, v93, v14
    v_mul_f32 v94, v94, v14
    v_mul_f32 v95, v95, v14
    v_mul_f32 v132, v132, v14
    s_nop 1
    v_smfmac_f32_32x32x32_bf16 v[80:95], a[32:35], v[144:151], v5
    v_smfmac_f32_16x16x64_bf16 v[132:135], v[20:23], v[144:151], v5
    v_smfmac_f32_32x32x32_bf16 v[80:95], a[36:39], v[152:159], v5
    v_smfmac_f32_16x16x64_bf16 v[132:135], v[20:23], v[152:159], v5
    v_mfma_f32_32x32x16_bf16 v[144:159], v[24:27], v[48:51], 0
    v_mfma_f32_32x32x16_bf16 v[144:159], v[28:31], v[52:55], v[144:159]
    s_nop 15
    v_max3_f32 v12, v144, v145, v162
    v_max3_f32 v12, v146, v147, v12
    v_max3_f32 v12, v148, v149, v12
    v_max3_f32 v12, v150, v151, v12
    v_max3_f32 v12, v152, v153, v12
    v_max3_f32 v12, v154, v155, v12
    v_max3_f32 v12, v156, v157, v12
    v_max3_f32 v12, v158, v159, v12
    v_mov_b32 v13, v12
    s_nop 1
    v_permlane32_swap_b32 v12, v13
    s_nop 0
    v_max_f32 v12, v12, v13
    v_sub_f32 v14, v162, v12
    v_exp_f32 v14, v14
    v_mov_b32 v162, v12
    v_sub_f32 v144, v144, v12
    v_sub_f32 v145, v145, v12
    v_sub_f32 v146, v146, v12
    v_sub_f32 v147, v147, v12
    v_sub_f32 v148, v148, v12
    v_sub_f32 v149, v149, v12
    v_sub_f32 v150, v150, v12
    v_sub_f32 v151, v151, v12
    v_sub_f32 v152, v152, v12
    v_sub_f32 v153, v153, v12
    v_sub_f32 v154, v154, v12
    v_sub_f32 v155, v155, v12
    v_sub_f32 v156, v156, v12
    v_sub_f32 v157, v157, v12
    v_sub_f32 v158, v158, v12
    v_sub_f32 v159, v159, v12
    v_exp_f32 v144, v144
    v_exp_f32 v145, v145
    v_exp_f32 v146, v146
    v_exp_f32 v147, v147
    v_exp_f32 v148, v148
    v_exp_f32 v149, v149
    v_exp_f32 v150, v150
    v_exp_f32 v151, v151
    v_exp_f32 v152, v152
    v_exp_f32 v153, v153
    v_exp_f32 v154, v154
    v_exp_f32 v155, v155
    v_exp_f32 v156, v156
    v_exp_f32 v157, v157
    v_exp_f32 v158, v158
    v_exp_f32 v159, v159
    v_mul_f32 v96, v96, v14
    v_mul_f32 v97, v97, v14
    v_mul_f32 v98, v98, v14
    v_mul_f32 v99, v99, v14
    v_mul_f32 v100, v100, v14
    v_mul_f32 v101, v101, v14
    v_mul_f32 v102, v102, v14
    v_mul_f32 v103, v103, v14
    v_mul_f32 v104, v104, v14
    v_mul_f32 v105, v105, v14
    v_mul_f32 v106, v106, v14
    v_mul_f32 v107, v107, v14
    v_mul_f32 v108, v108, v14
    v_mul_f32 v109, v109, v14
    v_mul_f32 v110, v110, v14
    v_mul_f32 v111, v111, v14
    v_mul_f32 v136, v136, v14
    s_nop 1
    v_smfmac_f32_32x32x32_bf16 v[96:111], a[32:35], v[144:151], v5
    v_smfmac_f32_16x16x64_bf16 v[136:139], v[20:23], v[144:151], v5
    v_smfmac_f32_32x32x32_bf16 v[96:111], a[36:39], v[152:159], v5
    v_smfmac_f32_16x16x64_bf16 v[136:139], v[20:23], v[152:159], v5
    v_mfma_f32_32x32x16_bf16 v[144:159], v[24:27], v[56:59], 0
    v_mfma_f32_32x32x16_bf16 v[144:159], v[28:31], v[60:63], v[144:159]
    s_nop 15
    v_max3_f32 v12, v144, v145, v163
    v_max3_f32 v12, v146, v147, v12
    v_max3_f32 v12, v148, v149, v12
    v_max3_f32 v12, v150, v151, v12
    v_max3_f32 v12, v152, v153, v12
    v_max3_f32 v12, v154, v155, v12
    v_max3_f32 v12, v156, v157, v12
    v_max3_f32 v12, v158, v159, v12
    v_mov_b32 v13, v12
    s_nop 1
    v_permlane32_swap_b32 v12, v13
    s_nop 0
    v_max_f32 v12, v12, v13
    v_sub_f32 v14, v163, v12
    v_exp_f32 v14, v14
    v_mov_b32 v163, v12
    v_sub_f32 v144, v144, v12
    v_sub_f32 v145, v145, v12
    v_sub_f32 v146, v146, v12
    v_sub_f32 v147, v147, v12
    v_sub_f32 v148, v148, v12
    v_sub_f32 v149, v149, v12
    v_sub_f32 v150, v150, v12
    v_sub_f32 v151, v151, v12
    v_sub_f32 v152, v152, v12
    v_sub_f32 v153, v153, v12
    v_sub_f32 v154, v154, v12
    v_sub_f32 v155, v155, v12
    v_sub_f32 v156, v156, v12
    v_sub_f32 v157, v157, v12
    v_sub_f32 v158, v158, v12
    v_sub_f32 v159, v159, v12
    v_exp_f32 v144, v144
    v_exp_f32 v145, v145
    v_exp_f32 v146, v146
    v_exp_f32 v147, v147
    v_exp_f32 v148, v148
    v_exp_f32 v149, v149
    v_exp_f32 v150, v150
    v_exp_f32 v151, v151
    v_exp_f32 v152, v152
    v_exp_f32 v153, v153
    v_exp_f32 v154, v154
    v_exp_f32 v155, v155
    v_exp_f32 v156, v156
    v_exp_f32 v157, v157
    v_exp_f32 v158, v158
    v_exp_f32 v159, v159
    v_mul_f32 v112, v112, v14
    v_mul_f32 v113, v113, v14
    v_mul_f32 v114, v114, v14
    v_mul_f32 v115, v115, v14
    v_mul_f32 v116, v116, v14
    v_mul_f32 v117, v117, v14
    v_mul_f32 v118, v118, v14
    v_mul_f32 v119, v119, v14
    v_mul_f32 v120, v120, v14
    v_mul_f32 v121, v121, v14
    v_mul_f32 v122, v122, v14
    v_mul_f32 v123, v123, v14
    v_mul_f32 v124, v124, v14
    v_mul_f32 v125, v125, v14
    v_mul_f32 v126, v126, v14
    v_mul_f32 v127, v127, v14
    v_mul_f32 v140, v140, v14
    s_nop 1
    v_smfmac_f32_32x32x32_bf16 v[112:127], a[32:35], v[144:151], v5
    v_smfmac_f32_16x16x64_bf16 v[140:143], v[20:23], v[144:151], v5
    v_smfmac_f32_32x32x32_bf16 v[112:127], a[36:39], v[152:159], v5
    v_smfmac_f32_16x16x64_bf16 v[140:143], v[20:23], v[152:159], v5
    s_nop 15
    s_add_u32 s34, s34, 2048
    s_cmp_lt_u32 s34, 0x20000
    s_cbranch_scc1 L_slow_kv
    v_rcp_f32 v12, v128
    s_nop 0
    v_pk_mul_f32 v[64:65], v[64:65], v[12:13] op_sel_hi:[1,0]
    v_pk_mul_f32 v[66:67], v[66:67], v[12:13] op_sel_hi:[1,0]
    v_pk_mul_f32 v[68:69], v[68:69], v[12:13] op_sel_hi:[1,0]
    v_pk_mul_f32 v[70:71], v[70:71], v[12:13] op_sel_hi:[1,0]
    v_pk_mul_f32 v[72:73], v[72:73], v[12:13] op_sel_hi:[1,0]
    v_pk_mul_f32 v[74:75], v[74:75], v[12:13] op_sel_hi:[1,0]
    v_pk_mul_f32 v[76:77], v[76:77], v[12:13] op_sel_hi:[1,0]
    v_pk_mul_f32 v[78:79], v[78:79], v[12:13] op_sel_hi:[1,0]
    v_cvt_pk_bf16_f32 v64, v64, v65
    v_cvt_pk_bf16_f32 v65, v66, v67
    v_cvt_pk_bf16_f32 v66, v68, v69
    v_cvt_pk_bf16_f32 v67, v70, v71
    v_cvt_pk_bf16_f32 v68, v72, v73
    v_cvt_pk_bf16_f32 v69, v74, v75
    v_cvt_pk_bf16_f32 v70, v76, v77
    v_cvt_pk_bf16_f32 v71, v78, v79
    v_permlane16_swap_b32 v64, v68
    v_permlane16_swap_b32 v65, v69
    v_permlane16_swap_b32 v66, v70
    v_permlane16_swap_b32 v67, v71
    buffer_store_dwordx4 v[64:67], v9, s[16:19], s33 offen sc1 nt
    buffer_store_dwordx4 v[68:71], v9, s[16:19], s33 offen offset:1024 sc1 nt
    v_rcp_f32 v14, v132
    s_nop 0
    v_pk_mul_f32 v[80:81], v[80:81], v[14:15] op_sel_hi:[1,0]
    v_pk_mul_f32 v[82:83], v[82:83], v[14:15] op_sel_hi:[1,0]
    v_pk_mul_f32 v[84:85], v[84:85], v[14:15] op_sel_hi:[1,0]
    v_pk_mul_f32 v[86:87], v[86:87], v[14:15] op_sel_hi:[1,0]
    v_pk_mul_f32 v[88:89], v[88:89], v[14:15] op_sel_hi:[1,0]
    v_pk_mul_f32 v[90:91], v[90:91], v[14:15] op_sel_hi:[1,0]
    v_pk_mul_f32 v[92:93], v[92:93], v[14:15] op_sel_hi:[1,0]
    v_pk_mul_f32 v[94:95], v[94:95], v[14:15] op_sel_hi:[1,0]
    v_cvt_pk_bf16_f32 v80, v80, v81
    v_cvt_pk_bf16_f32 v81, v82, v83
    v_cvt_pk_bf16_f32 v82, v84, v85
    v_cvt_pk_bf16_f32 v83, v86, v87
    v_cvt_pk_bf16_f32 v84, v88, v89
    v_cvt_pk_bf16_f32 v85, v90, v91
    v_cvt_pk_bf16_f32 v86, v92, v93
    v_cvt_pk_bf16_f32 v87, v94, v95
    v_permlane16_swap_b32 v80, v84
    v_permlane16_swap_b32 v81, v85
    v_permlane16_swap_b32 v82, v86
    v_permlane16_swap_b32 v83, v87
    buffer_store_dwordx4 v[80:83], v9, s[16:19], s35 offen sc1 nt
    buffer_store_dwordx4 v[84:87], v9, s[16:19], s35 offen offset:1024 sc1 nt
    v_rcp_f32 v12, v136
    s_nop 0
    v_pk_mul_f32 v[96:97], v[96:97], v[12:13] op_sel_hi:[1,0]
    v_pk_mul_f32 v[98:99], v[98:99], v[12:13] op_sel_hi:[1,0]
    v_pk_mul_f32 v[100:101], v[100:101], v[12:13] op_sel_hi:[1,0]
    v_pk_mul_f32 v[102:103], v[102:103], v[12:13] op_sel_hi:[1,0]
    v_pk_mul_f32 v[104:105], v[104:105], v[12:13] op_sel_hi:[1,0]
    v_pk_mul_f32 v[106:107], v[106:107], v[12:13] op_sel_hi:[1,0]
    v_pk_mul_f32 v[108:109], v[108:109], v[12:13] op_sel_hi:[1,0]
    v_pk_mul_f32 v[110:111], v[110:111], v[12:13] op_sel_hi:[1,0]
    v_cvt_pk_bf16_f32 v96, v96, v97
    v_cvt_pk_bf16_f32 v97, v98, v99
    v_cvt_pk_bf16_f32 v98, v100, v101
    v_cvt_pk_bf16_f32 v99, v102, v103
    v_cvt_pk_bf16_f32 v100, v104, v105
    v_cvt_pk_bf16_f32 v101, v106, v107
    v_cvt_pk_bf16_f32 v102, v108, v109
    v_cvt_pk_bf16_f32 v103, v110, v111
    v_permlane16_swap_b32 v96, v100
    v_permlane16_swap_b32 v97, v101
    v_permlane16_swap_b32 v98, v102
    v_permlane16_swap_b32 v99, v103
    buffer_store_dwordx4 v[96:99], v9, s[16:19], s54 offen sc1 nt
    buffer_store_dwordx4 v[100:103], v9, s[16:19], s54 offen offset:1024 sc1 nt
    v_rcp_f32 v14, v140
    s_nop 0
    v_pk_mul_f32 v[112:113], v[112:113], v[14:15] op_sel_hi:[1,0]
    v_pk_mul_f32 v[114:115], v[114:115], v[14:15] op_sel_hi:[1,0]
    v_pk_mul_f32 v[116:117], v[116:117], v[14:15] op_sel_hi:[1,0]
    v_pk_mul_f32 v[118:119], v[118:119], v[14:15] op_sel_hi:[1,0]
    v_pk_mul_f32 v[120:121], v[120:121], v[14:15] op_sel_hi:[1,0]
    v_pk_mul_f32 v[122:123], v[122:123], v[14:15] op_sel_hi:[1,0]
    v_pk_mul_f32 v[124:125], v[124:125], v[14:15] op_sel_hi:[1,0]
    v_pk_mul_f32 v[126:127], v[126:127], v[14:15] op_sel_hi:[1,0]
    v_cvt_pk_bf16_f32 v112, v112, v113
    v_cvt_pk_bf16_f32 v113, v114, v115
    v_cvt_pk_bf16_f32 v114, v116, v117
    v_cvt_pk_bf16_f32 v115, v118, v119
    v_cvt_pk_bf16_f32 v116, v120, v121
    v_cvt_pk_bf16_f32 v117, v122, v123
    v_cvt_pk_bf16_f32 v118, v124, v125
    v_cvt_pk_bf16_f32 v119, v126, v127
    v_permlane16_swap_b32 v112, v116
    v_permlane16_swap_b32 v113, v117
    v_permlane16_swap_b32 v114, v118
    v_permlane16_swap_b32 v115, v119
    buffer_store_dwordx4 v[112:115], v9, s[16:19], s59 offen sc1 nt
    buffer_store_dwordx4 v[116:119], v9, s[16:19], s59 offen offset:1024 sc1 nt
    s_endpgm
.section .rodata,"a"
.p2align 6
.amdhsa_kernel standalone__qk_norm__prompt_kernel
  .amdhsa_next_free_vgpr 256
  .amdhsa_next_free_sgpr 102
  .amdhsa_accum_offset 192
  .amdhsa_group_segment_fixed_size 0
  .amdhsa_kernarg_size 56
  .amdhsa_user_sgpr_count 2
  .amdhsa_user_sgpr_kernarg_segment_ptr 1
  .amdhsa_system_sgpr_workgroup_id_x 1
.end_amdhsa_kernel
```
